```python
import torch

def _softmax(x, axis=-1):
    return torch.softmax(x, dim=axis)
def _gelu(x):
    return torch.nn.functional.gelu(x, approximate="tanh")
def _silu(x):
    return torch.nn.functional.silu(x)
def _sigmoid(x):
    return torch.sigmoid(x)
def _layernorm(x, axis=-1, eps=1e-5):
    m = x.mean(dim=axis, keepdim=True)
    v = x.var(dim=axis, keepdim=True, unbiased=False)
    return (x - m) / torch.sqrt(v + eps)
def _scatter_add(tgt, idx, src, axis=0):
    return tgt.clone().index_add_(axis, idx, src)
def _segment_sum(src, seg, n):
    out = torch.zeros((n,) + src.shape[1:], dtype=src.dtype)
    return out.index_add_(0, seg, src)
def _pad(x, pw):
    flat = tuple(v for pair in reversed(pw) for v in pair)
    return torch.nn.functional.pad(x, flat)

kernel_name = 'gated_mix__linear_kernel_hedgehog__sliding_block__prompt'

def setup_inputs():

    _w = (lambda a: (lambda t: t.to(torch.bfloat16) if t.is_floating_point() else t)(torch.as_tensor(a)))
    def _A_setup():
        B, S, D, H = 1, 2048, 640, 32
        Dh = D // H
        return {
            "x": _w((lambda *s: torch.randn(*s, dtype=torch.bfloat16) * 0.05)(B, S, D)),
            "wqkv": _w((lambda *s: torch.randn(*s, dtype=torch.bfloat16) * 1.6)(D, 3 * D)),
            "w_phi": _w((lambda *s: torch.randn(*s, dtype=torch.bfloat16) * 1.6)(H, Dh, Dh) * (Dh ** -0.5)),
            "wo": _w((lambda *s: torch.randn(*s, dtype=torch.bfloat16) * 0.1)(D, D)),
        }
    _A_in = _A_setup()

    def _B_setup():
        B, S, D = 1, 2048, 640
        return {
            "x": _w((lambda *s: torch.randn(*s, dtype=torch.bfloat16) * 0.05)(B, S, D)),
            "wqkv": _w((lambda *s: torch.randn(*s, dtype=torch.bfloat16) * 0.8)(D, 3 * D)),
            "wo": _w((lambda *s: torch.randn(*s, dtype=torch.bfloat16) * 0.05)(D, D)),
        }
    _B_in = _B_setup()

    return {
        "A_x": _A_in["x"],
        "A_wqkv": _A_in["wqkv"],
        "A_w_phi": _A_in["w_phi"],
        "A_wo": _A_in["wo"],
        "B_x": _B_in["x"],
        "B_wqkv": _B_in["wqkv"],
        "B_wo": _B_in["wo"],
        "gate_w": _w((lambda *s: torch.randn(*s, dtype=torch.bfloat16) * 0.05)(640) * 16.0),
    }

def reference(A_x, A_wqkv, A_w_phi, A_wo, B_x, B_wqkv, B_wo, gate_w):
    def _A_ref(x, wqkv, w_phi, wo):
        B, S, D = x.shape
        H = 32; Dh = D // H
        qkv = (lambda x, *d: x.permute(*d))((x @ wqkv).reshape(B, S, 3, H, Dh), 2, 0, 3, 1, 4)
        q, k, v = qkv[0], qkv[1], qkv[2]
        pq = torch.einsum("bhsd,hdf->bhsf", q, w_phi)
        pk = torch.einsum("bhsd,hdf->bhsf", k, w_phi)
        phi_q = torch.concatenate([_softmax(pq, axis=-1), _softmax(-pq, axis=-1)], axis=-1)
        phi_k = torch.concatenate([_softmax(pk, axis=-1), _softmax(-pk, axis=-1)], axis=-1)
        kv = torch.einsum("bhsf,bhsd->bhfd", phi_k, v)
        z  = torch.einsum("bhsf->bhf", phi_k)
        num = torch.einsum("bhqf,bhfd->bhqd", phi_q, kv)
        den = torch.einsum("bhqf,bhf->bhq", phi_q, z)[..., None] + 1e-6
        o = num / den
        return (lambda x, *d: x.permute(*d))(o, 0, 2, 1, 3).reshape(B, S, D) @ wo

    def _B_ref(x, wqkv, wo):
        B, S, D = x.shape
        H = 32; Dh = D // H; W = 256
        qkv = (lambda x, *d: x.permute(*d))((x @ wqkv).reshape(B, S, 3, H, Dh), 2, 0, 3, 1, 4)
        q, k, v = qkv[0], qkv[1], qkv[2]
        scores = torch.einsum("bhqd,bhkd->bhqk", q, k) * (Dh ** -0.5)
        idx = torch.arange(S)
        mask = (idx[:, None] - idx[None, :] >= 0) & (idx[:, None] - idx[None, :] < W)
        scores = torch.where(mask[None, None], scores, -1e9)
        p = _softmax(scores, axis=-1)
        o = torch.einsum("bhqk,bhkd->bhqd", p, v)
        return (lambda x, *d: x.permute(*d))(o, 0, 2, 1, 3).reshape(B, S, D) @ wo

    x = A_x
    g = _sigmoid((x * gate_w).sum(-1, keepdims=True))
    a = _A_ref(x, A_wqkv, A_w_phi, A_wo)
    b = _B_ref(x, B_wqkv, B_wo)
    return g * a + (1 - g) * b
```

```asm
; @launch grid=(256,1,1) block=(512,1,1) lds=163840
.amdgcn_target "amdgcn-amd-amdhsa--gfx950"
.text
.globl gated_mix__linear_kernel_hedgehog__sliding_block__prompt_kernel
.p2align 8
.type gated_mix__linear_kernel_hedgehog__sliding_block__prompt_kernel,@function
gated_mix__linear_kernel_hedgehog__sliding_block__prompt_kernel:
    s_cmpk_ge_u32 s2, 256
    s_cbranch_scc1 L_end
    s_load_dwordx8 s[36:43], s[0:1], 0
    s_load_dwordx8 s[44:51], s[0:1], 40
    v_readfirstlane_b32 s25, v0
    v_and_b32 v0, 63, v0
    s_and_b32 s20, s2, 7
    s_lshr_b32 s21, s2, 3
    s_lshr_b32 s25, s25, 6
    s_cbranch_scc0 L_t_code
    s_cmp_ge_u32 s25, 4
    s_cbranch_scc1 L_nocpf
    s_lshr_b32 s28, s20, 1
    s_cmp_eq_u32 s25, 3
    s_cbranch_scc1 L_t_x
    s_mul_i32 s28, s28, 5
    s_lshr_b32 s28, s28, 1
    s_lshl1_add_u32 s29, s21, s25
    s_mulk_i32 s29, 90
    s_add_u32 s28, s28, s29
    s_addk_i32 s28, -90
    s_movk_i32 s29, 86
    s_mov_b32 s30, 7
    s_mov_b32 s31, 26
    s_bitcmp1_b32 s20, 0
    s_waitcnt lgkmcnt(0)
    s_cselect_b64 s[32:33], s[44:45], s[38:39]
    s_branch L_t
L_t_x:
    s_and_b32 s29, s20, 1
    s_lshl2_add_u32 s28, s29, s28
    s_lshl_b32 s28, s28, 5
    s_add_u32 s28, s28, s21
    s_mulk_i32 s28, 80
    s_movk_i32 s29, 86
    s_mov_b32 s30, 7
    s_mov_b32 s31, 23
    s_waitcnt lgkmcnt(0)
    s_mov_b64 s[32:33], s[36:37]
    s_branch L_t
L_t_code:
    s_getpc_b64 s[32:33]
    s_and_b32 s28, s21, 7
    s_mulk_i32 s28, 37
    s_mov_b32 s29, 0
    s_mov_b32 s30, 0
    s_mov_b32 s31, 36
L_t:
    v_min_u32 v1, s31, v0
    v_mul_u32_u24 v2, s29, v1
    v_lshrrev_b32 v2, 8, v2
    v_mad_u32_u24 v1, v2, s30, v1
    v_add_lshl_u32 v2, v1, s28, 7
    v_mov_b32 v3, 0
    v_lshl_add_u64 v[2:3], v[2:3], 0, s[32:33]
    global_load_dword v13, v[2:3], off
L_nocpf:
    s_load_dwordx4 s[52:55], s[0:1], 72
    s_and_b32 s26, s21, 7
    s_and_b32 s57, s20, 1
    s_lshl3_add_u32 s22, s57, s26
    s_lshr_b32 s27, s21, 3
    s_and_b32 s23, s27, 1
    s_and_b32 s56, s20, 6
    s_lshr_b32 s28, s27, 1
    s_add_u32 s24, s56, s28
    s_and_b32 s35, s25, 3
    s_mov_b32 s6, 2621440
    s_mov_b32 s7, 0x20000
    s_mov_b32 s11, s7
    s_mov_b32 s15, s7
    s_mov_b32 s19, s7
    s_mov_b32 s75, s7
    s_cmp_lt_u32 s25, 4
    s_cbranch_scc1 L_cons
    s_setprio 2
    v_lshrrev_b32 v1, 3, v0
    s_lshl4_add_u32 s28, s22, s35
    s_mul_i32 s28, s28, 10240
    v_mul_u32_u24 v1, 1280, v1
    s_lshl_b32 s29, s35, 2
    v_lshrrev_b32 v3, 4, v0
    v_xor_b32 v3, v3, v0
    v_xor_b32 v3, s29, v3
    v_and_b32 v3, 7, v3
    v_lshlrev_b32 v3, 4, v3
    v_add3_u32 v1, v3, v1, s28
    v_mul_u32_u24 v6, 26, v0
    v_lshrrev_b32 v6, 8, v6
    v_cmp_le_u32 vcc, 30, v0
    v_mul_u32_u24 v6, 1120, v6
    v_mov_b32 v5, 26880
    v_lshl_add_u32 v4, v0, 4, v6
    v_cndmask_b32 v5, 0, v5, vcc
    s_mul_i32 s28, s24, 160
    s_mul_i32 s63, s35, 960
    s_lshl2_add_u32 s28, s63, s28
    v_add3_u32 v2, v4, v5, s28
    s_mov_b32 s10, 2457600
    s_mov_b32 s60, -1
    s_mov_b32 s61, 0x0fffffff
    s_lshl_b32 s62, s35, 10
    s_add_u32 s63, s63, 16384
    s_mov_b32 s65, 0
    s_mov_b32 s68, s26
    s_lshl_b32 s59, s27, 12
    s_mov_b32 s31, 0
    s_mov_b32 s70, 0
L_h_nd:
    s_cmp_eq_u32 s23, 0
    s_waitcnt lgkmcnt(0)
    s_mov_b32 s4, s36
    s_mov_b32 s5, s37
    s_cselect_b32 s8, s38, s44
    s_cselect_b32 s9, s39, s45
L_h_head:
    s_and_b32 s64, s70, 15
    s_lshr_b64 s[70:71], s[70:71], 4
    s_lshl_b32 s66, s64, 7
    s_add_u32 s69, s62, s65
    s_add_u32 m0, s69, s59
    s_mul_i32 s28, s59, 10
    s_add_u32 s28, s28, s66
    buffer_load_dwordx4 v1, s[4:7], s28 offen lds
    s_add_u32 s59, s59, 4096
    s_and_b32 s59, s59, 0x3000
    s_add_u32 m0, s69, s59
    s_mul_i32 s28, s59, 10
    s_add_u32 s28, s28, s66
    buffer_load_dwordx4 v1, s[4:7], s28 offen lds
    s_add_u32 s59, s59, 4096
    s_and_b32 s59, s59, 0x3000
    s_add_u32 m0, s69, s59
    s_mul_i32 s28, s59, 10
    s_add_u32 s28, s28, s66
    buffer_load_dwordx4 v1, s[4:7], s28 offen lds
    s_add_u32 s59, s59, 4096
    s_and_b32 s59, s59, 0x3000
    s_add_u32 m0, s69, s59
    s_mul_i32 s28, s59, 10
    s_add_u32 s28, s28, s66
    buffer_load_dwordx4 v1, s[4:7], s28 offen lds
    s_add_u32 s59, s59, 4096
    s_and_b32 s59, s59, 0x3000
    s_mul_i32 s67, s64, 245760
    s_add_u32 s69, s63, s65
    s_mov_b64 exec, s[60:61]
    s_cmp_eq_u32 s31, 9
    s_cselect_b32 s68, 0, s68
    s_mul_i32 s28, s68, 3840
    s_add_u32 m0, s69, s28
    s_and_b32 s29, s68, 1
    s_mul_i32 s29, s29, 15360
    s_lshl3_add_u32 s28, s28, s67
    s_sub_u32 s28, s28, s29
    buffer_load_dwordx4 v2, s[8:11], s28 offen lds
    s_add_u32 s68, s68, 1
    s_and_b32 s68, s68, 7
    s_mul_i32 s28, s68, 3840
    s_add_u32 m0, s69, s28
    s_and_b32 s29, s68, 1
    s_mul_i32 s29, s29, 15360
    s_lshl3_add_u32 s28, s28, s67
    s_sub_u32 s28, s28, s29
    buffer_load_dwordx4 v2, s[8:11], s28 offen lds
    s_add_u32 s68, s68, 1
    s_and_b32 s68, s68, 7
    s_mul_i32 s28, s68, 3840
    s_add_u32 m0, s69, s28
    s_and_b32 s29, s68, 1
    s_mul_i32 s29, s29, 15360
    s_lshl3_add_u32 s28, s28, s67
    s_sub_u32 s28, s28, s29
    buffer_load_dwordx4 v2, s[8:11], s28 offen lds
    s_add_u32 s68, s68, 1
    s_and_b32 s68, s68, 7
    s_mul_i32 s28, s68, 3840
    s_add_u32 m0, s69, s28
    s_and_b32 s29, s68, 1
    s_mul_i32 s29, s29, 15360
    s_lshl3_add_u32 s28, s28, s67
    s_sub_u32 s28, s28, s29
    buffer_load_dwordx4 v2, s[8:11], s28 offen lds
    s_add_u32 s68, s68, 1
    s_and_b32 s68, s68, 7
    s_cmp_eq_u32 s31, 0
    s_cbranch_scc1 L_h_ord
    s_waitcnt vmcnt(8)
    s_setprio 0
    s_barrier
L_h_tail:
    s_mul_i32 s28, s68, 3840
    s_add_u32 m0, s69, s28
    s_and_b32 s29, s68, 1
    s_mul_i32 s29, s29, 15360
    s_lshl3_add_u32 s28, s28, s67
    s_sub_u32 s28, s28, s29
    buffer_load_dwordx4 v2, s[8:11], s28 offen lds
    s_add_u32 s68, s68, 1
    s_and_b32 s68, s68, 7
    s_mul_i32 s28, s68, 3840
    s_add_u32 m0, s69, s28
    s_and_b32 s29, s68, 1
    s_mul_i32 s29, s29, 15360
    s_lshl3_add_u32 s28, s28, s67
    s_sub_u32 s28, s28, s29
    buffer_load_dwordx4 v2, s[8:11], s28 offen lds
    s_add_u32 s68, s68, 1
    s_and_b32 s68, s68, 7
    s_mul_i32 s28, s68, 3840
    s_add_u32 m0, s69, s28
    s_and_b32 s29, s68, 1
    s_mul_i32 s29, s29, 15360
    s_lshl3_add_u32 s28, s28, s67
    s_sub_u32 s28, s28, s29
    buffer_load_dwordx4 v2, s[8:11], s28 offen lds
    s_add_u32 s68, s68, 1
    s_and_b32 s68, s68, 7
    s_mul_i32 s28, s68, 3840
    s_add_u32 m0, s69, s28
    s_and_b32 s29, s68, 1
    s_mul_i32 s29, s29, 15360
    s_lshl3_add_u32 s28, s28, s67
    s_sub_u32 s28, s28, s29
    buffer_load_dwordx4 v2, s[8:11], s28 offen lds
    s_add_u32 s68, s68, 1
    s_and_b32 s68, s68, 7
    s_mov_b64 exec, -1
    s_add_u32 s31, s31, 1
    s_cmp_eq_u32 s31, 10
    s_cbranch_scc1 L_h_post
    s_add_u32 s65, s65, 47104
    s_cmp_eq_u32 s65, 141312
    s_cselect_b32 s65, 0, s65
    s_branch L_h_head
L_h_ord:
    s_bfe_u32 s28, s20, 0x10001
    s_lshl1_add_u32 s28, s27, s28
    s_add_u32 s28, s28, s26
    s_and_b32 s28, s28, 7
    s_add_u32 s28, s28, 3
    s_lshr_b32 s29, s20, 2
    s_xor_b32 s29, s29, s20
    s_xor_b32 s29, s29, s28
    s_and_b32 s29, s29, s23
    s_cselect_b32 s28, 10, s28
    s_sub_u32 s29, s28, 2
    s_max_i32 s29, s29, 1
    s_cmp_ge_u32 s28, 10
    s_cselect_b32 s29, s28, s29
    s_lshl_b32 s33, s29, 2
    s_sub_u32 s29, s28, s29
    s_lshl_b32 s72, s29, 2
    s_bfm_b64 s[70:71], s72, 4
    s_and_b32 s70, s70, 0x11111111
    s_sub_u32 s72, s29, s70
    s_subb_u32 s73, 0, 0
    s_lshl_b64 s[72:73], s[72:73], s33
    s_add_u32 s70, s72, 0x76543210
    s_addc_u32 s71, s73, 0xa98
    s_lshr_b64 s[70:71], s[70:71], 4
    s_branch L_h_tail
L_cons:
    s_setprio 1
    s_lshl_b32 s58, s24, 2
    s_add_u32 s58, s58, s25
    s_lshl_b32 s28, s23, 5
    s_add_u32 s59, s28, s58
    v_lshrrev_b32 v65, 5, v0
    v_and_b32 v64, 31, v0
    v_lshlrev_b32 v1, 4, v0
    s_mov_b32 s34, 47104
    s_waitcnt lgkmcnt(0)
    s_cmp_lg_u32 s23, 0
    s_cbranch_scc1 L_nogw
    s_lshl_b32 s30, s25, 11
    s_add_u32 s30, s30, 141312
    s_mul_i32 s28, s58, 800
    s_mov_b32 s16, s40
    s_mov_b32 s17, s41
    s_add_u32 s18, s28, 800
    s_mov_b32 m0, s30
    v_add_u32 v57, s28, v1
    buffer_load_dwordx4 v57, s[16:19], 0 offen lds
    buffer_load_dwordx4 v57, s[16:19], 0 offen offset:1024 lds
    s_cmp_lg_u32 s25, 2
    s_cbranch_scc1 L_nogw
    s_mov_b32 s16, s48
    s_mov_b32 s17, s49
    s_mov_b32 m0, 154560
    s_mov_b32 s18, 1280
    buffer_load_dwordx4 v1, s[16:19], 0 offen lds
    buffer_load_dwordx4 v1, s[16:19], 0 offen offset:1024 lds
L_nogw:
    s_lshl2_add_u32 s56, s56, s26
    s_lshl2_add_u32 s57, s57, s27
    s_mov_b32 s14, 0x10000000
    s_mov_b32 s12, s54
    s_mov_b32 s13, s55
    s_cmp_lg_u32 s25, 1
    s_cbranch_scc1 L_nohv
    v_lshrrev_b32 v44, 4, v0
    v_bfe_u32 v42, v0, 2, 2
    v_and_b32 v41, 3, v0
    v_lshlrev_b32 v41, 3, v41
    v_add_u32 v41, 0, v41
    v_lshrrev_b32 v43, 5, v0
    v_mul_u32_u24 v43, 20, v43
    v_bfe_u32 v38, v0, 4, 1
    v_lshl_add_u32 v43, v38, 2, v43
    v_add_u32 v43, v43, v42
    v_mov_b32 v39, 160
    v_mad_u32_u24 v40, v43, v39, v41
    v_mad_u32_u24 v43, v44, 20, v42
    v_add_u32 v43, 16, v43
    v_mad_u32_u24 v41, v43, v39, v41
    v_and_b32 v36, 7, v0
    v_lshlrev_b32 v37, 7, v0
    v_bfe_u32 v38, v0, 3, 1
    v_lshlrev_b32 v43, 4, v36
    v_lshl_add_u32 v42, v38, 10, v43
    v_bfe_u32 v39, v0, 4, 1
    v_lshl_add_u32 v42, v39, 9, v42
    v_lshrrev_b32 v39, 5, v0
    v_mul_u32_u24 v39, 2560, v39
    v_add_u32 v42, v42, v39
    v_lshrrev_b32 v39, 4, v0
    v_lshl_add_u32 v39, v38, 2, v39
    v_mul_u32_u24 v39, 2560, v39
    v_add_u32 v43, v43, v39
    v_lshl_add_u32 v36, v38, 5, v36
    v_lshlrev_b32 v45, 2, v36
    v_mul_u32_u24 v36, 26, v0
    v_lshrrev_b32 v36, 8, v36
    v_mul_u32_u24 v36, 1120, v36
    v_add_u32 v36, v36, v1
    v_min_u32 v38, 49, v0
    v_mul_u32_u24 v39, 52, v38
    v_lshrrev_b32 v39, 8, v39
    v_mul_u32_u24 v39, 640, v39
    v_lshl_add_u32 v38, v38, 7, v39
    v_mov_b32 v39, v45
    v_add_u32 v44, 156608, v1
    ds_write_b128 v44, v[36:39]
    ds_write_b128 v44, v[40:43] offset:1024
L_nohv:
    s_lshl_b32 s28, s25, 8
    s_or_b32 s33, s28, s2
    s_sub_u32 s33, s33, 1002
    s_cmp_ge_u32 s33, 22
    s_cbranch_scc1 L_noinit
    v_mov_b32 v60, 0
    v_mov_b32 v61, 0
    v_mov_b32 v62, 0
    v_mov_b32 v63, 0
    s_lshl_b32 s28, s33, 13
    s_add_u32 s29, s28, 4096
    buffer_store_dwordx4 v[60:63], v1, s[12:15], s28 offen offset:0 sc1
    buffer_store_dwordx4 v[60:63], v1, s[12:15], s28 offen offset:1024 sc1
    buffer_store_dwordx4 v[60:63], v1, s[12:15], s28 offen offset:2048 sc1
    buffer_store_dwordx4 v[60:63], v1, s[12:15], s28 offen offset:3072 sc1
    buffer_store_dwordx4 v[60:63], v1, s[12:15], s29 offen offset:0 sc1
    buffer_store_dwordx4 v[60:63], v1, s[12:15], s29 offen offset:1024 sc1
    buffer_store_dwordx4 v[60:63], v1, s[12:15], s29 offen offset:2048 sc1
    buffer_store_dwordx4 v[60:63], v1, s[12:15], s29 offen offset:3072 sc1
L_noinit:
    s_mov_b32 s60, -1
    s_mov_b32 s61, 0
    v_bfrev_b32 v71, 1
    v_cndmask_b32 v2, v71, v1, s[60:61]
    s_mul_i32 s28, s25, 2560
    s_add_u32 s62, s28, 153536
    v_mul_u32_u24 v3, 48, v64
    v_add_u32 v3, s62, v3
    v_lshlrev_b32 v66, 3, v65
    v_sub_u32 v4, v3, v66
    v_add_u32 v4, 40, v4
    v_lshl_add_u32 v3, v65, 4, v3
    v_bfe_u32 v69, v0, 2, 2
    v_lshl_add_u32 v69, v65, 2, v69
    v_bfe_u32 v70, v0, 4, 1
    v_and_b32 v66, 3, v0
    v_lshl_add_u32 v70, v70, 2, v66
    v_min_u32 v66, 5, v70
    v_lshlrev_b32 v66, 3, v66
    v_mul_u32_u24 v5, 48, v69
    v_add3_u32 v5, v5, v66, s62
    v_mov_b32 v15, 0x3f803f80
    v_and_b32 v72, 15, v0
    v_lshlrev_b32 v72, 2, v72
    v_add_u32 v72, 163776, v72
    v_mov_b32 v74, 0
    ds_write_b32 v72, v74
    v_and_b32 v72, 15, v0
    v_lshrrev_b32 v73, 4, v0
    v_bfe_u32 v66, v0, 1, 3
    v_xor_b32 v66, v66, v73
    v_lshlrev_b32 v66, 4, v66
    v_lshl_add_u32 v8, v72, 7, v66
    v_xor_b32 v9, 64, v8
    v_bfe_u32 v66, v0, 2, 2
    v_lshlrev_b32 v66, 1, v66
    v_bfe_u32 v67, v0, 4, 1
    v_add_u32 v66, v66, v67
    v_lshl_add_u32 v66, v65, 4, v66
    v_mul_u32_u24 v66, 480, v66
    s_mul_i32 s28, s25, 40
    s_add_u32 s28, s28, 16384
    v_add_u32 v66, s28, v66
    v_and_b32 v68, 3, v0
    v_lshl_add_u32 v10, v68, 3, v66
    v_and_b32 v67, 1, v68
    v_lshrrev_b32 v68, 1, v68
    v_add_u32 v68, 1, v68
    v_mul_u32_u24 v68, v68, v67
    v_mul_u32_u24 v68, 160, v68
    v_add3_u32 v11, v68, v66, 32
    s_lshl_b32 s29, s22, 7
    s_add_u32 s28, s59, s29
    s_mul_i32 s28, s28, 2560
    s_add_u32 s76, s28, 7143424
    s_add_u32 s77, s76, 163840
    s_lshl3_add_u32 s28, s23, s24
    s_lshl_b32 s28, s28, 7
    s_lshl_b32 s29, s22, 11
    s_add_u32 s28, s28, s29
    s_add_u32 s78, s28, 16384
    s_cmp_lt_u32 s33, 22
    s_cselect_b32 s35, 0, 20
    s_mov_b32 s79, 0
    s_bitset1_b32 s79, s35
    v_mov_b32 v76, 0
    v_mov_b32 v77, 0
    v_mov_b32 v78, 0
    v_mov_b32 v79, 0
    s_nop 1
    v_mfma_f32_32x32x16_bf16 v[128:143], v[76:79], v[76:79], 0
    v_mfma_f32_32x32x16_bf16 v[144:159], v[76:79], v[76:79], 0
    v_mfma_f32_32x32x16_bf16 v[160:175], v[76:79], v[76:79], 0
    v_mfma_f32_32x32x16_bf16 v[176:191], v[76:79], v[76:79], 0
    v_mfma_f32_32x32x16_bf16 v[192:207], v[76:79], v[76:79], 0
    v_mfma_f32_32x32x16_bf16 v[208:223], v[76:79], v[76:79], 0
    v_mfma_f32_32x32x16_bf16 v[224:239], v[76:79], v[76:79], 0
    v_mfma_f32_32x32x16_bf16 v[240:255], v[76:79], v[76:79], 0
    s_mov_b32 s27, 65536
    s_mov_b32 s8, s52
    s_mov_b32 s9, s53
    s_mov_b32 s10, 256
    s_mov_b32 s31, 0
    s_mov_b32 s32, 0
    s_cmp_eq_u32 s23, 0
    s_cbranch_scc1 L_preA
    v_lshlrev_b32 v66, 2, v65
    v_sub_u32 v66, v64, v66
    v_mov_b32 v67, 0xff800000
    v_subrev_u32 v16, 0, v66
    v_and_b32 v16, v67, v16
    v_subrev_u32 v17, 1, v66
    v_and_b32 v17, v67, v17
    v_subrev_u32 v18, 2, v66
    v_and_b32 v18, v67, v18
    v_subrev_u32 v19, 3, v66
    v_and_b32 v19, v67, v19
    v_subrev_u32 v20, 8, v66
    v_and_b32 v20, v67, v20
    v_subrev_u32 v21, 9, v66
    v_and_b32 v21, v67, v21
    v_subrev_u32 v22, 10, v66
    v_and_b32 v22, v67, v22
    v_subrev_u32 v23, 11, v66
    v_and_b32 v23, v67, v23
    v_subrev_u32 v24, 16, v66
    v_and_b32 v24, v67, v24
    v_subrev_u32 v25, 17, v66
    v_and_b32 v25, v67, v25
    v_subrev_u32 v26, 18, v66
    v_and_b32 v26, v67, v26
    v_subrev_u32 v27, 19, v66
    v_and_b32 v27, v67, v27
    v_subrev_u32 v28, 24, v66
    v_and_b32 v28, v67, v28
    v_subrev_u32 v29, 25, v66
    v_and_b32 v29, v67, v29
    v_subrev_u32 v30, 26, v66
    v_and_b32 v30, v67, v30
    v_subrev_u32 v31, 27, v66
    v_and_b32 v31, v67, v31
    v_bfe_u32 v66, v0, 4, 1
    v_mov_b32 v14, 0x3ea52b5c
    v_cndmask_b32 v14, 0, v14, s[60:61]
    v_cmp_eq_u32 vcc, 1, v66
    s_mov_b32 s64, 0x3ea52b5c
    s_mov_b32 s65, 0x3ea52b5c
    v_cndmask_b32_e64 v14, v14, 1.0, vcc
    v_min_u32 v6, 23, v64
    v_mad_u32_u24 v6, v65, 24, v6
    v_cmp_ge_u32 vcc, 23, v64
    v_lshlrev_b32 v6, 4, v6
    s_lshl_b32 s28, s58, 4
    v_cndmask_b32 v7, v71, v6, vcc
    s_add_u32 s28, s28, s22
    s_mul_i32 s66, s28, 11264
    s_add_u32 s66, s66, 1343488
    s_add_u32 s67, s66, 4096
    s_add_u32 s68, s66, 5120
    s_add_u32 s69, s66, 8192
    s_sub_u32 s36, s66, 11264
    s_cmp_ge_u32 s22, 2
    s_cselect_b32 s37, 11264, 0
    s_movk_i32 s39, 128
    s_cselect_b32 s39, 256, s39
    s_lshl_b32 s28, s58, 11
    s_lshl_b32 s29, s22, 7
    s_add_u32 s28, s28, s29
    s_add_u32 s63, s28, 49152
    s_sub_u32 s38, s63, 128
    s_sub_u32 s39, s63, s39
    s_waitcnt lgkmcnt(0)
    s_barrier
    ds_read_b128 v[32:35], v8 offset:0
    ds_read_b64_tr_b16 v[96:97], v10 offset:0
    ds_read_b64_tr_b16 v[98:99], v10 offset:3840
    ds_read_b64_tr_b16 v[100:101], v10 offset:160
    ds_read_b64_tr_b16 v[102:103], v10 offset:4000
    ds_read_b64_tr_b16 v[104:105], v10 offset:320
    ds_read_b64_tr_b16 v[106:107], v10 offset:4160
    ds_read_b64_tr_b16 v[108:109], v11 offset:0
    ds_read_b64_tr_b16 v[110:111], v11 offset:3840
    ds_read_b128 v[36:39], v8 offset:2048
    ds_read_b128 v[40:43], v8 offset:4096
    ds_read_b128 v[44:47], v8 offset:6144
    ds_read_b128 v[48:51], v8 offset:8192
    ds_read_b128 v[52:55], v8 offset:10240
    ds_read_b128 v[56:59], v8 offset:12288
    ds_read_b128 v[60:63], v8 offset:14336
L_loopB:
    s_waitcnt lgkmcnt(0)
    v_mfma_f32_16x16x32_bf16 v[128:131], v[96:99], v[32:35], v[128:131]
    ds_read_b128 v[64:67], v9 offset:0
    v_mfma_f32_16x16x32_bf16 v[160:163], v[100:103], v[32:35], v[160:163]
    ds_read_b64_tr_b16 v[112:113], v10 offset:15360
    v_mfma_f32_16x16x32_bf16 v[192:195], v[104:107], v[32:35], v[192:195]
    ds_read_b64_tr_b16 v[114:115], v10 offset:19200
    v_mfma_f32_16x16x32_bf16 v[224:227], v[108:111], v[32:35], v[224:227]
    ds_read_b64_tr_b16 v[116:117], v10 offset:15520
    v_mfma_f32_16x16x32_bf16 v[228:231], v[108:111], v[36:39], v[228:231]
    ds_read_b64_tr_b16 v[118:119], v10 offset:19360
    v_mfma_f32_16x16x32_bf16 v[196:199], v[104:107], v[36:39], v[196:199]
    ds_read_b64_tr_b16 v[120:121], v10 offset:15680
    v_mfma_f32_16x16x32_bf16 v[164:167], v[100:103], v[36:39], v[164:167]
    ds_read_b64_tr_b16 v[122:123], v10 offset:19520
    v_mfma_f32_16x16x32_bf16 v[132:135], v[96:99], v[36:39], v[132:135]
    ds_read_b64_tr_b16 v[124:125], v11 offset:15360
    v_mfma_f32_16x16x32_bf16 v[136:139], v[96:99], v[40:43], v[136:139]
    ds_read_b64_tr_b16 v[126:127], v11 offset:19200
    v_mfma_f32_16x16x32_bf16 v[168:171], v[100:103], v[40:43], v[168:171]
    ds_read_b128 v[68:71], v9 offset:2048
    v_mfma_f32_16x16x32_bf16 v[200:203], v[104:107], v[40:43], v[200:203]
    ds_read_b128 v[72:75], v9 offset:4096
    v_mfma_f32_16x16x32_bf16 v[232:235], v[108:111], v[40:43], v[232:235]
    ds_read_b128 v[76:79], v9 offset:6144
    v_mfma_f32_16x16x32_bf16 v[236:239], v[108:111], v[44:47], v[236:239]
    ds_read_b128 v[80:83], v9 offset:8192
    v_mfma_f32_16x16x32_bf16 v[204:207], v[104:107], v[44:47], v[204:207]
    ds_read_b128 v[84:87], v9 offset:10240
    v_mfma_f32_16x16x32_bf16 v[172:175], v[100:103], v[44:47], v[172:175]
    ds_read_b128 v[88:91], v9 offset:12288
    v_mfma_f32_16x16x32_bf16 v[140:143], v[96:99], v[44:47], v[140:143]
    ds_read_b128 v[92:95], v9 offset:14336
    v_mfma_f32_16x16x32_bf16 v[144:147], v[96:99], v[48:51], v[144:147]
    v_mfma_f32_16x16x32_bf16 v[176:179], v[100:103], v[48:51], v[176:179]
    v_mfma_f32_16x16x32_bf16 v[208:211], v[104:107], v[48:51], v[208:211]
    v_mfma_f32_16x16x32_bf16 v[240:243], v[108:111], v[48:51], v[240:243]
    v_mfma_f32_16x16x32_bf16 v[244:247], v[108:111], v[52:55], v[244:247]
    s_bitcmp1_b32 s79, s31
    s_cbranch_scc1 L_side
L_backB:
    v_mfma_f32_16x16x32_bf16 v[212:215], v[104:107], v[52:55], v[212:215]
    v_mfma_f32_16x16x32_bf16 v[180:183], v[100:103], v[52:55], v[180:183]
    v_mfma_f32_16x16x32_bf16 v[148:151], v[96:99], v[52:55], v[148:151]
    v_mfma_f32_16x16x32_bf16 v[152:155], v[96:99], v[56:59], v[152:155]
    v_mfma_f32_16x16x32_bf16 v[184:187], v[100:103], v[56:59], v[184:187]
    v_mfma_f32_16x16x32_bf16 v[216:219], v[104:107], v[56:59], v[216:219]
    v_mfma_f32_16x16x32_bf16 v[248:251], v[108:111], v[56:59], v[248:251]
    v_mfma_f32_16x16x32_bf16 v[252:255], v[108:111], v[60:63], v[252:255]
    v_mfma_f32_16x16x32_bf16 v[220:223], v[104:107], v[60:63], v[220:223]
    v_mfma_f32_16x16x32_bf16 v[188:191], v[100:103], v[60:63], v[188:191]
    v_mfma_f32_16x16x32_bf16 v[156:159], v[96:99], v[60:63], v[156:159]
    s_waitcnt lgkmcnt(0)
    v_mfma_f32_16x16x32_bf16 v[128:131], v[112:115], v[64:67], v[128:131]
    s_add_u32 s32, s32, 1
    s_cmp_eq_u32 s32, 3
    v_mfma_f32_16x16x32_bf16 v[160:163], v[116:119], v[64:67], v[160:163]
    s_cselect_b32 s33, 4294873088, s34
    s_cselect_b32 s32, 0, s32
    v_mfma_f32_16x16x32_bf16 v[192:195], v[120:123], v[64:67], v[192:195]
    v_add_u32 v8, s33, v8
    v_mfma_f32_16x16x32_bf16 v[224:227], v[124:127], v[64:67], v[224:227]
    v_add_u32 v9, s33, v9
    v_mfma_f32_16x16x32_bf16 v[228:231], v[124:127], v[68:71], v[228:231]
    v_add_u32 v10, s33, v10
    v_mfma_f32_16x16x32_bf16 v[196:199], v[120:123], v[68:71], v[196:199]
    v_add_u32 v11, s33, v11
    v_mfma_f32_16x16x32_bf16 v[164:167], v[116:119], v[68:71], v[164:167]
    s_barrier
    ds_read_b128 v[32:35], v8 offset:0
    v_mfma_f32_16x16x32_bf16 v[132:135], v[112:115], v[68:71], v[132:135]
    ds_read_b64_tr_b16 v[96:97], v10 offset:0
    v_mfma_f32_16x16x32_bf16 v[136:139], v[112:115], v[72:75], v[136:139]
    ds_read_b64_tr_b16 v[98:99], v10 offset:3840
    v_mfma_f32_16x16x32_bf16 v[168:171], v[116:119], v[72:75], v[168:171]
    ds_read_b64_tr_b16 v[100:101], v10 offset:160
    v_mfma_f32_16x16x32_bf16 v[200:203], v[120:123], v[72:75], v[200:203]
    ds_read_b64_tr_b16 v[102:103], v10 offset:4000
    v_mfma_f32_16x16x32_bf16 v[232:235], v[124:127], v[72:75], v[232:235]
    ds_read_b64_tr_b16 v[104:105], v10 offset:320
    v_mfma_f32_16x16x32_bf16 v[236:239], v[124:127], v[76:79], v[236:239]
    ds_read_b64_tr_b16 v[106:107], v10 offset:4160
    v_mfma_f32_16x16x32_bf16 v[204:207], v[120:123], v[76:79], v[204:207]
    ds_read_b64_tr_b16 v[108:109], v11 offset:0
    v_mfma_f32_16x16x32_bf16 v[172:175], v[116:119], v[76:79], v[172:175]
    ds_read_b64_tr_b16 v[110:111], v11 offset:3840
    v_mfma_f32_16x16x32_bf16 v[140:143], v[112:115], v[76:79], v[140:143]
    ds_read_b128 v[36:39], v8 offset:2048
    v_mfma_f32_16x16x32_bf16 v[144:147], v[112:115], v[80:83], v[144:147]
    ds_read_b128 v[40:43], v8 offset:4096
    v_mfma_f32_16x16x32_bf16 v[176:179], v[116:119], v[80:83], v[176:179]
    ds_read_b128 v[44:47], v8 offset:6144
    v_mfma_f32_16x16x32_bf16 v[208:211], v[120:123], v[80:83], v[208:211]
    ds_read_b128 v[48:51], v8 offset:8192
    v_mfma_f32_16x16x32_bf16 v[240:243], v[124:127], v[80:83], v[240:243]
    ds_read_b128 v[52:55], v8 offset:10240
    v_mfma_f32_16x16x32_bf16 v[244:247], v[124:127], v[84:87], v[244:247]
    ds_read_b128 v[56:59], v8 offset:12288
    v_mfma_f32_16x16x32_bf16 v[212:215], v[120:123], v[84:87], v[212:215]
    ds_read_b128 v[60:63], v8 offset:14336
    v_mfma_f32_16x16x32_bf16 v[180:183], v[116:119], v[84:87], v[180:183]
    v_mfma_f32_16x16x32_bf16 v[148:151], v[112:115], v[84:87], v[148:151]
    v_mfma_f32_16x16x32_bf16 v[152:155], v[112:115], v[88:91], v[152:155]
    v_mfma_f32_16x16x32_bf16 v[184:187], v[116:119], v[88:91], v[184:187]
    v_mfma_f32_16x16x32_bf16 v[216:219], v[120:123], v[88:91], v[216:219]
    v_mfma_f32_16x16x32_bf16 v[248:251], v[124:127], v[88:91], v[248:251]
    v_mfma_f32_16x16x32_bf16 v[252:255], v[124:127], v[92:95], v[252:255]
    v_mfma_f32_16x16x32_bf16 v[220:223], v[120:123], v[92:95], v[220:223]
    s_add_u32 s31, s31, 1
    s_cmp_lt_u32 s31, 9
    v_mfma_f32_16x16x32_bf16 v[188:191], v[116:119], v[92:95], v[188:191]
    v_mfma_f32_16x16x32_bf16 v[156:159], v[112:115], v[92:95], v[156:159]
    s_cbranch_scc1 L_loopB
    s_waitcnt lgkmcnt(0)
    v_mfma_f32_16x16x32_bf16 v[128:131], v[96:99], v[32:35], v[128:131]
    ds_read_b128 v[64:67], v9 offset:0
    v_mfma_f32_16x16x32_bf16 v[160:163], v[100:103], v[32:35], v[160:163]
    ds_read_b128 v[68:71], v9 offset:2048
    v_mfma_f32_16x16x32_bf16 v[192:195], v[104:107], v[32:35], v[192:195]
    ds_read_b128 v[72:75], v9 offset:4096
    v_mfma_f32_16x16x32_bf16 v[224:227], v[108:111], v[32:35], v[224:227]
    ds_read_b128 v[76:79], v9 offset:6144
    v_mfma_f32_16x16x32_bf16 v[228:231], v[108:111], v[36:39], v[228:231]
    ds_read_b128 v[80:83], v9 offset:8192
    v_mfma_f32_16x16x32_bf16 v[196:199], v[104:107], v[36:39], v[196:199]
    ds_read_b128 v[84:87], v9 offset:10240
    v_mfma_f32_16x16x32_bf16 v[164:167], v[100:103], v[36:39], v[164:167]
    ds_read_b128 v[88:91], v9 offset:12288
    v_mfma_f32_16x16x32_bf16 v[132:135], v[96:99], v[36:39], v[132:135]
    ds_read_b128 v[92:95], v9 offset:14336
    v_mfma_f32_16x16x32_bf16 v[136:139], v[96:99], v[40:43], v[136:139]
    v_mfma_f32_16x16x32_bf16 v[168:171], v[100:103], v[40:43], v[168:171]
    v_bfrev_b32 v12, 1
    v_mfma_f32_16x16x32_bf16 v[200:203], v[104:107], v[40:43], v[200:203]
    v_writelane_b32 v12, s63, 0
    v_mfma_f32_16x16x32_bf16 v[232:235], v[108:111], v[40:43], v[232:235]
    v_bfrev_b32 v8, 1
    v_mfma_f32_16x16x32_bf16 v[236:239], v[108:111], v[44:47], v[236:239]
    v_writelane_b32 v8, s38, 0
    v_mfma_f32_16x16x32_bf16 v[204:207], v[104:107], v[44:47], v[204:207]
    v_writelane_b32 v8, s39, 1
    v_mfma_f32_16x16x32_bf16 v[172:175], v[100:103], v[44:47], v[172:175]
    v_mov_b32 v9, 163776
    v_mfma_f32_16x16x32_bf16 v[140:143], v[96:99], v[44:47], v[140:143]
    s_nop 0
    v_mfma_f32_16x16x32_bf16 v[144:147], v[96:99], v[48:51], v[144:147]
    s_barrier
    ds_read_b64_tr_b16 v[112:113], v10 offset:15360
    v_mfma_f32_16x16x32_bf16 v[176:179], v[100:103], v[48:51], v[176:179]
    ds_read_b64_tr_b16 v[114:115], v10 offset:19200
    v_mfma_f32_16x16x32_bf16 v[208:211], v[104:107], v[48:51], v[208:211]
    ds_read_b64_tr_b16 v[116:117], v10 offset:15520
    v_mfma_f32_16x16x32_bf16 v[240:243], v[108:111], v[48:51], v[240:243]
    ds_read_b64_tr_b16 v[118:119], v10 offset:19360
    v_mfma_f32_16x16x32_bf16 v[244:247], v[108:111], v[52:55], v[244:247]
    ds_read_b64_tr_b16 v[120:121], v10 offset:15680
    v_mfma_f32_16x16x32_bf16 v[212:215], v[104:107], v[52:55], v[212:215]
    ds_read_b64_tr_b16 v[122:123], v10 offset:19520
    v_mfma_f32_16x16x32_bf16 v[180:183], v[100:103], v[52:55], v[180:183]
    ds_read_b64_tr_b16 v[124:125], v11 offset:15360
    v_mfma_f32_16x16x32_bf16 v[148:151], v[96:99], v[52:55], v[148:151]
    ds_read_b64_tr_b16 v[126:127], v11 offset:19200
    v_mfma_f32_16x16x32_bf16 v[152:155], v[96:99], v[56:59], v[152:155]
    v_mfma_f32_16x16x32_bf16 v[184:187], v[100:103], v[56:59], v[184:187]
    v_and_b32 v11, 0x1f0, v1
    v_mfma_f32_16x16x32_bf16 v[216:219], v[104:107], v[56:59], v[216:219]
    v_mov_b32 v10, 0
    v_mfma_f32_16x16x32_bf16 v[248:251], v[108:111], v[56:59], v[248:251]
    s_nop 0
    v_mfma_f32_16x16x32_bf16 v[252:255], v[108:111], v[60:63], v[252:255]
    s_nop 0
    v_mfma_f32_16x16x32_bf16 v[220:223], v[104:107], v[60:63], v[220:223]
    v_mov_b32 v58, 0
    v_mfma_f32_16x16x32_bf16 v[188:191], v[100:103], v[60:63], v[188:191]
    v_mov_b32 v59, 0
    v_mfma_f32_16x16x32_bf16 v[156:159], v[96:99], v[60:63], v[156:159]
    s_waitcnt vmcnt(0) lgkmcnt(0)
    s_barrier
    v_mfma_f32_16x16x32_bf16 v[220:223], v[120:123], v[92:95], v[220:223]
    v_mov_b32 v13, 1
    v_mfma_f32_16x16x32_bf16 v[216:219], v[120:123], v[88:91], v[216:219]
    v_mfma_f32_16x16x32_bf16 v[252:255], v[124:127], v[92:95], v[252:255]
    v_mfma_f32_16x16x32_bf16 v[248:251], v[124:127], v[88:91], v[248:251]
    v_mfma_f32_16x16x32_bf16 v[224:227], v[124:127], v[64:67], v[224:227]
    v_mfma_f32_16x16x32_bf16 v[192:195], v[120:123], v[64:67], v[192:195]
    s_nop 1
    v_cvt_pk_bf16_f32 v106, v220, v221
    v_cvt_pk_bf16_f32 v107, v222, v223
    v_cvt_pk_bf16_f32 v104, v216, v217
    v_cvt_pk_bf16_f32 v105, v218, v219
    v_mul_f32 v248, v14, v248
    v_permlane16_swap_b32 v104, v106
    v_permlane16_swap_b32 v105, v107
    ds_write_b128 v3, v[104:107]
    v_mul_f32 v249, v14, v249
    v_mul_f32 v250, v14, v250
    v_mul_f32 v251, v14, v251
    v_mul_f32 v252, v14, v252
    v_mul_f32 v253, v14, v253
    v_mul_f32 v254, v14, v254
    v_mul_f32 v255, v14, v255
    v_mfma_f32_16x16x32_bf16 v[160:163], v[116:119], v[64:67], v[160:163]
    v_cvt_pk_bf16_f32 v54, v252, v253
    v_mfma_f32_16x16x32_bf16 v[128:131], v[112:115], v[64:67], v[128:131]
    v_cvt_pk_bf16_f32 v66, v248, v249
    v_cvt_pk_bf16_f32 v67, v250, v251
    v_cvt_pk_bf16_f32 v55, v254, v255
    v_permlane16_swap_b32 v66, v54
    v_cndmask_b32 v110, v54, v15, s[60:61]
    v_permlane16_swap_b32 v67, v55
    v_cndmask_b32 v111, v55, v15, s[60:61]
    ds_write_b64 v4, v[110:111]
    v_mfma_f32_16x16x32_bf16 v[188:191], v[116:119], v[92:95], v[188:191]
    v_cvt_pk_bf16_f32 v32, v160, v161
    v_mfma_f32_16x16x32_bf16 v[184:187], v[116:119], v[88:91], v[184:187]
    v_cvt_pk_bf16_f32 v33, v162, v163
    v_mfma_f32_16x16x32_bf16 v[156:159], v[112:115], v[92:95], v[156:159]
    ds_read_b64_tr_b16 v[92:93], v5 offset:0
    ds_read_b64_tr_b16 v[94:95], v5 offset:384
    ds_read_b64_tr_b16 v[96:97], v5 offset:768
    v_mfma_f32_16x16x32_bf16 v[212:215], v[120:123], v[84:87], v[212:215]
    v_cvt_pk_bf16_f32 v46, v188, v189
    v_cvt_pk_bf16_f32 v47, v190, v191
    v_cvt_pk_bf16_f32 v44, v184, v185
    v_cvt_pk_bf16_f32 v45, v186, v187
    ds_read_b64_tr_b16 v[98:99], v5 offset:1152
    v_permlane16_swap_b32 v44, v46
    v_permlane16_swap_b32 v45, v47
    buffer_store_dwordx4 v[44:47], v1, s[12:15], s66 offen offset:3072 sc1
    v_mfma_f32_16x16x32_bf16 v[208:211], v[120:123], v[80:83], v[208:211]
    v_cvt_pk_bf16_f32 v102, v212, v213
    v_cvt_pk_bf16_f32 v103, v214, v215
    v_mfma_f32_16x16x32_bf16 v[244:247], v[124:127], v[84:87], v[244:247]
    v_mov_b32 v64, 0
    v_mov_b32 v65, 0
    v_mfma_f32_16x16x32_bf16 v[240:243], v[124:127], v[80:83], v[240:243]
    s_nop 1
    v_cvt_pk_bf16_f32 v100, v208, v209
    s_waitcnt lgkmcnt(2)
    buffer_store_dwordx4 v[92:95], v7, s[12:15], s69 offen offset:1536 sc1
    v_cvt_pk_bf16_f32 v101, v210, v211
    v_permlane16_swap_b32 v100, v102
    v_mfma_f32_16x16x32_bf16 v[180:183], v[116:119], v[84:87], v[180:183]
    v_permlane16_swap_b32 v101, v103
    ds_write_b128 v3, v[100:103]
    v_mfma_f32_16x16x32_bf16 v[176:179], v[116:119], v[80:83], v[176:179]
    v_mul_f32 v240, v14, v240
    v_mul_f32 v241, v14, v241
    v_mul_f32 v242, v14, v242
    s_waitcnt lgkmcnt(1)
    buffer_store_dwordx4 v[96:99], v7, s[12:15], s69 offen offset:2304 sc1
    v_mul_f32 v243, v14, v243
    v_mul_f32 v244, v14, v244
    v_mul_f32 v245, v14, v245
    v_mul_f32 v246, v14, v246
    v_mul_f32 v247, v14, v247
    v_cvt_pk_bf16_f32 v62, v240, v241
    v_cvt_pk_bf16_f32 v52, v244, v245
    v_cvt_pk_bf16_f32 v63, v242, v243
    v_cvt_pk_bf16_f32 v53, v246, v247
    v_permlane16_swap_b32 v62, v52
    v_cndmask_b32 v108, v52, v15, s[60:61]
    v_permlane16_swap_b32 v63, v53
    v_cndmask_b32 v109, v53, v15, s[60:61]
    ds_write_b64 v4, v[108:109]
    v_cvt_pk_bf16_f32 v40, v176, v177
    v_cvt_pk_bf16_f32 v42, v180, v181
    v_cvt_pk_bf16_f32 v41, v178, v179
    v_cvt_pk_bf16_f32 v43, v182, v183
    v_permlane16_swap_b32 v40, v42
    v_mfma_f32_16x16x32_bf16 v[148:151], v[112:115], v[84:87], v[148:151]
    v_permlane16_swap_b32 v41, v43
    buffer_store_dwordx4 v[40:43], v1, s[12:15], s66 offen offset:2048 sc1
    ds_read_b64_tr_b16 v[84:85], v5 offset:0
    ds_read_b64_tr_b16 v[86:87], v5 offset:384
    v_mfma_f32_16x16x32_bf16 v[204:207], v[120:123], v[76:79], v[204:207]
    v_cvt_pk_bf16_f32 v100, v192, v193
    v_mfma_f32_16x16x32_bf16 v[200:203], v[120:123], v[72:75], v[200:203]
    v_cvt_pk_bf16_f32 v101, v194, v195
    v_mfma_f32_16x16x32_bf16 v[152:155], v[112:115], v[88:91], v[152:155]
    ds_read_b64_tr_b16 v[88:89], v5 offset:768
    ds_read_b64_tr_b16 v[90:91], v5 offset:1152
    buffer_store_dwordx4 v[52:55], v2, s[12:15], s67 offen offset:512 sc1
    v_mfma_f32_16x16x32_bf16 v[236:239], v[124:127], v[76:79], v[236:239]
    v_cvt_pk_bf16_f32 v106, v204, v205
    v_cvt_pk_bf16_f32 v107, v206, v207
    v_cvt_pk_bf16_f32 v104, v200, v201
    v_cvt_pk_bf16_f32 v105, v202, v203
    v_mfma_f32_16x16x32_bf16 v[232:235], v[124:127], v[72:75], v[232:235]
    v_permlane16_swap_b32 v104, v106
    v_permlane16_swap_b32 v105, v107
    ds_write_b128 v3, v[104:107]
    s_waitcnt lgkmcnt(3)
    buffer_store_dwordx4 v[84:87], v7, s[12:15], s69 offen offset:0 sc1
    v_pk_mul_f32 v[236:237], v[236:237], v[14:15] op_sel_hi:[1,0]
    v_pk_mul_f32 v[238:239], v[238:239], v[14:15] op_sel_hi:[1,0]
    v_cvt_pk_bf16_f32 v50, v236, v237
    v_pk_mul_f32 v[232:233], v[232:233], v[14:15] op_sel_hi:[1,0]
    v_pk_mul_f32 v[234:235], v[234:235], v[14:15] op_sel_hi:[1,0]
    v_cvt_pk_bf16_f32 v60, v232, v233
    v_cvt_pk_bf16_f32 v61, v234, v235
    v_cvt_pk_bf16_f32 v51, v238, v239
    v_permlane16_swap_b32 v60, v50
    v_cndmask_b32 v110, v50, v15, s[60:61]
    v_permlane16_swap_b32 v61, v51
    v_cndmask_b32 v111, v51, v15, s[60:61]
    ds_write_b64 v4, v[110:111]
    s_waitcnt lgkmcnt(2)
    buffer_store_dwordx4 v[88:91], v7, s[12:15], s69 offen offset:768 sc1
    v_mfma_f32_16x16x32_bf16 v[172:175], v[116:119], v[76:79], v[172:175]
    v_mfma_f32_16x16x32_bf16 v[168:171], v[116:119], v[72:75], v[168:171]
    v_mfma_f32_16x16x32_bf16 v[140:143], v[112:115], v[76:79], v[140:143]
    ds_read_b64_tr_b16 v[76:77], v5 offset:0
    ds_read_b64_tr_b16 v[78:79], v5 offset:384
    v_mfma_f32_16x16x32_bf16 v[144:147], v[112:115], v[80:83], v[144:147]
    ds_read_b64_tr_b16 v[80:81], v5 offset:768
    ds_read_b64_tr_b16 v[82:83], v5 offset:1152
    v_mfma_f32_16x16x32_bf16 v[196:199], v[120:123], v[68:71], v[196:199]
    v_cvt_pk_bf16_f32 v38, v172, v173
    v_cvt_pk_bf16_f32 v36, v168, v169
    v_cvt_pk_bf16_f32 v37, v170, v171
    v_cvt_pk_bf16_f32 v39, v174, v175
    v_permlane16_swap_b32 v36, v38
    v_mfma_f32_16x16x32_bf16 v[228:231], v[124:127], v[68:71], v[228:231]
    v_permlane16_swap_b32 v37, v39
    buffer_store_dwordx4 v[36:39], v1, s[12:15], s66 offen offset:1024 sc1
    v_cvt_pk_bf16_f32 v102, v196, v197
    v_cvt_pk_bf16_f32 v103, v198, v199
    v_mfma_f32_16x16x32_bf16 v[164:167], v[116:119], v[68:71], v[164:167]
    v_permlane16_swap_b32 v100, v102
    v_permlane16_swap_b32 v101, v103
    ds_write_b128 v3, v[100:103]
    v_pk_mul_f32 v[224:225], v[224:225], v[14:15] op_sel_hi:[1,0]
    v_pk_mul_f32 v[226:227], v[226:227], v[14:15] op_sel_hi:[1,0]
    v_pk_mul_f32 v[228:229], v[228:229], v[14:15] op_sel_hi:[1,0]
    s_waitcnt lgkmcnt(3)
    buffer_store_dwordx4 v[76:79], v7, s[12:15], s68 offen offset:1536 sc1
    v_pk_mul_f32 v[230:231], v[230:231], v[14:15] op_sel_hi:[1,0]
    v_cvt_pk_bf16_f32 v56, v224, v225
    v_cvt_pk_bf16_f32 v48, v228, v229
    v_cvt_pk_bf16_f32 v57, v226, v227
    v_cvt_pk_bf16_f32 v49, v230, v231
    v_permlane16_swap_b32 v56, v48
    v_cndmask_b32 v108, v48, v15, s[60:61]
    v_permlane16_swap_b32 v57, v49
    v_cndmask_b32 v109, v49, v15, s[60:61]
    ds_write_b64 v4, v[108:109]
    s_waitcnt lgkmcnt(2)
    buffer_store_dwordx4 v[80:83], v7, s[12:15], s68 offen offset:2304 sc1
    v_cvt_pk_bf16_f32 v34, v164, v165
    v_cvt_pk_bf16_f32 v35, v166, v167
    v_mfma_f32_16x16x32_bf16 v[132:135], v[112:115], v[68:71], v[132:135]
    v_permlane16_swap_b32 v32, v34
    v_permlane16_swap_b32 v33, v35
    ds_read_b64_tr_b16 v[68:69], v5 offset:0
    ds_read_b64_tr_b16 v[70:71], v5 offset:384
    v_mfma_f32_16x16x32_bf16 v[136:139], v[112:115], v[72:75], v[136:139]
    ds_read_b64_tr_b16 v[72:73], v5 offset:768
    buffer_store_dwordx4 v[32:35], v1, s[12:15], s66 offen offset:0 sc1
    ds_read_b64_tr_b16 v[74:75], v5 offset:1152
    s_mov_b64 exec, 1
    ds_add_u32 v9, v13 offset:0
    s_mov_b64 exec, -1
    v_pk_mul_f32 v[152:153], v[152:153], s[64:65]
    v_pk_mul_f32 v[154:155], v[154:155], s[64:65]
    v_pk_mul_f32 v[156:157], v[156:157], s[64:65]
    v_pk_mul_f32 v[158:159], v[158:159], s[64:65]
    v_cvt_pk_bf16_f32 v124, v152, v153
    v_cvt_pk_bf16_f32 v126, v156, v157
    v_cvt_pk_bf16_f32 v125, v154, v155
    v_cvt_pk_bf16_f32 v127, v158, v159
    v_permlane16_swap_b32 v124, v126
    buffer_store_dwordx4 v[48:51], v2, s[12:15], s67 offen offset:0 sc1
    v_permlane16_swap_b32 v125, v127
    v_pk_mul_f32 v[144:145], v[144:145], s[64:65]
    v_pk_mul_f32 v[146:147], v[146:147], s[64:65]
    v_mfma_f32_32x32x16_bf16 v[176:191], v[44:47], v[124:127], v[16:31]
    v_cvt_pk_bf16_f32 v120, v144, v145
    v_cvt_pk_bf16_f32 v121, v146, v147
    v_mfma_f32_32x32x16_bf16 v[176:191], v[52:55], v[64:67], v[176:191]
    s_waitcnt lgkmcnt(3)
    buffer_store_dwordx4 v[68:71], v7, s[12:15], s68 offen offset:0 sc1
    s_waitcnt lgkmcnt(0)
    v_pk_mul_f32 v[148:149], v[148:149], s[64:65]
    v_pk_mul_f32 v[150:151], v[150:151], s[64:65]
    v_pk_mul_f32 v[136:137], v[136:137], s[64:65]
    v_pk_mul_f32 v[138:139], v[138:139], s[64:65]
    v_pk_mul_f32 v[140:141], v[140:141], s[64:65]
    v_pk_mul_f32 v[142:143], v[142:143], s[64:65]
    buffer_store_dwordx4 v[72:75], v7, s[12:15], s68 offen offset:768 sc1
    v_pk_mul_f32 v[128:129], v[128:129], s[64:65]
    v_pk_mul_f32 v[130:131], v[130:131], s[64:65]
    v_pk_mul_f32 v[132:133], v[132:133], s[64:65]
    v_pk_mul_f32 v[134:135], v[134:135], s[64:65]
    v_cvt_pk_bf16_f32 v122, v148, v149
    v_cvt_pk_bf16_f32 v123, v150, v151
    v_cvt_pk_bf16_f32 v116, v136, v137
    v_cvt_pk_bf16_f32 v118, v140, v141
    v_cvt_pk_bf16_f32 v117, v138, v139
    v_cvt_pk_bf16_f32 v119, v142, v143
    v_cvt_pk_bf16_f32 v112, v128, v129
    v_cvt_pk_bf16_f32 v114, v132, v133
    v_cvt_pk_bf16_f32 v113, v130, v131
    v_cvt_pk_bf16_f32 v115, v134, v135
    v_permlane16_swap_b32 v120, v122
    v_permlane16_swap_b32 v121, v123
    v_permlane16_swap_b32 v116, v118
    v_permlane16_swap_b32 v117, v119
    v_permlane16_swap_b32 v112, v114
    v_permlane16_swap_b32 v113, v115
    v_mfma_f32_32x32x16_bf16 v[160:175], v[40:43], v[120:123], v[16:31]
    v_exp_f32 v176, v176
    v_exp_f32 v177, v177
    v_exp_f32 v178, v178
    v_exp_f32 v179, v179
    v_cvt_pk_bf16_f32 v128, v176, v177
    v_cvt_pk_bf16_f32 v129, v178, v179
    v_mfma_f32_32x32x16_bf16 v[160:175], v[52:55], v[62:65], v[160:175]
    v_exp_f32 v180, v180
    v_exp_f32 v181, v181
    v_exp_f32 v182, v182
    v_exp_f32 v183, v183
    v_cvt_pk_bf16_f32 v130, v180, v181
    v_cvt_pk_bf16_f32 v131, v182, v183
    v_exp_f32 v184, v184
    v_exp_f32 v185, v185
    v_exp_f32 v186, v186
    v_exp_f32 v187, v187
    v_cvt_pk_bf16_f32 v132, v184, v185
    v_cvt_pk_bf16_f32 v133, v186, v187
    v_mfma_f32_32x32x16_bf16 v[240:255], v[92:95], v[128:131], 0
    s_waitcnt vmcnt(7)
    buffer_store_dword v13, v12, s[12:15], 0 offen sc1
    v_exp_f32 v188, v188
    v_exp_f32 v189, v189
    v_exp_f32 v190, v190
    v_exp_f32 v191, v191
    v_cvt_pk_bf16_f32 v134, v188, v189
    v_cvt_pk_bf16_f32 v135, v190, v191
    v_mfma_f32_32x32x16_bf16 v[176:191], v[40:43], v[124:127], 0
    v_exp_f32 v160, v160
    v_exp_f32 v161, v161
    v_exp_f32 v162, v162
    v_exp_f32 v163, v163
    v_cvt_pk_bf16_f32 v128, v160, v161
    v_cvt_pk_bf16_f32 v129, v162, v163
    v_mfma_f32_32x32x16_bf16 v[176:191], v[50:53], v[64:67], v[176:191]
    v_exp_f32 v164, v164
    v_exp_f32 v165, v165
    v_exp_f32 v166, v166
    v_exp_f32 v167, v167
    v_cvt_pk_bf16_f32 v130, v164, v165
    v_cvt_pk_bf16_f32 v131, v166, v167
    v_mfma_f32_32x32x16_bf16 v[240:255], v[96:99], v[132:135], v[240:255]
    v_exp_f32 v168, v168
    v_exp_f32 v169, v169
    v_exp_f32 v170, v170
    v_exp_f32 v171, v171
    v_cvt_pk_bf16_f32 v132, v168, v169
    v_cvt_pk_bf16_f32 v133, v170, v171
    v_mfma_f32_32x32x16_bf16 v[224:239], v[84:87], v[128:131], 0
    v_exp_f32 v172, v172
    v_exp_f32 v173, v173
    v_exp_f32 v174, v174
    v_exp_f32 v175, v175
    v_cvt_pk_bf16_f32 v134, v172, v173
    v_cvt_pk_bf16_f32 v135, v174, v175
    v_mfma_f32_32x32x16_bf16 v[160:175], v[36:39], v[116:119], v[16:31]
    v_exp_f32 v176, v176
    v_exp_f32 v177, v177
    v_exp_f32 v178, v178
    v_exp_f32 v179, v179
    v_cvt_pk_bf16_f32 v128, v176, v177
    v_cvt_pk_bf16_f32 v129, v178, v179
    v_mfma_f32_32x32x16_bf16 v[160:175], v[48:51], v[58:61], v[160:175]
    v_exp_f32 v180, v180
    v_exp_f32 v181, v181
    v_exp_f32 v182, v182
    v_exp_f32 v183, v183
    v_cvt_pk_bf16_f32 v130, v180, v181
    v_cvt_pk_bf16_f32 v131, v182, v183
    v_mfma_f32_32x32x16_bf16 v[224:239], v[88:91], v[132:135], v[224:239]
    v_exp_f32 v184, v184
    v_exp_f32 v185, v185
    v_exp_f32 v186, v186
    v_exp_f32 v187, v187
    v_cvt_pk_bf16_f32 v132, v184, v185
    v_cvt_pk_bf16_f32 v133, v186, v187
    v_mfma_f32_32x32x16_bf16 v[240:255], v[84:87], v[128:131], v[240:255]
    v_exp_f32 v188, v188
    v_exp_f32 v189, v189
    v_exp_f32 v190, v190
    v_exp_f32 v191, v191
    v_cvt_pk_bf16_f32 v134, v188, v189
    v_cvt_pk_bf16_f32 v135, v190, v191
    v_mfma_f32_32x32x16_bf16 v[176:191], v[36:39], v[120:123], 0
    v_exp_f32 v160, v160
    v_exp_f32 v161, v161
    v_exp_f32 v162, v162
    v_exp_f32 v163, v163
    v_cvt_pk_bf16_f32 v128, v160, v161
    v_cvt_pk_bf16_f32 v129, v162, v163
    v_mfma_f32_32x32x16_bf16 v[176:191], v[50:53], v[62:65], v[176:191]
    v_exp_f32 v164, v164
    v_exp_f32 v165, v165
    v_exp_f32 v166, v166
    v_exp_f32 v167, v167
    v_cvt_pk_bf16_f32 v130, v164, v165
    v_cvt_pk_bf16_f32 v131, v166, v167
    v_mfma_f32_32x32x16_bf16 v[240:255], v[88:91], v[132:135], v[240:255]
    v_exp_f32 v168, v168
    v_exp_f32 v169, v169
    v_exp_f32 v170, v170
    v_exp_f32 v171, v171
    v_cvt_pk_bf16_f32 v132, v168, v169
    v_cvt_pk_bf16_f32 v133, v170, v171
    v_mfma_f32_32x32x16_bf16 v[208:223], v[76:79], v[128:131], 0
    buffer_load_dword v9, v8, s[12:15], 0 offen sc1
    v_exp_f32 v172, v172
    v_exp_f32 v173, v173
    v_exp_f32 v174, v174
    v_exp_f32 v175, v175
    v_cvt_pk_bf16_f32 v134, v172, v173
    v_cvt_pk_bf16_f32 v135, v174, v175
    v_mfma_f32_32x32x16_bf16 v[160:175], v[36:39], v[124:127], 0
    v_exp_f32 v176, v176
    v_exp_f32 v177, v177
    v_exp_f32 v178, v178
    v_exp_f32 v179, v179
    v_cvt_pk_bf16_f32 v128, v176, v177
    v_cvt_pk_bf16_f32 v129, v178, v179
    v_mfma_f32_32x32x16_bf16 v[160:175], v[48:51], v[64:67], v[160:175]
    v_exp_f32 v180, v180
    v_exp_f32 v181, v181
    v_exp_f32 v182, v182
    v_exp_f32 v183, v183
    v_cvt_pk_bf16_f32 v130, v180, v181
    v_cvt_pk_bf16_f32 v131, v182, v183
    v_mfma_f32_32x32x16_bf16 v[208:223], v[80:83], v[132:135], v[208:223]
    s_waitcnt vmcnt(2)
    buffer_store_dword v13, v12, s[12:15], s27 offen sc1
    v_exp_f32 v184, v184
    v_exp_f32 v185, v185
    v_exp_f32 v186, v186
    v_exp_f32 v187, v187
    v_cvt_pk_bf16_f32 v132, v184, v185
    v_cvt_pk_bf16_f32 v133, v186, v187
    v_mfma_f32_32x32x16_bf16 v[224:239], v[76:79], v[128:131], v[224:239]
    v_exp_f32 v188, v188
    v_exp_f32 v189, v189
    v_exp_f32 v190, v190
    v_exp_f32 v191, v191
    v_cvt_pk_bf16_f32 v134, v188, v189
    v_cvt_pk_bf16_f32 v135, v190, v191
    v_mfma_f32_32x32x16_bf16 v[176:191], v[32:35], v[112:115], v[16:31]
    v_exp_f32 v160, v160
    v_exp_f32 v161, v161
    v_exp_f32 v162, v162
    v_exp_f32 v163, v163
    v_cvt_pk_bf16_f32 v128, v160, v161
    v_cvt_pk_bf16_f32 v129, v162, v163
    v_mfma_f32_32x32x16_bf16 v[176:191], v[48:51], v[56:59], v[176:191]
    v_exp_f32 v164, v164
    v_exp_f32 v165, v165
    v_exp_f32 v166, v166
    v_exp_f32 v167, v167
    v_cvt_pk_bf16_f32 v130, v164, v165
    v_cvt_pk_bf16_f32 v131, v166, v167
    v_mfma_f32_32x32x16_bf16 v[224:239], v[80:83], v[132:135], v[224:239]
    v_exp_f32 v168, v168
    v_exp_f32 v169, v169
    v_exp_f32 v170, v170
    v_exp_f32 v171, v171
    v_cvt_pk_bf16_f32 v132, v168, v169
    v_cvt_pk_bf16_f32 v133, v170, v171
    v_mfma_f32_32x32x16_bf16 v[240:255], v[76:79], v[128:131], v[240:255]
    v_exp_f32 v172, v172
    v_exp_f32 v173, v173
    v_exp_f32 v174, v174
    v_exp_f32 v175, v175
    v_cvt_pk_bf16_f32 v134, v172, v173
    v_cvt_pk_bf16_f32 v135, v174, v175
    v_mfma_f32_32x32x16_bf16 v[160:175], v[32:35], v[116:119], 0
    v_exp_f32 v176, v176
    v_exp_f32 v177, v177
    v_exp_f32 v178, v178
    v_exp_f32 v179, v179
    v_cvt_pk_bf16_f32 v128, v176, v177
    v_cvt_pk_bf16_f32 v129, v178, v179
    v_mfma_f32_32x32x16_bf16 v[160:175], v[46:49], v[58:61], v[160:175]
    v_exp_f32 v180, v180
    v_exp_f32 v181, v181
    v_exp_f32 v182, v182
    v_exp_f32 v183, v183
    v_cvt_pk_bf16_f32 v130, v180, v181
    v_cvt_pk_bf16_f32 v131, v182, v183
    v_mfma_f32_32x32x16_bf16 v[240:255], v[80:83], v[132:135], v[240:255]
    v_exp_f32 v184, v184
    v_exp_f32 v185, v185
    v_exp_f32 v186, v186
    v_exp_f32 v187, v187
    v_cvt_pk_bf16_f32 v132, v184, v185
    v_cvt_pk_bf16_f32 v133, v186, v187
    v_mfma_f32_32x32x16_bf16 v[192:207], v[68:71], v[128:131], 0
    s_waitcnt vmcnt(1)
    v_cmp_eq_u32 vcc, 0, v9
    s_cmp_eq_u32 s22, 0
    s_cselect_b32 s28, 1, vcc_lo
    s_and_b32 s79, s28, 1
    s_cbranch_scc1 L_B_skip
    s_mov_b32 s66, s36
    s_add_u32 s67, s36, 4096
    s_add_u32 s68, s36, 5120
    s_add_u32 s69, s36, 8192
    buffer_load_dwordx4 v[44:47], v1, s[12:15], s66 offen offset:3072 sc1
    buffer_load_dwordx4 v[52:55], v11, s[12:15], s67 offen offset:512 sc1
    buffer_load_dwordx4 v[92:95], v6, s[12:15], s69 offen offset:1536 sc1
    buffer_load_dwordx4 v[96:99], v6, s[12:15], s69 offen offset:2304 sc1
    buffer_load_dwordx4 v[40:43], v1, s[12:15], s66 offen offset:2048 sc1
    buffer_load_dwordx4 v[84:87], v6, s[12:15], s69 offen offset:0 sc1
    buffer_load_dwordx4 v[88:91], v6, s[12:15], s69 offen offset:768 sc1
L_B_skip:
    v_exp_f32 v188, v188
    v_exp_f32 v189, v189
    v_exp_f32 v190, v190
    v_exp_f32 v191, v191
    v_cvt_pk_bf16_f32 v134, v188, v189
    v_cvt_pk_bf16_f32 v135, v190, v191
    v_mfma_f32_32x32x16_bf16 v[176:191], v[32:35], v[120:123], 0
    v_exp_f32 v160, v160
    v_exp_f32 v161, v161
    v_exp_f32 v162, v162
    v_exp_f32 v163, v163
    v_cvt_pk_bf16_f32 v128, v160, v161
    v_cvt_pk_bf16_f32 v129, v162, v163
    v_mfma_f32_32x32x16_bf16 v[176:191], v[48:51], v[62:65], v[176:191]
    v_exp_f32 v164, v164
    v_exp_f32 v165, v165
    v_exp_f32 v166, v166
    v_exp_f32 v167, v167
    v_cvt_pk_bf16_f32 v130, v164, v165
    v_cvt_pk_bf16_f32 v131, v166, v167
    v_mfma_f32_32x32x16_bf16 v[192:207], v[72:75], v[132:135], v[192:207]
    v_exp_f32 v168, v168
    v_exp_f32 v169, v169
    v_exp_f32 v170, v170
    v_exp_f32 v171, v171
    v_cvt_pk_bf16_f32 v132, v168, v169
    v_cvt_pk_bf16_f32 v133, v170, v171
    v_mfma_f32_32x32x16_bf16 v[208:223], v[68:71], v[128:131], v[208:223]
    v_exp_f32 v172, v172
    v_exp_f32 v173, v173
    v_exp_f32 v174, v174
    v_exp_f32 v175, v175
    v_cvt_pk_bf16_f32 v134, v172, v173
    v_cvt_pk_bf16_f32 v135, v174, v175
    v_mfma_f32_32x32x16_bf16 v[160:175], v[32:35], v[124:127], 0
    v_exp_f32 v176, v176
    v_exp_f32 v177, v177
    v_exp_f32 v178, v178
    v_exp_f32 v179, v179
    v_cvt_pk_bf16_f32 v128, v176, v177
    v_cvt_pk_bf16_f32 v129, v178, v179
    v_mfma_f32_32x32x16_bf16 v[160:175], v[46:49], v[64:67], v[160:175]
    v_exp_f32 v180, v180
    v_exp_f32 v181, v181
    v_exp_f32 v182, v182
    v_exp_f32 v183, v183
    v_cvt_pk_bf16_f32 v130, v180, v181
    v_cvt_pk_bf16_f32 v131, v182, v183
    v_mfma_f32_32x32x16_bf16 v[208:223], v[72:75], v[132:135], v[208:223]
    v_exp_f32 v184, v184
    v_exp_f32 v185, v185
    v_exp_f32 v186, v186
    v_exp_f32 v187, v187
    v_cvt_pk_bf16_f32 v132, v184, v185
    v_cvt_pk_bf16_f32 v133, v186, v187
    v_mfma_f32_32x32x16_bf16 v[224:239], v[68:71], v[128:131], v[224:239]
    v_exp_f32 v188, v188
    v_exp_f32 v189, v189
    v_exp_f32 v190, v190
    v_exp_f32 v191, v191
    v_cvt_pk_bf16_f32 v134, v188, v189
    v_cvt_pk_bf16_f32 v135, v190, v191
    s_cmp_lg_u32 s79, 0
    s_cbranch_scc1 L_B_wait
L_B_go:
    v_xor_b32 v16, 0xff800000, v16
    v_xor_b32 v17, 0xff800000, v17
    v_xor_b32 v18, 0xff800000, v18
    v_xor_b32 v19, 0xff800000, v19
    v_xor_b32 v20, 0xff800000, v20
    v_xor_b32 v21, 0xff800000, v21
    v_xor_b32 v22, 0xff800000, v22
    v_xor_b32 v23, 0xff800000, v23
    v_xor_b32 v24, 0xff800000, v24
    v_xor_b32 v25, 0xff800000, v25
    v_xor_b32 v26, 0xff800000, v26
    v_xor_b32 v27, 0xff800000, v27
    v_xor_b32 v28, 0xff800000, v28
    v_xor_b32 v29, 0xff800000, v29
    v_xor_b32 v30, 0xff800000, v30
    v_xor_b32 v31, 0xff800000, v31
    s_waitcnt vmcnt(6)
    v_mfma_f32_32x32x16_bf16 v[176:191], v[44:47], v[112:115], 0
    v_exp_f32 v160, v160
    v_exp_f32 v161, v161
    v_exp_f32 v162, v162
    v_exp_f32 v163, v163
    v_cvt_pk_bf16_f32 v128, v160, v161
    v_cvt_pk_bf16_f32 v129, v162, v163
    s_waitcnt vmcnt(5)
    v_mfma_f32_32x32x16_bf16 v[176:191], v[54:57], v[56:59], v[176:191]
    v_exp_f32 v164, v164
    v_exp_f32 v165, v165
    v_exp_f32 v166, v166
    v_exp_f32 v167, v167
    v_cvt_pk_bf16_f32 v130, v164, v165
    v_cvt_pk_bf16_f32 v131, v166, v167
    v_mfma_f32_32x32x16_bf16 v[224:239], v[72:75], v[132:135], v[224:239]
    v_exp_f32 v168, v168
    v_exp_f32 v169, v169
    v_exp_f32 v170, v170
    v_exp_f32 v171, v171
    v_cvt_pk_bf16_f32 v132, v168, v169
    v_cvt_pk_bf16_f32 v133, v170, v171
    v_mfma_f32_32x32x16_bf16 v[240:255], v[68:71], v[128:131], v[240:255]
    v_exp_f32 v172, v172
    v_exp_f32 v173, v173
    v_exp_f32 v174, v174
    v_exp_f32 v175, v175
    v_cvt_pk_bf16_f32 v134, v172, v173
    v_cvt_pk_bf16_f32 v135, v174, v175
    s_cmp_eq_u32 s22, 0
    s_cbranch_scc1 L_B_x0
    v_mfma_f32_32x32x16_bf16 v[160:175], v[44:47], v[116:119], 0
    buffer_load_dword v9, v8, s[12:15], s27 offen sc1
    v_exp_f32 v176, v176
    v_exp_f32 v177, v177
    v_exp_f32 v178, v178
    v_exp_f32 v179, v179
    v_cvt_pk_bf16_f32 v128, v176, v177
    v_cvt_pk_bf16_f32 v129, v178, v179
    v_mfma_f32_32x32x16_bf16 v[160:175], v[52:55], v[58:61], v[160:175]
    v_mov_b32 v100, 163776
    s_mov_b64 exec, 1
    ds_add_u32 v100, v13 offset:24
    s_mov_b64 exec, -1
    v_exp_f32 v180, v180
    v_exp_f32 v181, v181
    v_exp_f32 v182, v182
    v_exp_f32 v183, v183
    v_cvt_pk_bf16_f32 v130, v180, v181
    v_cvt_pk_bf16_f32 v131, v182, v183
    v_mfma_f32_32x32x16_bf16 v[240:255], v[72:75], v[132:135], v[240:255]
    v_exp_f32 v184, v184
    v_exp_f32 v185, v185
    v_exp_f32 v186, v186
    v_exp_f32 v187, v187
    v_cvt_pk_bf16_f32 v132, v184, v185
    v_cvt_pk_bf16_f32 v133, v186, v187
    s_waitcnt vmcnt(5)
    v_mfma_f32_32x32x16_bf16 v[192:207], v[92:95], v[128:131], v[192:207]
    v_exp_f32 v188, v188
    v_exp_f32 v189, v189
    v_exp_f32 v190, v190
    v_exp_f32 v191, v191
    v_cvt_pk_bf16_f32 v134, v188, v189
    v_cvt_pk_bf16_f32 v135, v190, v191
    v_mfma_f32_32x32x16_bf16 v[176:191], v[44:47], v[120:123], 0
    v_exp_f32 v160, v160
    v_exp_f32 v161, v161
    v_exp_f32 v162, v162
    v_exp_f32 v163, v163
    v_cvt_pk_bf16_f32 v128, v160, v161
    v_cvt_pk_bf16_f32 v129, v162, v163
    v_mfma_f32_32x32x16_bf16 v[176:191], v[54:57], v[62:65], v[176:191]
    v_exp_f32 v164, v164
    v_exp_f32 v165, v165
    v_exp_f32 v166, v166
    v_exp_f32 v167, v167
    v_cvt_pk_bf16_f32 v130, v164, v165
    v_cvt_pk_bf16_f32 v131, v166, v167
    s_waitcnt vmcnt(4)
    v_mfma_f32_32x32x16_bf16 v[192:207], v[96:99], v[132:135], v[192:207]
    v_exp_f32 v168, v168
    v_exp_f32 v169, v169
    v_exp_f32 v170, v170
    v_exp_f32 v171, v171
    v_cvt_pk_bf16_f32 v132, v168, v169
    v_cvt_pk_bf16_f32 v133, v170, v171
    v_mfma_f32_32x32x16_bf16 v[208:223], v[92:95], v[128:131], v[208:223]
    v_exp_f32 v172, v172
    v_exp_f32 v173, v173
    v_exp_f32 v174, v174
    v_exp_f32 v175, v175
    v_cvt_pk_bf16_f32 v134, v172, v173
    v_cvt_pk_bf16_f32 v135, v174, v175
    v_mfma_f32_32x32x16_bf16 v[160:175], v[44:47], v[124:127], 0
    v_exp_f32 v176, v176
    v_exp_f32 v177, v177
    v_exp_f32 v178, v178
    v_exp_f32 v179, v179
    v_cvt_pk_bf16_f32 v128, v176, v177
    v_cvt_pk_bf16_f32 v129, v178, v179
    v_mfma_f32_32x32x16_bf16 v[160:175], v[52:55], v[64:67], v[160:175]
    s_waitcnt vmcnt(0)
    v_cmp_eq_u32 vcc, 0, v9
    s_nop 0
    s_and_b32 s28, vcc_lo, 3
    s_cbranch_scc1 L_B_wait2
L_B_go2:
    buffer_load_dwordx4 v[36:39], v1, s[12:15], s66 offen offset:1024 sc1
    buffer_load_dwordx4 v[48:51], v11, s[12:15], s67 offen offset:0 sc1
    v_exp_f32 v180, v180
    v_exp_f32 v181, v181
    v_exp_f32 v182, v182
    v_exp_f32 v183, v183
    v_cvt_pk_bf16_f32 v130, v180, v181
    v_cvt_pk_bf16_f32 v131, v182, v183
    v_mfma_f32_32x32x16_bf16 v[208:223], v[96:99], v[132:135], v[208:223]
    v_exp_f32 v184, v184
    v_exp_f32 v185, v185
    v_exp_f32 v186, v186
    v_exp_f32 v187, v187
    v_cvt_pk_bf16_f32 v132, v184, v185
    v_cvt_pk_bf16_f32 v133, v186, v187
    v_mfma_f32_32x32x16_bf16 v[224:239], v[92:95], v[128:131], v[224:239]
    buffer_load_dwordx4 v[76:79], v6, s[12:15], s68 offen offset:1536 sc1
    buffer_load_dwordx4 v[80:83], v6, s[12:15], s68 offen offset:2304 sc1
    v_exp_f32 v188, v188
    v_exp_f32 v189, v189
    v_exp_f32 v190, v190
    v_exp_f32 v191, v191
    v_cvt_pk_bf16_f32 v134, v188, v189
    v_cvt_pk_bf16_f32 v135, v190, v191
    v_mfma_f32_32x32x16_bf16 v[176:191], v[40:43], v[112:115], 0
    buffer_load_dwordx4 v[32:35], v1, s[12:15], s66 offen offset:0 sc1
    v_exp_f32 v160, v160
    v_exp_f32 v161, v161
    v_exp_f32 v162, v162
    v_exp_f32 v163, v163
    v_cvt_pk_bf16_f32 v128, v160, v161
    v_cvt_pk_bf16_f32 v129, v162, v163
    v_mfma_f32_32x32x16_bf16 v[176:191], v[52:55], v[56:59], v[176:191]
    v_exp_f32 v164, v164
    v_exp_f32 v165, v165
    v_exp_f32 v166, v166
    v_exp_f32 v167, v167
    v_cvt_pk_bf16_f32 v130, v164, v165
    v_cvt_pk_bf16_f32 v131, v166, v167
    v_mfma_f32_32x32x16_bf16 v[224:239], v[96:99], v[132:135], v[224:239]
    buffer_load_dwordx4 v[68:71], v6, s[12:15], s68 offen offset:0 sc1
    buffer_load_dwordx4 v[72:75], v6, s[12:15], s68 offen offset:768 sc1
    s_sub_u32 s66, s66, s37
    s_sub_u32 s67, s67, s37
    s_sub_u32 s68, s68, s37
    s_sub_u32 s69, s69, s37
    v_exp_f32 v168, v168
    v_exp_f32 v169, v169
    v_exp_f32 v170, v170
    v_exp_f32 v171, v171
    v_cvt_pk_bf16_f32 v132, v168, v169
    v_cvt_pk_bf16_f32 v133, v170, v171
    v_mfma_f32_32x32x16_bf16 v[240:255], v[92:95], v[128:131], v[240:255]
    v_exp_f32 v172, v172
    v_exp_f32 v173, v173
    v_exp_f32 v174, v174
    v_exp_f32 v175, v175
    v_cvt_pk_bf16_f32 v134, v172, v173
    v_cvt_pk_bf16_f32 v135, v174, v175
    v_mfma_f32_32x32x16_bf16 v[160:175], v[40:43], v[116:119], 0
    v_exp_f32 v176, v176
    v_exp_f32 v177, v177
    v_exp_f32 v178, v178
    v_exp_f32 v179, v179
    v_cvt_pk_bf16_f32 v128, v176, v177
    v_cvt_pk_bf16_f32 v129, v178, v179
    v_mfma_f32_32x32x16_bf16 v[160:175], v[50:53], v[58:61], v[160:175]
    v_exp_f32 v180, v180
    v_exp_f32 v181, v181
    v_exp_f32 v182, v182
    v_exp_f32 v183, v183
    v_cvt_pk_bf16_f32 v130, v180, v181
    v_cvt_pk_bf16_f32 v131, v182, v183
    v_mfma_f32_32x32x16_bf16 v[240:255], v[96:99], v[132:135], v[240:255]
    buffer_load_dwordx4 v[44:47], v1, s[12:15], s66 offen offset:3072 sc1
    v_exp_f32 v184, v184
    v_exp_f32 v185, v185
    v_exp_f32 v186, v186
    v_exp_f32 v187, v187
    v_cvt_pk_bf16_f32 v132, v184, v185
    v_cvt_pk_bf16_f32 v133, v186, v187
    v_mfma_f32_32x32x16_bf16 v[192:207], v[84:87], v[128:131], v[192:207]
    buffer_load_dwordx4 v[92:95], v6, s[12:15], s69 offen offset:1536 sc1
    buffer_load_dwordx4 v[96:99], v6, s[12:15], s69 offen offset:2304 sc1
    v_exp_f32 v188, v188
    v_exp_f32 v189, v189
    v_exp_f32 v190, v190
    v_exp_f32 v191, v191
    v_cvt_pk_bf16_f32 v134, v188, v189
    v_cvt_pk_bf16_f32 v135, v190, v191
    v_mfma_f32_32x32x16_bf16 v[176:191], v[40:43], v[120:123], 0
    v_exp_f32 v160, v160
    v_exp_f32 v161, v161
    v_exp_f32 v162, v162
    v_exp_f32 v163, v163
    v_cvt_pk_bf16_f32 v128, v160, v161
    v_cvt_pk_bf16_f32 v129, v162, v163
    v_mfma_f32_32x32x16_bf16 v[176:191], v[52:55], v[62:65], v[176:191]
    v_exp_f32 v164, v164
    v_exp_f32 v165, v165
    v_exp_f32 v166, v166
    v_exp_f32 v167, v167
    v_cvt_pk_bf16_f32 v130, v164, v165
    v_cvt_pk_bf16_f32 v131, v166, v167
    v_mfma_f32_32x32x16_bf16 v[192:207], v[88:91], v[132:135], v[192:207]
    v_exp_f32 v168, v168
    v_exp_f32 v169, v169
    v_exp_f32 v170, v170
    v_exp_f32 v171, v171
    v_cvt_pk_bf16_f32 v132, v168, v169
    v_cvt_pk_bf16_f32 v133, v170, v171
    v_mfma_f32_32x32x16_bf16 v[208:223], v[84:87], v[128:131], v[208:223]
    v_exp_f32 v172, v172
    v_exp_f32 v173, v173
    v_exp_f32 v174, v174
    v_exp_f32 v175, v175
    v_cvt_pk_bf16_f32 v134, v172, v173
    v_cvt_pk_bf16_f32 v135, v174, v175
    v_mfma_f32_32x32x16_bf16 v[160:175], v[40:43], v[124:127], 0
    v_exp_f32 v176, v176
    v_exp_f32 v177, v177
    v_exp_f32 v178, v178
    v_exp_f32 v179, v179
    v_cvt_pk_bf16_f32 v128, v176, v177
    v_cvt_pk_bf16_f32 v129, v178, v179
    v_mfma_f32_32x32x16_bf16 v[160:175], v[50:53], v[64:67], v[160:175]
    v_exp_f32 v180, v180
    v_exp_f32 v181, v181
    v_exp_f32 v182, v182
    v_exp_f32 v183, v183
    v_cvt_pk_bf16_f32 v130, v180, v181
    v_cvt_pk_bf16_f32 v131, v182, v183
    v_mfma_f32_32x32x16_bf16 v[208:223], v[88:91], v[132:135], v[208:223]
    v_exp_f32 v184, v184
    v_exp_f32 v185, v185
    v_exp_f32 v186, v186
    v_exp_f32 v187, v187
    v_cvt_pk_bf16_f32 v132, v184, v185
    v_cvt_pk_bf16_f32 v133, v186, v187
    v_mfma_f32_32x32x16_bf16 v[224:239], v[84:87], v[128:131], v[224:239]
    v_exp_f32 v188, v188
    v_exp_f32 v189, v189
    v_exp_f32 v190, v190
    v_exp_f32 v191, v191
    v_cvt_pk_bf16_f32 v134, v188, v189
    v_cvt_pk_bf16_f32 v135, v190, v191
    s_waitcnt vmcnt(9)
    v_mfma_f32_32x32x16_bf16 v[176:191], v[36:39], v[112:115], 0
    v_exp_f32 v160, v160
    v_exp_f32 v161, v161
    v_exp_f32 v162, v162
    v_exp_f32 v163, v163
    v_cvt_pk_bf16_f32 v128, v160, v161
    v_cvt_pk_bf16_f32 v129, v162, v163
    s_waitcnt vmcnt(8)
    v_mfma_f32_32x32x16_bf16 v[176:191], v[50:53], v[56:59], v[176:191]
    v_exp_f32 v164, v164
    v_exp_f32 v165, v165
    v_exp_f32 v166, v166
    v_exp_f32 v167, v167
    v_cvt_pk_bf16_f32 v130, v164, v165
    v_cvt_pk_bf16_f32 v131, v166, v167
    v_mfma_f32_32x32x16_bf16 v[224:239], v[88:91], v[132:135], v[224:239]
    v_exp_f32 v168, v168
    v_exp_f32 v169, v169
    v_exp_f32 v170, v170
    v_exp_f32 v171, v171
    v_cvt_pk_bf16_f32 v132, v168, v169
    v_cvt_pk_bf16_f32 v133, v170, v171
    v_mfma_f32_32x32x16_bf16 v[240:255], v[84:87], v[128:131], v[240:255]
    v_exp_f32 v172, v172
    v_exp_f32 v173, v173
    v_exp_f32 v174, v174
    v_exp_f32 v175, v175
    v_cvt_pk_bf16_f32 v134, v172, v173
    v_cvt_pk_bf16_f32 v135, v174, v175
    v_mfma_f32_32x32x16_bf16 v[160:175], v[36:39], v[116:119], 0
    v_exp_f32 v176, v176
    v_exp_f32 v177, v177
    v_exp_f32 v178, v178
    v_exp_f32 v179, v179
    v_cvt_pk_bf16_f32 v128, v176, v177
    v_cvt_pk_bf16_f32 v129, v178, v179
    v_mfma_f32_32x32x16_bf16 v[160:175], v[48:51], v[58:61], v[160:175]
    v_exp_f32 v180, v180
    v_exp_f32 v181, v181
    v_exp_f32 v182, v182
    v_exp_f32 v183, v183
    v_cvt_pk_bf16_f32 v130, v180, v181
    v_cvt_pk_bf16_f32 v131, v182, v183
    v_mfma_f32_32x32x16_bf16 v[240:255], v[88:91], v[132:135], v[240:255]
    buffer_load_dwordx4 v[40:43], v1, s[12:15], s66 offen offset:2048 sc1
    buffer_load_dwordx4 v[52:55], v11, s[12:15], s67 offen offset:512 sc1
    v_exp_f32 v184, v184
    v_exp_f32 v185, v185
    v_exp_f32 v186, v186
    v_exp_f32 v187, v187
    v_cvt_pk_bf16_f32 v132, v184, v185
    v_cvt_pk_bf16_f32 v133, v186, v187
    s_waitcnt vmcnt(9)
    v_mfma_f32_32x32x16_bf16 v[192:207], v[76:79], v[128:131], v[192:207]
    buffer_load_dwordx4 v[84:87], v6, s[12:15], s69 offen offset:0 sc1
    buffer_load_dwordx4 v[88:91], v6, s[12:15], s69 offen offset:768 sc1
    v_exp_f32 v188, v188
    v_exp_f32 v189, v189
    v_exp_f32 v190, v190
    v_exp_f32 v191, v191
    v_cvt_pk_bf16_f32 v134, v188, v189
    v_cvt_pk_bf16_f32 v135, v190, v191
    v_mfma_f32_32x32x16_bf16 v[176:191], v[36:39], v[120:123], 0
    v_exp_f32 v160, v160
    v_exp_f32 v161, v161
    v_exp_f32 v162, v162
    v_exp_f32 v163, v163
    v_cvt_pk_bf16_f32 v128, v160, v161
    v_cvt_pk_bf16_f32 v129, v162, v163
    v_mfma_f32_32x32x16_bf16 v[176:191], v[50:53], v[62:65], v[176:191]
    v_exp_f32 v164, v164
    v_exp_f32 v165, v165
    v_exp_f32 v166, v166
    v_exp_f32 v167, v167
    v_cvt_pk_bf16_f32 v130, v164, v165
    v_cvt_pk_bf16_f32 v131, v166, v167
    s_waitcnt vmcnt(10)
    v_mfma_f32_32x32x16_bf16 v[192:207], v[80:83], v[132:135], v[192:207]
    v_exp_f32 v168, v168
    v_exp_f32 v169, v169
    v_exp_f32 v170, v170
    v_exp_f32 v171, v171
    v_cvt_pk_bf16_f32 v132, v168, v169
    v_cvt_pk_bf16_f32 v133, v170, v171
    v_mfma_f32_32x32x16_bf16 v[208:223], v[76:79], v[128:131], v[208:223]
    v_exp_f32 v172, v172
    v_exp_f32 v173, v173
    v_exp_f32 v174, v174
    v_exp_f32 v175, v175
    v_cvt_pk_bf16_f32 v134, v172, v173
    v_cvt_pk_bf16_f32 v135, v174, v175
    v_mfma_f32_32x32x16_bf16 v[160:175], v[36:39], v[124:127], 0
    v_exp_f32 v176, v176
    v_exp_f32 v177, v177
    v_exp_f32 v178, v178
    v_exp_f32 v179, v179
    v_cvt_pk_bf16_f32 v128, v176, v177
    v_cvt_pk_bf16_f32 v129, v178, v179
    v_mfma_f32_32x32x16_bf16 v[160:175], v[48:51], v[64:67], v[160:175]
    v_exp_f32 v180, v180
    v_exp_f32 v181, v181
    v_exp_f32 v182, v182
    v_exp_f32 v183, v183
    v_cvt_pk_bf16_f32 v130, v180, v181
    v_cvt_pk_bf16_f32 v131, v182, v183
    v_mfma_f32_32x32x16_bf16 v[208:223], v[80:83], v[132:135], v[208:223]
    v_exp_f32 v184, v184
    v_exp_f32 v185, v185
    v_exp_f32 v186, v186
    v_exp_f32 v187, v187
    v_cvt_pk_bf16_f32 v132, v184, v185
    v_cvt_pk_bf16_f32 v133, v186, v187
    v_mfma_f32_32x32x16_bf16 v[224:239], v[76:79], v[128:131], v[224:239]
    v_exp_f32 v188, v188
    v_exp_f32 v189, v189
    v_exp_f32 v190, v190
    v_exp_f32 v191, v191
    v_cvt_pk_bf16_f32 v134, v188, v189
    v_cvt_pk_bf16_f32 v135, v190, v191
    s_waitcnt vmcnt(9)
    v_mfma_f32_32x32x16_bf16 v[176:191], v[32:35], v[112:115], 0
    v_exp_f32 v160, v160
    v_exp_f32 v161, v161
    v_exp_f32 v162, v162
    v_exp_f32 v163, v163
    v_cvt_pk_bf16_f32 v128, v160, v161
    v_cvt_pk_bf16_f32 v129, v162, v163
    v_mfma_f32_32x32x16_bf16 v[176:191], v[48:51], v[56:59], v[176:191]
    v_exp_f32 v164, v164
    v_exp_f32 v165, v165
    v_exp_f32 v166, v166
    v_exp_f32 v167, v167
    v_cvt_pk_bf16_f32 v130, v164, v165
    v_cvt_pk_bf16_f32 v131, v166, v167
    v_mfma_f32_32x32x16_bf16 v[224:239], v[80:83], v[132:135], v[224:239]
    v_exp_f32 v168, v168
    v_exp_f32 v169, v169
    v_exp_f32 v170, v170
    v_exp_f32 v171, v171
    v_cvt_pk_bf16_f32 v132, v168, v169
    v_cvt_pk_bf16_f32 v133, v170, v171
    v_mfma_f32_32x32x16_bf16 v[240:255], v[76:79], v[128:131], v[240:255]
    v_exp_f32 v172, v172
    v_exp_f32 v173, v173
    v_exp_f32 v174, v174
    v_exp_f32 v175, v175
    v_cvt_pk_bf16_f32 v134, v172, v173
    v_cvt_pk_bf16_f32 v135, v174, v175
    v_mfma_f32_32x32x16_bf16 v[160:175], v[32:35], v[116:119], 0
    v_exp_f32 v176, v176
    v_exp_f32 v177, v177
    v_exp_f32 v178, v178
    v_exp_f32 v179, v179
    v_cvt_pk_bf16_f32 v128, v176, v177
    v_cvt_pk_bf16_f32 v129, v178, v179
    v_mfma_f32_32x32x16_bf16 v[160:175], v[46:49], v[58:61], v[160:175]
    v_exp_f32 v180, v180
    v_exp_f32 v181, v181
    v_exp_f32 v182, v182
    v_exp_f32 v183, v183
    v_cvt_pk_bf16_f32 v130, v180, v181
    v_cvt_pk_bf16_f32 v131, v182, v183
    v_mfma_f32_32x32x16_bf16 v[240:255], v[80:83], v[132:135], v[240:255]
    buffer_load_dwordx4 v[36:39], v1, s[12:15], s66 offen offset:1024 sc1
    v_exp_f32 v184, v184
    v_exp_f32 v185, v185
    v_exp_f32 v186, v186
    v_exp_f32 v187, v187
    v_cvt_pk_bf16_f32 v132, v184, v185
    v_cvt_pk_bf16_f32 v133, v186, v187
    s_waitcnt vmcnt(9)
    v_mfma_f32_32x32x16_bf16 v[192:207], v[68:71], v[128:131], v[192:207]
    buffer_load_dwordx4 v[76:79], v6, s[12:15], s68 offen offset:1536 sc1
    buffer_load_dwordx4 v[80:83], v6, s[12:15], s68 offen offset:2304 sc1
    v_exp_f32 v188, v188
    v_exp_f32 v189, v189
    v_exp_f32 v190, v190
    v_exp_f32 v191, v191
    v_cvt_pk_bf16_f32 v134, v188, v189
    v_cvt_pk_bf16_f32 v135, v190, v191
    v_mfma_f32_32x32x16_bf16 v[176:191], v[32:35], v[120:123], 0
    v_exp_f32 v160, v160
    v_exp_f32 v161, v161
    v_exp_f32 v162, v162
    v_exp_f32 v163, v163
    v_cvt_pk_bf16_f32 v128, v160, v161
    v_cvt_pk_bf16_f32 v129, v162, v163
    v_mfma_f32_32x32x16_bf16 v[176:191], v[48:51], v[62:65], v[176:191]
    v_exp_f32 v164, v164
    v_exp_f32 v165, v165
    v_exp_f32 v166, v166
    v_exp_f32 v167, v167
    v_cvt_pk_bf16_f32 v130, v164, v165
    v_cvt_pk_bf16_f32 v131, v166, v167
    s_waitcnt vmcnt(10)
    v_mfma_f32_32x32x16_bf16 v[192:207], v[72:75], v[132:135], v[192:207]
    v_exp_f32 v168, v168
    v_exp_f32 v169, v169
    v_exp_f32 v170, v170
    v_exp_f32 v171, v171
    v_cvt_pk_bf16_f32 v132, v168, v169
    v_cvt_pk_bf16_f32 v133, v170, v171
    v_mfma_f32_32x32x16_bf16 v[208:223], v[68:71], v[128:131], v[208:223]
    v_exp_f32 v172, v172
    v_exp_f32 v173, v173
    v_exp_f32 v174, v174
    v_exp_f32 v175, v175
    v_cvt_pk_bf16_f32 v134, v172, v173
    v_cvt_pk_bf16_f32 v135, v174, v175
    v_mfma_f32_32x32x16_bf16 v[160:175], v[32:35], v[124:127], 0
    v_exp_f32 v176, v176
    v_exp_f32 v177, v177
    v_exp_f32 v178, v178
    v_exp_f32 v179, v179
    v_cvt_pk_bf16_f32 v128, v176, v177
    v_cvt_pk_bf16_f32 v129, v178, v179
    v_mfma_f32_32x32x16_bf16 v[160:175], v[46:49], v[64:67], v[160:175]
    v_exp_f32 v180, v180
    v_exp_f32 v181, v181
    v_exp_f32 v182, v182
    v_exp_f32 v183, v183
    v_cvt_pk_bf16_f32 v130, v180, v181
    v_cvt_pk_bf16_f32 v131, v182, v183
    v_mfma_f32_32x32x16_bf16 v[208:223], v[72:75], v[132:135], v[208:223]
    v_exp_f32 v184, v184
    v_exp_f32 v185, v185
    v_exp_f32 v186, v186
    v_exp_f32 v187, v187
    v_cvt_pk_bf16_f32 v132, v184, v185
    v_cvt_pk_bf16_f32 v133, v186, v187
    v_mfma_f32_32x32x16_bf16 v[224:239], v[68:71], v[128:131], v[224:239]
    v_exp_f32 v188, v188
    v_exp_f32 v189, v189
    v_exp_f32 v190, v190
    v_exp_f32 v191, v191
    v_cvt_pk_bf16_f32 v134, v188, v189
    v_cvt_pk_bf16_f32 v135, v190, v191
    s_waitcnt vmcnt(9)
    v_mfma_f32_32x32x16_bf16 v[176:191], v[44:47], v[124:127], v[16:31]
    v_exp_f32 v160, v160
    v_exp_f32 v161, v161
    v_exp_f32 v162, v162
    v_exp_f32 v163, v163
    v_cvt_pk_bf16_f32 v128, v160, v161
    v_cvt_pk_bf16_f32 v129, v162, v163
    s_waitcnt vmcnt(5)
    v_mfma_f32_32x32x16_bf16 v[176:191], v[52:55], v[64:67], v[176:191]
    v_exp_f32 v164, v164
    v_exp_f32 v165, v165
    v_exp_f32 v166, v166
    v_exp_f32 v167, v167
    v_cvt_pk_bf16_f32 v130, v164, v165
    v_cvt_pk_bf16_f32 v131, v166, v167
    v_mfma_f32_32x32x16_bf16 v[224:239], v[72:75], v[132:135], v[224:239]
    v_exp_f32 v168, v168
    v_exp_f32 v169, v169
    v_exp_f32 v170, v170
    v_exp_f32 v171, v171
    v_cvt_pk_bf16_f32 v132, v168, v169
    v_cvt_pk_bf16_f32 v133, v170, v171
    v_mfma_f32_32x32x16_bf16 v[240:255], v[68:71], v[128:131], v[240:255]
    v_exp_f32 v172, v172
    v_exp_f32 v173, v173
    v_exp_f32 v174, v174
    v_exp_f32 v175, v175
    v_cvt_pk_bf16_f32 v134, v172, v173
    v_cvt_pk_bf16_f32 v135, v174, v175
    s_cmp_eq_u32 s22, 1
    s_cbranch_scc1 L_B_x1
    v_mfma_f32_32x32x16_bf16 v[160:175], v[44:47], v[120:123], 0
    v_exp_f32 v176, v176
    v_exp_f32 v177, v177
    v_exp_f32 v178, v178
    v_exp_f32 v179, v179
    v_cvt_pk_bf16_f32 v128, v176, v177
    v_cvt_pk_bf16_f32 v129, v178, v179
    v_mfma_f32_32x32x16_bf16 v[160:175], v[54:57], v[62:65], v[160:175]
    v_exp_f32 v180, v180
    v_exp_f32 v181, v181
    v_exp_f32 v182, v182
    v_exp_f32 v183, v183
    v_cvt_pk_bf16_f32 v130, v180, v181
    v_cvt_pk_bf16_f32 v131, v182, v183
    v_mfma_f32_32x32x16_bf16 v[240:255], v[72:75], v[132:135], v[240:255]
    buffer_load_dwordx4 v[32:35], v1, s[12:15], s66 offen offset:0 sc1
    buffer_load_dwordx4 v[48:51], v11, s[12:15], s67 offen offset:0 sc1
    v_exp_f32 v184, v184
    v_exp_f32 v185, v185
    v_exp_f32 v186, v186
    v_exp_f32 v187, v187
    v_cvt_pk_bf16_f32 v132, v184, v185
    v_cvt_pk_bf16_f32 v133, v186, v187
    v_mfma_f32_32x32x16_bf16 v[240:255], v[92:95], v[128:131], v[240:255]
    buffer_load_dwordx4 v[68:71], v6, s[12:15], s68 offen offset:0 sc1
    buffer_load_dwordx4 v[72:75], v6, s[12:15], s68 offen offset:768 sc1
    v_exp_f32 v188, v188
    v_exp_f32 v189, v189
    v_exp_f32 v190, v190
    v_exp_f32 v191, v191
    v_cvt_pk_bf16_f32 v134, v188, v189
    v_cvt_pk_bf16_f32 v135, v190, v191
    v_mfma_f32_32x32x16_bf16 v[176:191], v[44:47], v[116:119], 0
    v_exp_f32 v160, v160
    v_exp_f32 v161, v161
    v_exp_f32 v162, v162
    v_exp_f32 v163, v163
    v_cvt_pk_bf16_f32 v128, v160, v161
    v_cvt_pk_bf16_f32 v129, v162, v163
    v_mfma_f32_32x32x16_bf16 v[176:191], v[52:55], v[58:61], v[176:191]
    v_exp_f32 v164, v164
    v_exp_f32 v165, v165
    v_exp_f32 v166, v166
    v_exp_f32 v167, v167
    v_cvt_pk_bf16_f32 v130, v164, v165
    v_cvt_pk_bf16_f32 v131, v166, v167
    v_mfma_f32_32x32x16_bf16 v[240:255], v[96:99], v[132:135], v[240:255]
    v_exp_f32 v168, v168
    v_exp_f32 v169, v169
    v_exp_f32 v170, v170
    v_exp_f32 v171, v171
    v_cvt_pk_bf16_f32 v132, v168, v169
    v_cvt_pk_bf16_f32 v133, v170, v171
    v_mfma_f32_32x32x16_bf16 v[224:239], v[92:95], v[128:131], v[224:239]
    v_exp_f32 v172, v172
    v_exp_f32 v173, v173
    v_exp_f32 v174, v174
    v_exp_f32 v175, v175
    v_cvt_pk_bf16_f32 v134, v172, v173
    v_cvt_pk_bf16_f32 v135, v174, v175
    v_mfma_f32_32x32x16_bf16 v[160:175], v[44:47], v[112:115], 0
    v_add_u32 v253, 0xd4800000, v252
    v_max_u32 v10, v10, v253
    v_rcp_f32 v252, v252
    s_nop 0
    v_mul_f32 v240, v240, v252
    v_mul_f32 v241, v241, v252
    v_mul_f32 v242, v242, v252
    v_exp_f32 v176, v176
    v_exp_f32 v177, v177
    v_exp_f32 v178, v178
    v_exp_f32 v179, v179
    v_cvt_pk_bf16_f32 v128, v176, v177
    v_cvt_pk_bf16_f32 v129, v178, v179
    v_mfma_f32_32x32x16_bf16 v[160:175], v[54:57], v[56:59], v[160:175]
    v_mul_f32 v243, v243, v252
    v_mul_f32 v244, v244, v252
    v_mul_f32 v245, v245, v252
    v_mul_f32 v246, v246, v252
    v_mul_f32 v247, v247, v252
    v_mul_f32 v248, v248, v252
    v_exp_f32 v180, v180
    v_exp_f32 v181, v181
    v_exp_f32 v182, v182
    v_exp_f32 v183, v183
    v_cvt_pk_bf16_f32 v130, v180, v181
    v_cvt_pk_bf16_f32 v131, v182, v183
    v_mfma_f32_32x32x16_bf16 v[224:239], v[96:99], v[132:135], v[224:239]
    v_mul_f32 v249, v249, v252
    v_mul_f32 v250, v250, v252
    v_mul_f32 v251, v251, v252
    v_cvt_pk_bf16_f32 v148, v240, v241
    v_cvt_pk_bf16_f32 v149, v242, v243
    v_cvt_pk_bf16_f32 v150, v244, v245
    v_exp_f32 v184, v184
    v_exp_f32 v185, v185
    v_exp_f32 v186, v186
    v_exp_f32 v187, v187
    v_cvt_pk_bf16_f32 v132, v184, v185
    v_cvt_pk_bf16_f32 v133, v186, v187
    v_mfma_f32_32x32x16_bf16 v[208:223], v[92:95], v[128:131], v[208:223]
    v_cvt_pk_bf16_f32 v151, v246, v247
    buffer_store_dwordx4 v[148:151], v1, s[12:15], s77 offen offset:1024 sc1
    v_cvt_pk_bf16_f32 v158, v248, v249
    v_cvt_pk_bf16_f32 v159, v250, v251
    v_exp_f32 v188, v188
    v_exp_f32 v189, v189
    v_exp_f32 v190, v190
    v_exp_f32 v191, v191
    v_cvt_pk_bf16_f32 v134, v188, v189
    v_cvt_pk_bf16_f32 v135, v190, v191
    v_mfma_f32_32x32x16_bf16 v[176:191], v[40:43], v[120:123], v[16:31]
    v_exp_f32 v160, v160
    v_exp_f32 v161, v161
    v_exp_f32 v162, v162
    v_exp_f32 v163, v163
    v_cvt_pk_bf16_f32 v128, v160, v161
    v_cvt_pk_bf16_f32 v129, v162, v163
    v_mfma_f32_32x32x16_bf16 v[176:191], v[52:55], v[62:65], v[176:191]
    v_exp_f32 v164, v164
    v_exp_f32 v165, v165
    v_exp_f32 v166, v166
    v_exp_f32 v167, v167
    v_cvt_pk_bf16_f32 v130, v164, v165
    v_cvt_pk_bf16_f32 v131, v166, v167
    v_mfma_f32_32x32x16_bf16 v[208:223], v[96:99], v[132:135], v[208:223]
    v_exp_f32 v168, v168
    v_exp_f32 v169, v169
    v_exp_f32 v170, v170
    v_exp_f32 v171, v171
    v_cvt_pk_bf16_f32 v132, v168, v169
    v_cvt_pk_bf16_f32 v133, v170, v171
    v_mfma_f32_32x32x16_bf16 v[192:207], v[92:95], v[128:131], v[192:207]
    v_exp_f32 v172, v172
    v_exp_f32 v173, v173
    v_exp_f32 v174, v174
    v_exp_f32 v175, v175
    v_cvt_pk_bf16_f32 v134, v172, v173
    v_cvt_pk_bf16_f32 v135, v174, v175
    v_mfma_f32_32x32x16_bf16 v[160:175], v[40:43], v[116:119], 0
    v_exp_f32 v176, v176
    v_exp_f32 v177, v177
    v_exp_f32 v178, v178
    v_exp_f32 v179, v179
    v_cvt_pk_bf16_f32 v128, v176, v177
    v_cvt_pk_bf16_f32 v129, v178, v179
    v_mfma_f32_32x32x16_bf16 v[160:175], v[50:53], v[58:61], v[160:175]
    v_exp_f32 v180, v180
    v_exp_f32 v181, v181
    v_exp_f32 v182, v182
    v_exp_f32 v183, v183
    v_cvt_pk_bf16_f32 v130, v180, v181
    v_cvt_pk_bf16_f32 v131, v182, v183
    v_mfma_f32_32x32x16_bf16 v[192:207], v[96:99], v[132:135], v[192:207]
    v_exp_f32 v184, v184
    v_exp_f32 v185, v185
    v_exp_f32 v186, v186
    v_exp_f32 v187, v187
    v_cvt_pk_bf16_f32 v132, v184, v185
    v_cvt_pk_bf16_f32 v133, v186, v187
    s_waitcnt vmcnt(9)
    v_mfma_f32_32x32x16_bf16 v[224:239], v[84:87], v[128:131], v[224:239]
    v_exp_f32 v188, v188
    v_exp_f32 v189, v189
    v_exp_f32 v190, v190
    v_exp_f32 v191, v191
    v_cvt_pk_bf16_f32 v134, v188, v189
    v_cvt_pk_bf16_f32 v135, v190, v191
    v_mfma_f32_32x32x16_bf16 v[176:191], v[40:43], v[112:115], 0
    v_exp_f32 v160, v160
    v_exp_f32 v161, v161
    v_exp_f32 v162, v162
    v_exp_f32 v163, v163
    v_cvt_pk_bf16_f32 v128, v160, v161
    v_cvt_pk_bf16_f32 v129, v162, v163
    v_mfma_f32_32x32x16_bf16 v[176:191], v[52:55], v[56:59], v[176:191]
    v_exp_f32 v164, v164
    v_exp_f32 v165, v165
    v_exp_f32 v166, v166
    v_exp_f32 v167, v167
    v_cvt_pk_bf16_f32 v130, v164, v165
    v_cvt_pk_bf16_f32 v131, v166, v167
    s_waitcnt vmcnt(8)
    v_mfma_f32_32x32x16_bf16 v[224:239], v[88:91], v[132:135], v[224:239]
    v_exp_f32 v168, v168
    v_exp_f32 v169, v169
    v_exp_f32 v170, v170
    v_exp_f32 v171, v171
    v_cvt_pk_bf16_f32 v132, v168, v169
    v_cvt_pk_bf16_f32 v133, v170, v171
    v_mfma_f32_32x32x16_bf16 v[208:223], v[84:87], v[128:131], v[208:223]
    v_exp_f32 v172, v172
    v_exp_f32 v173, v173
    v_exp_f32 v174, v174
    v_exp_f32 v175, v175
    v_cvt_pk_bf16_f32 v134, v172, v173
    v_cvt_pk_bf16_f32 v135, v174, v175
    s_waitcnt vmcnt(7)
    v_mfma_f32_32x32x16_bf16 v[160:175], v[36:39], v[116:119], v[16:31]
    v_add_u32 v237, 0xd4800000, v236
    v_max_u32 v10, v10, v237
    v_rcp_f32 v236, v236
    s_nop 0
    v_mul_f32 v224, v224, v236
    v_mul_f32 v225, v225, v236
    v_mul_f32 v226, v226, v236
    v_exp_f32 v176, v176
    v_exp_f32 v177, v177
    v_exp_f32 v178, v178
    v_exp_f32 v179, v179
    v_cvt_pk_bf16_f32 v128, v176, v177
    v_cvt_pk_bf16_f32 v129, v178, v179
    s_waitcnt vmcnt(3)
    v_mfma_f32_32x32x16_bf16 v[160:175], v[48:51], v[58:61], v[160:175]
    v_mul_f32 v227, v227, v236
    v_mul_f32 v228, v228, v236
    v_mul_f32 v229, v229, v236
    v_mul_f32 v230, v230, v236
    v_mul_f32 v231, v231, v236
    v_mul_f32 v232, v232, v236
    v_exp_f32 v180, v180
    v_exp_f32 v181, v181
    v_exp_f32 v182, v182
    v_exp_f32 v183, v183
    v_cvt_pk_bf16_f32 v130, v180, v181
    v_cvt_pk_bf16_f32 v131, v182, v183
    v_mfma_f32_32x32x16_bf16 v[208:223], v[88:91], v[132:135], v[208:223]
    v_mul_f32 v233, v233, v236
    v_mul_f32 v234, v234, v236
    v_mul_f32 v235, v235, v236
    v_cvt_pk_bf16_f32 v144, v224, v225
    v_cvt_pk_bf16_f32 v145, v226, v227
    v_cvt_pk_bf16_f32 v146, v228, v229
    v_exp_f32 v184, v184
    v_exp_f32 v185, v185
    v_exp_f32 v186, v186
    v_exp_f32 v187, v187
    v_cvt_pk_bf16_f32 v132, v184, v185
    v_cvt_pk_bf16_f32 v133, v186, v187
    v_mfma_f32_32x32x16_bf16 v[192:207], v[84:87], v[128:131], v[192:207]
    v_cvt_pk_bf16_f32 v147, v230, v231
    buffer_store_dwordx4 v[144:147], v1, s[12:15], s77 offen offset:0 sc1
    v_cvt_pk_bf16_f32 v156, v232, v233
    v_cvt_pk_bf16_f32 v157, v234, v235
    buffer_store_dwordx4 v[156:159], v2, s[12:15], s77 offen offset:2048 sc1
    v_exp_f32 v188, v188
    v_exp_f32 v189, v189
    v_exp_f32 v190, v190
    v_exp_f32 v191, v191
    v_cvt_pk_bf16_f32 v134, v188, v189
    v_cvt_pk_bf16_f32 v135, v190, v191
    v_mfma_f32_32x32x16_bf16 v[176:191], v[36:39], v[112:115], 0
    v_exp_f32 v160, v160
    v_exp_f32 v161, v161
    v_exp_f32 v162, v162
    v_exp_f32 v163, v163
    v_cvt_pk_bf16_f32 v128, v160, v161
    v_cvt_pk_bf16_f32 v129, v162, v163
    v_mfma_f32_32x32x16_bf16 v[176:191], v[50:53], v[56:59], v[176:191]
    v_exp_f32 v164, v164
    v_exp_f32 v165, v165
    v_exp_f32 v166, v166
    v_exp_f32 v167, v167
    v_cvt_pk_bf16_f32 v130, v164, v165
    v_cvt_pk_bf16_f32 v131, v166, v167
    v_mfma_f32_32x32x16_bf16 v[192:207], v[88:91], v[132:135], v[192:207]
    v_exp_f32 v168, v168
    v_exp_f32 v169, v169
    v_exp_f32 v170, v170
    v_exp_f32 v171, v171
    v_cvt_pk_bf16_f32 v132, v168, v169
    v_cvt_pk_bf16_f32 v133, v170, v171
    v_mfma_f32_32x32x16_bf16 v[208:223], v[76:79], v[128:131], v[208:223]
    v_exp_f32 v172, v172
    v_exp_f32 v173, v173
    v_exp_f32 v174, v174
    v_exp_f32 v175, v175
    v_cvt_pk_bf16_f32 v134, v172, v173
    v_cvt_pk_bf16_f32 v135, v174, v175
    v_mfma_f32_32x32x16_bf16 v[160:175], v[32:35], v[112:115], v[16:31]
    v_exp_f32 v176, v176
    v_exp_f32 v177, v177
    v_exp_f32 v178, v178
    v_exp_f32 v179, v179
    v_cvt_pk_bf16_f32 v128, v176, v177
    v_cvt_pk_bf16_f32 v129, v178, v179
    v_mfma_f32_32x32x16_bf16 v[160:175], v[48:51], v[56:59], v[160:175]
    v_exp_f32 v180, v180
    v_exp_f32 v181, v181
    v_exp_f32 v182, v182
    v_exp_f32 v183, v183
    v_cvt_pk_bf16_f32 v130, v180, v181
    v_cvt_pk_bf16_f32 v131, v182, v183
    v_mfma_f32_32x32x16_bf16 v[208:223], v[80:83], v[132:135], v[208:223]
    v_exp_f32 v184, v184
    v_exp_f32 v185, v185
    v_exp_f32 v186, v186
    v_exp_f32 v187, v187
    v_cvt_pk_bf16_f32 v132, v184, v185
    v_cvt_pk_bf16_f32 v133, v186, v187
    v_mfma_f32_32x32x16_bf16 v[192:207], v[76:79], v[128:131], v[192:207]
    v_exp_f32 v188, v188
    v_exp_f32 v189, v189
    v_exp_f32 v190, v190
    v_exp_f32 v191, v191
    v_cvt_pk_bf16_f32 v134, v188, v189
    v_cvt_pk_bf16_f32 v135, v190, v191
    v_add_u32 v221, 0xd4800000, v220
    v_max_u32 v10, v10, v221
    v_rcp_f32 v220, v220
    s_nop 0
    v_mul_f32 v208, v208, v220
    v_mul_f32 v209, v209, v220
    v_mul_f32 v210, v210, v220
    v_exp_f32 v160, v160
    v_exp_f32 v161, v161
    v_exp_f32 v162, v162
    v_exp_f32 v163, v163
    v_cvt_pk_bf16_f32 v128, v160, v161
    v_cvt_pk_bf16_f32 v129, v162, v163
    v_mul_f32 v211, v211, v220
    v_mul_f32 v212, v212, v220
    v_mul_f32 v213, v213, v220
    v_mul_f32 v214, v214, v220
    v_mul_f32 v215, v215, v220
    v_mul_f32 v216, v216, v220
    v_exp_f32 v164, v164
    v_exp_f32 v165, v165
    v_exp_f32 v166, v166
    v_exp_f32 v167, v167
    v_cvt_pk_bf16_f32 v130, v164, v165
    v_cvt_pk_bf16_f32 v131, v166, v167
    v_mfma_f32_32x32x16_bf16 v[192:207], v[80:83], v[132:135], v[192:207]
    v_mul_f32 v217, v217, v220
    v_mul_f32 v218, v218, v220
    v_mul_f32 v219, v219, v220
    v_cvt_pk_bf16_f32 v140, v208, v209
    v_cvt_pk_bf16_f32 v141, v210, v211
    v_cvt_pk_bf16_f32 v142, v212, v213
    v_exp_f32 v168, v168
    v_exp_f32 v169, v169
    v_exp_f32 v170, v170
    v_exp_f32 v171, v171
    v_cvt_pk_bf16_f32 v132, v168, v169
    v_cvt_pk_bf16_f32 v133, v170, v171
    s_waitcnt vmcnt(4)
    v_mfma_f32_32x32x16_bf16 v[192:207], v[68:71], v[128:131], v[192:207]
    v_cvt_pk_bf16_f32 v143, v214, v215
    buffer_store_dwordx4 v[140:143], v1, s[12:15], s76 offen offset:1024 sc1
    v_cvt_pk_bf16_f32 v154, v216, v217
    v_cvt_pk_bf16_f32 v155, v218, v219
    v_exp_f32 v172, v172
    v_exp_f32 v173, v173
    v_exp_f32 v174, v174
    v_exp_f32 v175, v175
    v_cvt_pk_bf16_f32 v134, v172, v173
    v_cvt_pk_bf16_f32 v135, v174, v175
    s_waitcnt vmcnt(4)
    s_nop 0
    v_mfma_f32_32x32x16_bf16 v[192:207], v[72:75], v[132:135], v[192:207]
    s_nop 11
    v_add_u32 v205, 0xd4800000, v204
    v_max_u32 v10, v10, v205
    v_rcp_f32 v204, v204
    s_nop 0
    v_pk_mul_f32 v[192:193], v[192:193], v[204:205] op_sel_hi:[1,0]
    v_pk_mul_f32 v[194:195], v[194:195], v[204:205] op_sel_hi:[1,0]
    v_pk_mul_f32 v[196:197], v[196:197], v[204:205] op_sel_hi:[1,0]
    v_pk_mul_f32 v[198:199], v[198:199], v[204:205] op_sel_hi:[1,0]
    v_pk_mul_f32 v[200:201], v[200:201], v[204:205] op_sel_hi:[1,0]
    v_pk_mul_f32 v[202:203], v[202:203], v[204:205] op_sel_hi:[1,0]
    v_cvt_pk_bf16_f32 v136, v192, v193
    v_cvt_pk_bf16_f32 v137, v194, v195
    v_cvt_pk_bf16_f32 v138, v196, v197
    v_cvt_pk_bf16_f32 v139, v198, v199
    buffer_store_dwordx4 v[136:139], v1, s[12:15], s76 offen offset:0 sc1
    v_cvt_pk_bf16_f32 v152, v200, v201
    v_cvt_pk_bf16_f32 v153, v202, v203
    buffer_store_dwordx4 v[152:155], v2, s[12:15], s76 offen offset:2048 sc1
L_B_chk:
    v_cmp_le_u32 vcc, 0x28000000, v10
    s_nop 0
    s_cbranch_vccz L_P3c
    s_cmp_lg_u32 s79, 9
    s_cbranch_scc1 L_B_slow
    s_branch L_P3c
L_B_wait:
    s_cmp_eq_u32 s22, 0
    s_cbranch_scc1 L_B_go
    s_mov_b32 s29, 0
    s_mov_b64 exec, 0x1
L_pollB:
    buffer_load_dword v9, v8, s[12:15], 0 offen sc1
    s_add_u32 s29, s29, 1
    s_cmp_ge_u32 s29, 2000000
    s_cbranch_scc1 L_goB
    s_waitcnt vmcnt(0)
    v_cmp_eq_u32 vcc, 0, v9
    s_nop 0
    s_cbranch_vccz L_goB
    s_mov_b64 exec, vcc
    s_sleep 5
    s_branch L_pollB
L_goB:
    s_mov_b64 exec, -1
    s_mov_b32 s66, s36
    s_add_u32 s67, s36, 4096
    s_add_u32 s68, s36, 5120
    s_add_u32 s69, s36, 8192
    buffer_load_dwordx4 v[44:47], v1, s[12:15], s66 offen offset:3072 sc1
    buffer_load_dwordx4 v[52:55], v11, s[12:15], s67 offen offset:512 sc1
    buffer_load_dwordx4 v[92:95], v6, s[12:15], s69 offen offset:1536 sc1
    buffer_load_dwordx4 v[96:99], v6, s[12:15], s69 offen offset:2304 sc1
    buffer_load_dwordx4 v[40:43], v1, s[12:15], s66 offen offset:2048 sc1
    buffer_load_dwordx4 v[84:87], v6, s[12:15], s69 offen offset:0 sc1
    buffer_load_dwordx4 v[88:91], v6, s[12:15], s69 offen offset:768 sc1
    s_branch L_B_go
L_B_wait2:
    s_mov_b32 s29, 0
    s_mov_b64 exec, 0x3
L_pollB2:
    buffer_load_dword v9, v8, s[12:15], s27 offen sc1
    s_add_u32 s29, s29, 1
    s_cmp_ge_u32 s29, 2000000
    s_cbranch_scc1 L_goB2
    s_waitcnt vmcnt(0)
    v_cmp_eq_u32 vcc, 0, v9
    s_nop 0
    s_cbranch_vccz L_goB2
    s_mov_b64 exec, vcc
    s_sleep 5
    s_branch L_pollB2
L_goB2:
    s_mov_b64 exec, -1
    s_branch L_B_go2
L_B_x0:
    v_mov_b32 v9, 163776
    s_mov_b64 exec, 1
    ds_add_u32 v9, v13 offset:24
    s_mov_b64 exec, -1
L_B_x1:
    s_nop 1
    v_mfma_f32_32x32x16_bf16 v[240:255], v[72:75], v[132:135], v[240:255]
L_B_fin4:
    v_add_u32 v205, 0xd4800000, v204
    v_max_u32 v10, v10, v205
    v_rcp_f32 v204, v204
    s_nop 0
    v_pk_mul_f32 v[192:193], v[192:193], v[204:205] op_sel_hi:[1,0]
    v_pk_mul_f32 v[194:195], v[194:195], v[204:205] op_sel_hi:[1,0]
    v_pk_mul_f32 v[196:197], v[196:197], v[204:205] op_sel_hi:[1,0]
    v_pk_mul_f32 v[198:199], v[198:199], v[204:205] op_sel_hi:[1,0]
    v_pk_mul_f32 v[200:201], v[200:201], v[204:205] op_sel_hi:[1,0]
    v_pk_mul_f32 v[202:203], v[202:203], v[204:205] op_sel_hi:[1,0]
    v_cvt_pk_bf16_f32 v136, v192, v193
    v_cvt_pk_bf16_f32 v137, v194, v195
    v_cvt_pk_bf16_f32 v138, v196, v197
    v_cvt_pk_bf16_f32 v139, v198, v199
    buffer_store_dwordx4 v[136:139], v1, s[12:15], s76 offen offset:0 sc1
    v_cvt_pk_bf16_f32 v152, v200, v201
    v_cvt_pk_bf16_f32 v153, v202, v203
    v_add_u32 v221, 0xd4800000, v220
    v_max_u32 v10, v10, v221
    v_rcp_f32 v220, v220
    s_nop 0
    v_pk_mul_f32 v[208:209], v[208:209], v[220:221] op_sel_hi:[1,0]
    v_pk_mul_f32 v[210:211], v[210:211], v[220:221] op_sel_hi:[1,0]
    v_pk_mul_f32 v[212:213], v[212:213], v[220:221] op_sel_hi:[1,0]
    v_pk_mul_f32 v[214:215], v[214:215], v[220:221] op_sel_hi:[1,0]
    v_pk_mul_f32 v[216:217], v[216:217], v[220:221] op_sel_hi:[1,0]
    v_pk_mul_f32 v[218:219], v[218:219], v[220:221] op_sel_hi:[1,0]
    v_cvt_pk_bf16_f32 v140, v208, v209
    v_cvt_pk_bf16_f32 v141, v210, v211
    v_cvt_pk_bf16_f32 v142, v212, v213
    v_cvt_pk_bf16_f32 v143, v214, v215
    buffer_store_dwordx4 v[140:143], v1, s[12:15], s76 offen offset:1024 sc1
    v_cvt_pk_bf16_f32 v154, v216, v217
    v_cvt_pk_bf16_f32 v155, v218, v219
    buffer_store_dwordx4 v[152:155], v2, s[12:15], s76 offen offset:2048 sc1
    v_add_u32 v237, 0xd4800000, v236
    v_max_u32 v10, v10, v237
    v_rcp_f32 v236, v236
    s_nop 0
    v_pk_mul_f32 v[224:225], v[224:225], v[236:237] op_sel_hi:[1,0]
    v_pk_mul_f32 v[226:227], v[226:227], v[236:237] op_sel_hi:[1,0]
    v_pk_mul_f32 v[228:229], v[228:229], v[236:237] op_sel_hi:[1,0]
    v_pk_mul_f32 v[230:231], v[230:231], v[236:237] op_sel_hi:[1,0]
    v_pk_mul_f32 v[232:233], v[232:233], v[236:237] op_sel_hi:[1,0]
    v_pk_mul_f32 v[234:235], v[234:235], v[236:237] op_sel_hi:[1,0]
    v_cvt_pk_bf16_f32 v144, v224, v225
    v_cvt_pk_bf16_f32 v145, v226, v227
    v_cvt_pk_bf16_f32 v146, v228, v229
    v_cvt_pk_bf16_f32 v147, v230, v231
    buffer_store_dwordx4 v[144:147], v1, s[12:15], s77 offen offset:0 sc1
    v_cvt_pk_bf16_f32 v156, v232, v233
    v_cvt_pk_bf16_f32 v157, v234, v235
    v_add_u32 v253, 0xd4800000, v252
    v_max_u32 v10, v10, v253
    v_rcp_f32 v252, v252
    s_nop 0
    v_pk_mul_f32 v[240:241], v[240:241], v[252:253] op_sel_hi:[1,0]
    v_pk_mul_f32 v[242:243], v[242:243], v[252:253] op_sel_hi:[1,0]
    v_pk_mul_f32 v[244:245], v[244:245], v[252:253] op_sel_hi:[1,0]
    v_pk_mul_f32 v[246:247], v[246:247], v[252:253] op_sel_hi:[1,0]
    v_pk_mul_f32 v[248:249], v[248:249], v[252:253] op_sel_hi:[1,0]
    v_pk_mul_f32 v[250:251], v[250:251], v[252:253] op_sel_hi:[1,0]
    v_cvt_pk_bf16_f32 v148, v240, v241
    v_cvt_pk_bf16_f32 v149, v242, v243
    v_cvt_pk_bf16_f32 v150, v244, v245
    v_cvt_pk_bf16_f32 v151, v246, v247
    buffer_store_dwordx4 v[148:151], v1, s[12:15], s77 offen offset:1024 sc1
    v_cvt_pk_bf16_f32 v158, v248, v249
    v_cvt_pk_bf16_f32 v159, v250, v251
    buffer_store_dwordx4 v[156:159], v2, s[12:15], s77 offen offset:2048 sc1
    s_branch L_B_chk
L_side:
    s_waitcnt vmcnt(0)
    s_cmp_lg_u32 s31, s35
    s_cbranch_scc1 L_side4
    s_sub_u32 s28, s2, 234
    s_mul_i32 s28, s28, 12
    s_mov_b64 exec, 1
    buffer_store_dword v15, v0, s[8:11], s28 offen sc1
    s_mov_b64 exec, -1
L_side4:
L_side5:
    s_cmp_lg_u32 s23, 0
    s_cbranch_scc1 L_backB
    s_branch L_backA
L_preA:
    s_bfe_u32 s28, s20, 0x10001
    s_lshl1_add_u32 s28, s57, s28
    s_add_u32 s28, s28, s26
    s_and_b32 s28, s28, 7
    s_add_u32 s28, s28, 3
    s_lshr_b32 s29, s20, 2
    s_xor_b32 s29, s29, s20
    s_xor_b32 s29, s29, s28
    s_and_b32 s29, s29, s23
    s_cselect_b32 s28, 10, s28
    s_sub_u32 s29, s28, 2
    s_max_i32 s29, s29, 1
    s_cmp_ge_u32 s28, 10
    s_cselect_b32 s29, s28, s29
    s_lshl_b32 s33, s29, 2
    s_sub_u32 s29, s28, s29
    s_lshl_b32 s72, s29, 2
    s_bfm_b64 s[4:5], s72, 4
    s_and_b32 s4, s4, 0x11111111
    s_sub_u32 s72, s29, s4
    s_subb_u32 s73, 0, 0
    s_lshl_b64 s[72:73], s[72:73], s33
    s_add_u32 s4, s72, 0x76543210
    s_addc_u32 s5, s73, 0xa98
    v_lshrrev_b32 v66, 3, v64
    v_bfe_u32 v67, v64, 2, 1
    v_and_b32 v68, 3, v64
    v_lshl_add_u32 v72, v66, 2, v68
    v_mad_u32_u24 v73, v67, 10, v72
    s_lshl_b32 s28, s25, 11
    s_add_u32 s30, s28, 141312
    v_lshl_add_u32 v73, v73, 1, s30
    v_mul_u32_u24 v75, 320, v65
    v_cmp_gt_u32 vcc, 10, v72
    s_add_u32 s28, s30, 1024
    v_mov_b32 v74, s28
    v_add_u32 v75, v75, v73
    v_cndmask_b32 v75, v74, v75, vcc
    v_cndmask_b32 v73, v74, v73, vcc
    v_cndmask_b32 v73, v74, v73, s[60:61]
    v_and_b32 v24, 0x30, v0
    v_add_u32 v27, 154560, v24
    v_mov_b32 v24, v27
    v_subrev_u32 v25, 32, v0
    v_cmp_gt_u32 vcc, 16, v25
    v_lshlrev_b32 v25, 2, v25
    s_cmp_eq_u32 s25, 0
    s_cselect_b64 vcc, vcc, 0
    v_cndmask_b32 v25, v71, v25, vcc
    s_mov_b32 s64, 0x0f000f00
    s_mov_b32 s65, 0x0f000f00
    s_lshl3_add_u32 s69, s22, s24
    s_lshl_b32 s69, s69, 6
    s_add_u32 s69, s69, 327680
    s_lshl_b32 s27, s24, 2
    v_mov_b32 v74, 99
    v_cmp_eq_u32 vcc, v65, v67
    v_and_b32 v30, 1, v72
    v_lshlrev_b32 v30, 4, v30
    v_cndmask_b32 v72, v74, v72, vcc
    v_mov_b32 v74, 0x3f80
    v_lshlrev_b32 v30, v30, v74
    v_lshrrev_b32 v31, 1, v72
    v_mul_u32_u24 v6, 80, v64
    v_mul_u32_u24 v66, 40, v65
    v_add3_u32 v6, v6, v66, s62
    v_and_b32 v66, 1, v70
    v_mul_u32_u24 v66, 40, v66
    v_mul_u32_u24 v14, 80, v69
    v_add3_u32 v14, v14, v66, s62
    v_lshrrev_b32 v66, 1, v70
    v_lshl_add_u32 v7, v66, 3, v14
    v_mul_u32_u24 v66, 960, v65
    v_lshl_add_u32 v28, v64, 4, v66
    v_cmp_ge_u32 vcc, 23, v64
    v_lshl_add_u32 v29, v64, 3, v66
    s_lshl_b32 s28, s58, 4
    v_cndmask_b32 v28, v71, v28, vcc
    v_cndmask_b32 v29, v71, v29, vcc
    s_mul_i32 s66, s28, 1920
    s_add_u32 s66, s66, 360448
    s_mul_i32 s67, s22, 1920
    s_add_u32 s67, s67, s66
    s_lshl_b32 s28, s24, 11
    s_add_u32 s68, s28, 0
    s_lshl_b32 s29, s22, 7
    s_add_u32 s63, s68, s29
    s_waitcnt vmcnt(0)
    ds_read_u16 v40, v75 offset:0
    ds_read_u16 v41, v75 offset:40
    ds_read_u16 v42, v75 offset:80
    ds_read_u16 v43, v75 offset:120
    ds_read_u16 v44, v75 offset:160
    ds_read_u16 v45, v75 offset:200
    ds_read_u16 v46, v75 offset:240
    ds_read_u16 v47, v75 offset:280
    ds_read_u16 v48, v73 offset:640
    ds_read_u16 v49, v73 offset:680
    ds_read_u16 v50, v73 offset:720
    ds_read_u16 v51, v73 offset:760
    v_mov_b32 v22, 0
    v_mov_b32 v23, 0
    s_waitcnt lgkmcnt(11)
    v_lshlrev_b32 v40, 16, v40
    v_mul_f32 v40, 0x3fb8aa3b, v40
    s_waitcnt lgkmcnt(10)
    v_lshlrev_b32 v41, 16, v41
    v_mul_f32 v41, 0x3fb8aa3b, v41
    v_cvt_pk_bf16_f32 v16, v40, v41
    s_waitcnt lgkmcnt(9)
    v_lshlrev_b32 v42, 16, v42
    v_mul_f32 v42, 0x3fb8aa3b, v42
    s_waitcnt lgkmcnt(8)
    v_lshlrev_b32 v43, 16, v43
    v_mul_f32 v43, 0x3fb8aa3b, v43
    v_cvt_pk_bf16_f32 v17, v42, v43
    s_waitcnt lgkmcnt(7)
    v_lshlrev_b32 v44, 16, v44
    v_mul_f32 v44, 0x3fb8aa3b, v44
    s_waitcnt lgkmcnt(6)
    v_lshlrev_b32 v45, 16, v45
    v_mul_f32 v45, 0x3fb8aa3b, v45
    v_cvt_pk_bf16_f32 v18, v44, v45
    s_waitcnt lgkmcnt(5)
    v_lshlrev_b32 v46, 16, v46
    v_mul_f32 v46, 0x3fb8aa3b, v46
    s_waitcnt lgkmcnt(4)
    v_lshlrev_b32 v47, 16, v47
    v_mul_f32 v47, 0x3fb8aa3b, v47
    v_cvt_pk_bf16_f32 v19, v46, v47
    s_waitcnt lgkmcnt(3)
    v_lshlrev_b32 v48, 16, v48
    v_mul_f32 v48, 0x3fb8aa3b, v48
    s_waitcnt lgkmcnt(2)
    v_lshlrev_b32 v49, 16, v49
    v_mul_f32 v49, 0x3fb8aa3b, v49
    v_cvt_pk_bf16_f32 v20, v48, v49
    s_waitcnt lgkmcnt(1)
    v_lshlrev_b32 v50, 16, v50
    v_mul_f32 v50, 0x3fb8aa3b, v50
    s_waitcnt lgkmcnt(0)
    v_lshlrev_b32 v51, 16, v51
    v_mul_f32 v51, 0x3fb8aa3b, v51
    v_cvt_pk_bf16_f32 v21, v50, v51
    s_waitcnt lgkmcnt(0)
    s_barrier
    ds_read_b128 v[32:35], v8 offset:0
    ds_read_b64_tr_b16 v[96:97], v10 offset:0
    ds_read_b64_tr_b16 v[98:99], v10 offset:3840
    ds_read_b64_tr_b16 v[100:101], v10 offset:160
    ds_read_b64_tr_b16 v[102:103], v10 offset:4000
    ds_read_b64_tr_b16 v[104:105], v10 offset:320
    ds_read_b64_tr_b16 v[106:107], v10 offset:4160
    ds_read_b64_tr_b16 v[108:109], v11 offset:0
    ds_read_b64_tr_b16 v[110:111], v11 offset:3840
    ds_read_b128 v[36:39], v8 offset:2048
    ds_read_b128 v[40:43], v8 offset:4096
    ds_read_b128 v[44:47], v8 offset:6144
    ds_read_b128 v[48:51], v8 offset:8192
    ds_read_b128 v[52:55], v8 offset:10240
    ds_read_b128 v[56:59], v8 offset:12288
    ds_read_b128 v[60:63], v8 offset:14336
    s_mov_b64 exec, s[64:65]
    ds_read_b128 v[108:111], v24 offset:0
    s_mov_b64 exec, -1
L_loopA:
    s_waitcnt lgkmcnt(0)
    v_mfma_f32_16x16x32_bf16 v[128:131], v[96:99], v[32:35], v[128:131]
    ds_read_b128 v[64:67], v9 offset:0
    v_mfma_f32_16x16x32_bf16 v[160:163], v[100:103], v[32:35], v[160:163]
    ds_read_b64_tr_b16 v[112:113], v10 offset:15360
    v_mfma_f32_16x16x32_bf16 v[192:195], v[104:107], v[32:35], v[192:195]
    ds_read_b64_tr_b16 v[114:115], v10 offset:19200
    v_mfma_f32_16x16x32_bf16 v[224:227], v[108:111], v[32:35], v[224:227]
    ds_read_b64_tr_b16 v[116:117], v10 offset:15520
    v_mfma_f32_16x16x32_bf16 v[228:231], v[108:111], v[36:39], v[228:231]
    ds_read_b64_tr_b16 v[118:119], v10 offset:19360
    v_mfma_f32_16x16x32_bf16 v[196:199], v[104:107], v[36:39], v[196:199]
    ds_read_b64_tr_b16 v[120:121], v10 offset:15680
    v_mfma_f32_16x16x32_bf16 v[164:167], v[100:103], v[36:39], v[164:167]
    ds_read_b64_tr_b16 v[122:123], v10 offset:19520
    v_mfma_f32_16x16x32_bf16 v[132:135], v[96:99], v[36:39], v[132:135]
    ds_read_b64_tr_b16 v[124:125], v11 offset:15360
    v_mfma_f32_16x16x32_bf16 v[136:139], v[96:99], v[40:43], v[136:139]
    ds_read_b64_tr_b16 v[126:127], v11 offset:19200
    v_mfma_f32_16x16x32_bf16 v[168:171], v[100:103], v[40:43], v[168:171]
    ds_read_b128 v[68:71], v9 offset:2048
    v_mfma_f32_16x16x32_bf16 v[200:203], v[104:107], v[40:43], v[200:203]
    ds_read_b128 v[72:75], v9 offset:4096
    v_mfma_f32_16x16x32_bf16 v[232:235], v[108:111], v[40:43], v[232:235]
    ds_read_b128 v[76:79], v9 offset:6144
    v_mfma_f32_16x16x32_bf16 v[236:239], v[108:111], v[44:47], v[236:239]
    ds_read_b128 v[80:83], v9 offset:8192
    v_mfma_f32_16x16x32_bf16 v[204:207], v[104:107], v[44:47], v[204:207]
    ds_read_b128 v[84:87], v9 offset:10240
    v_mfma_f32_16x16x32_bf16 v[172:175], v[100:103], v[44:47], v[172:175]
    ds_read_b128 v[88:91], v9 offset:12288
    v_mfma_f32_16x16x32_bf16 v[140:143], v[96:99], v[44:47], v[140:143]
    ds_read_b128 v[92:95], v9 offset:14336
    v_mfma_f32_16x16x32_bf16 v[144:147], v[96:99], v[48:51], v[144:147]
    s_mov_b64 exec, s[64:65]
    ds_read_b128 v[124:127], v24 offset:64
    s_mov_b64 exec, -1
    v_mfma_f32_16x16x32_bf16 v[176:179], v[100:103], v[48:51], v[176:179]
    s_lshr_b64 s[4:5], s[4:5], 4
    s_and_b32 s30, s4, 15
    v_mfma_f32_16x16x32_bf16 v[208:211], v[104:107], v[48:51], v[208:211]
    v_lshl_add_u32 v24, s30, 7, v27
    v_mfma_f32_16x16x32_bf16 v[240:243], v[108:111], v[48:51], v[240:243]
    v_mfma_f32_16x16x32_bf16 v[244:247], v[108:111], v[52:55], v[244:247]
    s_bitcmp1_b32 s79, s31
    s_cbranch_scc1 L_side
L_backA:
    v_mfma_f32_16x16x32_bf16 v[212:215], v[104:107], v[52:55], v[212:215]
    v_mfma_f32_16x16x32_bf16 v[180:183], v[100:103], v[52:55], v[180:183]
    v_mfma_f32_16x16x32_bf16 v[148:151], v[96:99], v[52:55], v[148:151]
    v_mfma_f32_16x16x32_bf16 v[152:155], v[96:99], v[56:59], v[152:155]
    v_mfma_f32_16x16x32_bf16 v[184:187], v[100:103], v[56:59], v[184:187]
    v_mfma_f32_16x16x32_bf16 v[216:219], v[104:107], v[56:59], v[216:219]
    v_mfma_f32_16x16x32_bf16 v[248:251], v[108:111], v[56:59], v[248:251]
    v_mfma_f32_16x16x32_bf16 v[252:255], v[108:111], v[60:63], v[252:255]
    v_mfma_f32_16x16x32_bf16 v[220:223], v[104:107], v[60:63], v[220:223]
    v_mfma_f32_16x16x32_bf16 v[188:191], v[100:103], v[60:63], v[188:191]
    v_mfma_f32_16x16x32_bf16 v[156:159], v[96:99], v[60:63], v[156:159]
    s_waitcnt lgkmcnt(0)
    v_mfma_f32_16x16x32_bf16 v[128:131], v[112:115], v[64:67], v[128:131]
    s_add_u32 s32, s32, 1
    s_cmp_eq_u32 s32, 3
    v_mfma_f32_16x16x32_bf16 v[160:163], v[116:119], v[64:67], v[160:163]
    s_cselect_b32 s33, 4294873088, s34
    s_cselect_b32 s32, 0, s32
    v_mfma_f32_16x16x32_bf16 v[192:195], v[120:123], v[64:67], v[192:195]
    v_add_u32 v8, s33, v8
    v_mfma_f32_16x16x32_bf16 v[224:227], v[124:127], v[64:67], v[224:227]
    v_add_u32 v9, s33, v9
    v_mfma_f32_16x16x32_bf16 v[228:231], v[124:127], v[68:71], v[228:231]
    v_add_u32 v10, s33, v10
    v_mfma_f32_16x16x32_bf16 v[196:199], v[120:123], v[68:71], v[196:199]
    v_add_u32 v11, s33, v11
    v_mfma_f32_16x16x32_bf16 v[164:167], v[116:119], v[68:71], v[164:167]
    s_barrier
    ds_read_b128 v[32:35], v8 offset:0
    v_mfma_f32_16x16x32_bf16 v[132:135], v[112:115], v[68:71], v[132:135]
    ds_read_b64_tr_b16 v[96:97], v10 offset:0
    v_mfma_f32_16x16x32_bf16 v[136:139], v[112:115], v[72:75], v[136:139]
    ds_read_b64_tr_b16 v[98:99], v10 offset:3840
    v_mfma_f32_16x16x32_bf16 v[168:171], v[116:119], v[72:75], v[168:171]
    ds_read_b64_tr_b16 v[100:101], v10 offset:160
    v_mfma_f32_16x16x32_bf16 v[200:203], v[120:123], v[72:75], v[200:203]
    ds_read_b64_tr_b16 v[102:103], v10 offset:4000
    v_mfma_f32_16x16x32_bf16 v[232:235], v[124:127], v[72:75], v[232:235]
    ds_read_b64_tr_b16 v[104:105], v10 offset:320
    v_mfma_f32_16x16x32_bf16 v[236:239], v[124:127], v[76:79], v[236:239]
    ds_read_b64_tr_b16 v[106:107], v10 offset:4160
    v_mfma_f32_16x16x32_bf16 v[204:207], v[120:123], v[76:79], v[204:207]
    ds_read_b64_tr_b16 v[108:109], v11 offset:0
    v_mfma_f32_16x16x32_bf16 v[172:175], v[116:119], v[76:79], v[172:175]
    ds_read_b64_tr_b16 v[110:111], v11 offset:3840
    v_mfma_f32_16x16x32_bf16 v[140:143], v[112:115], v[76:79], v[140:143]
    ds_read_b128 v[36:39], v8 offset:2048
    v_mfma_f32_16x16x32_bf16 v[144:147], v[112:115], v[80:83], v[144:147]
    ds_read_b128 v[40:43], v8 offset:4096
    v_mfma_f32_16x16x32_bf16 v[176:179], v[116:119], v[80:83], v[176:179]
    ds_read_b128 v[44:47], v8 offset:6144
    v_mfma_f32_16x16x32_bf16 v[208:211], v[120:123], v[80:83], v[208:211]
    ds_read_b128 v[48:51], v8 offset:8192
    v_mfma_f32_16x16x32_bf16 v[240:243], v[124:127], v[80:83], v[240:243]
    ds_read_b128 v[52:55], v8 offset:10240
    v_mfma_f32_16x16x32_bf16 v[244:247], v[124:127], v[84:87], v[244:247]
    ds_read_b128 v[56:59], v8 offset:12288
    v_mfma_f32_16x16x32_bf16 v[212:215], v[120:123], v[84:87], v[212:215]
    ds_read_b128 v[60:63], v8 offset:14336
    v_mfma_f32_16x16x32_bf16 v[180:183], v[116:119], v[84:87], v[180:183]
    s_mov_b64 exec, s[64:65]
    ds_read_b128 v[108:111], v24 offset:0
    s_mov_b64 exec, -1
    v_mfma_f32_16x16x32_bf16 v[148:151], v[112:115], v[84:87], v[148:151]
    v_mfma_f32_16x16x32_bf16 v[152:155], v[112:115], v[88:91], v[152:155]
    v_mfma_f32_16x16x32_bf16 v[184:187], v[116:119], v[88:91], v[184:187]
    v_mfma_f32_16x16x32_bf16 v[216:219], v[120:123], v[88:91], v[216:219]
    v_mfma_f32_16x16x32_bf16 v[248:251], v[124:127], v[88:91], v[248:251]
    v_mfma_f32_16x16x32_bf16 v[252:255], v[124:127], v[92:95], v[252:255]
    v_mfma_f32_16x16x32_bf16 v[220:223], v[120:123], v[92:95], v[220:223]
    s_add_u32 s31, s31, 1
    s_cmp_lt_u32 s31, 9
    v_mfma_f32_16x16x32_bf16 v[188:191], v[116:119], v[92:95], v[188:191]
    v_mfma_f32_16x16x32_bf16 v[156:159], v[112:115], v[92:95], v[156:159]
    s_cbranch_scc1 L_loopA
    s_waitcnt lgkmcnt(0)
    v_mfma_f32_16x16x32_bf16 v[128:131], v[96:99], v[32:35], v[128:131]
    ds_read_b128 v[64:67], v9 offset:0
    v_mfma_f32_16x16x32_bf16 v[160:163], v[100:103], v[32:35], v[160:163]
    ds_read_b128 v[68:71], v9 offset:2048
    v_mfma_f32_16x16x32_bf16 v[192:195], v[104:107], v[32:35], v[192:195]
    ds_read_b128 v[72:75], v9 offset:4096
    v_mfma_f32_16x16x32_bf16 v[224:227], v[108:111], v[32:35], v[224:227]
    ds_read_b128 v[76:79], v9 offset:6144
    v_mfma_f32_16x16x32_bf16 v[228:231], v[108:111], v[36:39], v[228:231]
    ds_read_b128 v[80:83], v9 offset:8192
    v_mfma_f32_16x16x32_bf16 v[196:199], v[104:107], v[36:39], v[196:199]
    ds_read_b128 v[84:87], v9 offset:10240
    v_mfma_f32_16x16x32_bf16 v[164:167], v[100:103], v[36:39], v[164:167]
    ds_read_b128 v[88:91], v9 offset:12288
    v_mfma_f32_16x16x32_bf16 v[132:135], v[96:99], v[36:39], v[132:135]
    ds_read_b128 v[92:95], v9 offset:14336
    v_mfma_f32_16x16x32_bf16 v[136:139], v[96:99], v[40:43], v[136:139]
    v_mfma_f32_16x16x32_bf16 v[168:171], v[100:103], v[40:43], v[168:171]
    v_bfrev_b32 v12, 1
    v_mfma_f32_16x16x32_bf16 v[200:203], v[104:107], v[40:43], v[200:203]
    v_writelane_b32 v12, s63, 0
    v_mfma_f32_16x16x32_bf16 v[232:235], v[108:111], v[40:43], v[232:235]
    v_mfma_f32_16x16x32_bf16 v[236:239], v[108:111], v[44:47], v[236:239]
    v_mfma_f32_16x16x32_bf16 v[204:207], v[104:107], v[44:47], v[204:207]
    v_mfma_f32_16x16x32_bf16 v[172:175], v[100:103], v[44:47], v[172:175]
    v_mfma_f32_16x16x32_bf16 v[140:143], v[96:99], v[44:47], v[140:143]
    v_mfma_f32_16x16x32_bf16 v[144:147], v[96:99], v[48:51], v[144:147]
    s_barrier
    ds_read_b64_tr_b16 v[112:113], v10 offset:15360
    v_mfma_f32_16x16x32_bf16 v[176:179], v[100:103], v[48:51], v[176:179]
    ds_read_b64_tr_b16 v[114:115], v10 offset:19200
    v_mfma_f32_16x16x32_bf16 v[208:211], v[104:107], v[48:51], v[208:211]
    ds_read_b64_tr_b16 v[116:117], v10 offset:15520
    v_mfma_f32_16x16x32_bf16 v[240:243], v[108:111], v[48:51], v[240:243]
    ds_read_b64_tr_b16 v[118:119], v10 offset:19360
    v_mfma_f32_16x16x32_bf16 v[244:247], v[108:111], v[52:55], v[244:247]
    ds_read_b64_tr_b16 v[120:121], v10 offset:15680
    v_mfma_f32_16x16x32_bf16 v[212:215], v[104:107], v[52:55], v[212:215]
    ds_read_b64_tr_b16 v[122:123], v10 offset:19520
    v_mfma_f32_16x16x32_bf16 v[180:183], v[100:103], v[52:55], v[180:183]
    ds_read_b64_tr_b16 v[124:125], v11 offset:15360
    v_mfma_f32_16x16x32_bf16 v[148:151], v[96:99], v[52:55], v[148:151]
    ds_read_b64_tr_b16 v[126:127], v11 offset:19200
    v_mfma_f32_16x16x32_bf16 v[152:155], v[96:99], v[56:59], v[152:155]
    s_mov_b64 exec, s[64:65]
    ds_read_b128 v[124:127], v24 offset:64
    s_mov_b64 exec, -1
    v_mfma_f32_16x16x32_bf16 v[184:187], v[100:103], v[56:59], v[184:187]
    v_mfma_f32_16x16x32_bf16 v[216:219], v[104:107], v[56:59], v[216:219]
    v_mfma_f32_16x16x32_bf16 v[248:251], v[108:111], v[56:59], v[248:251]
    v_mfma_f32_16x16x32_bf16 v[252:255], v[108:111], v[60:63], v[252:255]
    v_mfma_f32_16x16x32_bf16 v[220:223], v[104:107], v[60:63], v[220:223]
    v_mfma_f32_16x16x32_bf16 v[188:191], v[100:103], v[60:63], v[188:191]
    v_mfma_f32_16x16x32_bf16 v[156:159], v[96:99], v[60:63], v[156:159]
    s_waitcnt vmcnt(0) lgkmcnt(0)
    s_barrier
    v_mfma_f32_16x16x32_bf16 v[160:163], v[116:119], v[64:67], v[160:163]
    v_mov_b32 v10, 0
    v_mov_b32 v13, 1
    v_mfma_f32_16x16x32_bf16 v[164:167], v[116:119], v[68:71], v[164:167]
    v_mfma_f32_16x16x32_bf16 v[168:171], v[116:119], v[72:75], v[168:171]
    v_mfma_f32_16x16x32_bf16 v[172:175], v[116:119], v[76:79], v[172:175]
    v_mfma_f32_16x16x32_bf16 v[224:227], v[124:127], v[64:67], v[224:227]
    v_mfma_f32_16x16x32_bf16 v[192:195], v[120:123], v[64:67], v[192:195]
    s_nop 0
    v_cvt_pk_bf16_f32 v32, v160, v161
    v_mfma_f32_16x16x32_bf16 v[228:231], v[124:127], v[68:71], v[228:231]
    v_cvt_pk_bf16_f32 v33, v162, v163
    v_mfma_f32_16x16x32_bf16 v[196:199], v[120:123], v[68:71], v[196:199]
    v_cvt_pk_bf16_f32 v34, v164, v165
    v_cvt_pk_bf16_f32 v35, v166, v167
    v_cvt_pk_bf16_f32 v36, v168, v169
    v_permlane16_swap_b32 v32, v34
    v_permlane16_swap_b32 v33, v35
    v_cvt_pk_bf16_f32 v38, v172, v173
    v_cvt_pk_bf16_f32 v37, v170, v171
    v_cvt_pk_bf16_f32 v39, v174, v175
    v_mfma_f32_32x32x16_bf16 v[160:175], v[16:19], v[32:35], 0
    v_cvt_pk_bf16_f32 v56, v224, v225
    v_cvt_pk_bf16_f32 v48, v228, v229
    v_cvt_pk_bf16_f32 v57, v226, v227
    v_cvt_pk_bf16_f32 v49, v230, v231
    v_permlane16_swap_b32 v56, v48
    v_mfma_f32_16x16x32_bf16 v[128:131], v[112:115], v[64:67], v[128:131]
    v_cvt_pk_bf16_f32 v64, v192, v193
    v_cvt_pk_bf16_f32 v66, v196, v197
    v_cvt_pk_bf16_f32 v65, v194, v195
    v_cvt_pk_bf16_f32 v67, v198, v199
    v_permlane16_swap_b32 v57, v49
    v_permlane16_swap_b32 v64, v66
    v_permlane16_swap_b32 v65, v67
    v_mfma_f32_32x32x16_bf16 v[160:175], v[20:23], v[48:51], v[160:175]
    ds_write_b128 v3, v[64:67]
    v_permlane16_swap_b32 v36, v38
    v_permlane16_swap_b32 v37, v39
    v_mfma_f32_16x16x32_bf16 v[232:235], v[124:127], v[72:75], v[232:235]
    v_mfma_f32_16x16x32_bf16 v[236:239], v[124:127], v[76:79], v[236:239]
    v_mfma_f32_16x16x32_bf16 v[240:243], v[124:127], v[80:83], v[240:243]
    v_mfma_f32_16x16x32_bf16 v[244:247], v[124:127], v[84:87], v[244:247]
    v_mfma_f32_16x16x32_bf16 v[248:251], v[124:127], v[88:91], v[248:251]
    v_mfma_f32_16x16x32_bf16 v[252:255], v[124:127], v[92:95], v[252:255]
    v_mfma_f32_16x16x32_bf16 v[200:203], v[120:123], v[72:75], v[200:203]
    v_mfma_f32_16x16x32_bf16 v[204:207], v[120:123], v[76:79], v[204:207]
    s_nop 0
    v_exp_f32_e64 v225, -v161
    v_mfma_f32_16x16x32_bf16 v[208:211], v[120:123], v[80:83], v[208:211]
    v_exp_f32_e64 v226, -v162
    v_mfma_f32_16x16x32_bf16 v[212:215], v[120:123], v[84:87], v[212:215]
    v_exp_f32_e64 v227, -v163
    v_mfma_f32_16x16x32_bf16 v[216:219], v[120:123], v[88:91], v[216:219]
    s_set_gpr_idx_on s27, gpr_idx(SRC0)
    v_mov_b32 v26, v224
    s_set_gpr_idx_off
    v_exp_f32_e64 v224, -v160
    v_mfma_f32_16x16x32_bf16 v[220:223], v[120:123], v[92:95], v[220:223]
    v_cndmask_b32 v120, v48, v15, s[60:61]
    v_cndmask_b32 v121, v49, v15, s[60:61]
    ds_write_b64 v4, v[120:121]
    v_exp_f32 v160, v160
    v_exp_f32 v161, v161
    v_exp_f32 v162, v162
    v_exp_f32 v163, v163
    v_exp_f32_e64 v228, -v164
    v_exp_f32_e64 v229, -v165
    v_exp_f32 v164, v164
    v_exp_f32 v165, v165
    v_exp_f32_e64 v230, -v166
    v_exp_f32_e64 v231, -v167
    v_exp_f32 v166, v166
    v_exp_f32 v167, v167
    v_pk_add_f32 v[170:171], v[160:161], v[162:163]
    v_pk_add_f32 v[172:173], v[224:225], v[226:227]
    v_cvt_pk_bf16_f32 v58, v232, v233
    v_exp_f32_e64 v232, -v168
    v_exp_f32_e64 v233, -v169
    v_exp_f32 v168, v168
    v_exp_f32 v169, v169
    v_pk_add_f32 v[170:171], v[170:171], v[164:165]
    v_pk_add_f32 v[172:173], v[172:173], v[228:229]
    v_pk_add_f32 v[170:171], v[170:171], v[166:167]
    v_pk_add_f32 v[172:173], v[172:173], v[230:231]
    v_pk_add_f32 v[170:171], v[170:171], v[168:169]
    v_pk_add_f32 v[172:173], v[172:173], v[232:233]
    ds_read_b64_tr_b16 v[104:105], v5 offset:0
    v_add_f32 v170, v170, v171
    v_add_f32 v172, v172, v173
    ds_read_b64_tr_b16 v[106:107], v5 offset:384
    v_mfma_f32_16x16x32_bf16 v[176:179], v[116:119], v[80:83], v[176:179]
    v_permlane32_swap_b32 v170, v172
    v_add_f32 v170, v170, v172
    v_max_u32 v10, v10, v170
    v_rcp_f32 v170, v170
    v_mfma_f32_16x16x32_bf16 v[180:183], v[116:119], v[84:87], v[180:183]
    v_mov_b32 v172, v170
    v_cvt_pk_bf16_f32 v52, v244, v245
    v_mfma_f32_16x16x32_bf16 v[184:187], v[116:119], v[88:91], v[184:187]
    v_permlane32_swap_b32 v170, v172
    v_mfma_f32_16x16x32_bf16 v[188:191], v[116:119], v[92:95], v[188:191]
    ds_read_b64_tr_b16 v[116:117], v5 offset:768
    ds_read_b64_tr_b16 v[118:119], v5 offset:1152
    v_cvt_pk_bf16_f32 v53, v246, v247
    v_cvt_pk_bf16_f32 v62, v248, v249
    v_pk_mul_f32 v[160:161], v[160:161], v[170:171] op_sel_hi:[1,0]
    v_pk_mul_f32 v[162:163], v[162:163], v[170:171] op_sel_hi:[1,0]
    v_cvt_pk_bf16_f32 v244, v160, v161
    v_cvt_pk_bf16_f32 v245, v162, v163
    ds_write_b64 v6, v[244:245] offset:0
    v_pk_mul_f32 v[164:165], v[164:165], v[170:171] op_sel_hi:[1,0]
    v_pk_mul_f32 v[166:167], v[166:167], v[170:171] op_sel_hi:[1,0]
    v_cvt_pk_bf16_f32 v246, v164, v165
    v_cvt_pk_bf16_f32 v247, v166, v167
    ds_write_b64 v6, v[246:247] offset:8
    v_pk_mul_f32 v[168:169], v[168:169], v[170:171] op_sel_hi:[1,0]
    v_pk_mul_f32 v[224:225], v[224:225], v[172:173] op_sel_hi:[1,0]
    v_cvt_pk_bf16_f32 v248, v168, v169
    v_cvt_pk_bf16_f32 v249, v224, v225
    ds_write_b64 v6, v[248:249] offset:16
    v_pk_mul_f32 v[226:227], v[226:227], v[172:173] op_sel_hi:[1,0]
    v_pk_mul_f32 v[228:229], v[228:229], v[172:173] op_sel_hi:[1,0]
    v_cvt_pk_bf16_f32 v63, v250, v251
    v_cvt_pk_bf16_f32 v250, v226, v227
    v_cvt_pk_bf16_f32 v251, v228, v229
    ds_write_b64 v6, v[250:251] offset:24
    v_pk_mul_f32 v[230:231], v[230:231], v[172:173] op_sel_hi:[1,0]
    v_pk_mul_f32 v[232:233], v[232:233], v[172:173] op_sel_hi:[1,0]
    v_cvt_pk_bf16_f32 v54, v252, v253
    v_cvt_pk_bf16_f32 v252, v230, v231
    v_cvt_pk_bf16_f32 v253, v232, v233
    ds_write_b64 v6, v[252:253] offset:32
    v_mfma_f32_16x16x32_bf16 v[132:135], v[112:115], v[68:71], v[132:135]
    v_cvt_pk_bf16_f32 v40, v176, v177
    ds_read_b64_tr_b16 v[96:97], v7 offset:0
    v_mfma_f32_16x16x32_bf16 v[136:139], v[112:115], v[72:75], v[136:139]
    ds_read_b64_tr_b16 v[100:101], v14 offset:32
    v_mfma_f32_16x16x32_bf16 v[140:143], v[112:115], v[76:79], v[140:143]
    ds_read_b64_tr_b16 v[98:99], v7 offset:640
    v_cvt_pk_bf16_f32 v42, v180, v181
    v_mfma_f32_16x16x32_bf16 v[144:147], v[112:115], v[80:83], v[144:147]
    ds_read_b64_tr_b16 v[102:103], v14 offset:672
    v_cvt_pk_bf16_f32 v41, v178, v179
    ds_read_b64_tr_b16 v[108:109], v7 offset:1280
    v_mfma_f32_16x16x32_bf16 v[148:151], v[112:115], v[84:87], v[148:151]
    v_cvt_pk_bf16_f32 v43, v182, v183
    v_mfma_f32_16x16x32_bf16 v[152:155], v[112:115], v[88:91], v[152:155]
    v_cvt_pk_bf16_f32 v44, v184, v185
    v_mfma_f32_16x16x32_bf16 v[156:159], v[112:115], v[92:95], v[156:159]
    ds_read_b64_tr_b16 v[112:113], v14 offset:1312
    v_cvt_pk_bf16_f32 v46, v188, v189
    v_cvt_pk_bf16_f32 v45, v186, v187
    v_cvt_pk_bf16_f32 v47, v190, v191
    v_mfma_f32_32x32x16_bf16 v[176:191], v[16:19], v[36:39], 0
    ds_read_b64_tr_b16 v[110:111], v7 offset:1920
    ds_read_b64_tr_b16 v[114:115], v14 offset:1952
    v_cvt_pk_bf16_f32 v50, v236, v237
    v_cvt_pk_bf16_f32 v59, v234, v235
    v_cvt_pk_bf16_f32 v51, v238, v239
    v_cvt_pk_bf16_f32 v68, v200, v201
    v_cvt_pk_bf16_f32 v70, v204, v205
    v_cvt_pk_bf16_f32 v69, v202, v203
    v_cvt_pk_bf16_f32 v71, v206, v207
    v_permlane16_swap_b32 v58, v50
    v_permlane16_swap_b32 v59, v51
    v_permlane16_swap_b32 v68, v70
    v_permlane16_swap_b32 v69, v71
    v_mfma_f32_32x32x16_bf16 v[176:191], v[20:23], v[50:53], v[176:191]
    ds_write_b128 v3, v[68:71]
    v_cndmask_b32 v122, v50, v15, s[60:61]
    v_cndmask_b32 v123, v51, v15, s[60:61]
    v_cvt_pk_bf16_f32 v60, v240, v241
    v_cvt_pk_bf16_f32 v61, v242, v243
    v_cvt_pk_bf16_f32 v72, v208, v209
    ds_write_b64 v4, v[122:123]
    v_cvt_pk_bf16_f32 v74, v212, v213
    v_cvt_pk_bf16_f32 v73, v210, v211
    v_cvt_pk_bf16_f32 v75, v214, v215
    v_cvt_pk_bf16_f32 v76, v216, v217
    v_cvt_pk_bf16_f32 v78, v220, v221
    v_exp_f32_e64 v234, -v176
    v_exp_f32_e64 v235, -v177
    v_exp_f32_e64 v236, -v178
    v_exp_f32_e64 v237, -v179
    v_exp_f32 v176, v176
    v_exp_f32 v177, v177
    v_exp_f32 v178, v178
    v_exp_f32 v179, v179
    v_exp_f32_e64 v238, -v180
    v_exp_f32_e64 v239, -v181
    v_exp_f32 v180, v180
    v_exp_f32 v181, v181
    v_exp_f32_e64 v240, -v182
    v_exp_f32_e64 v241, -v183
    v_exp_f32 v182, v182
    v_exp_f32 v183, v183
    v_pk_add_f32 v[186:187], v[176:177], v[178:179]
    v_pk_add_f32 v[188:189], v[234:235], v[236:237]
    v_exp_f32_e64 v242, -v184
    v_exp_f32_e64 v243, -v185
    v_exp_f32 v184, v184
    v_exp_f32 v185, v185
    v_pk_add_f32 v[186:187], v[186:187], v[180:181]
    v_pk_add_f32 v[188:189], v[188:189], v[238:239]
    v_cvt_pk_bf16_f32 v77, v218, v219
    v_cvt_pk_bf16_f32 v79, v222, v223
    s_waitcnt lgkmcnt(0)
    v_mfma_f32_32x32x16_bf16 v[192:207], v[96:99], v[104:107], 0
    v_permlane16_swap_b32 v40, v42
    v_permlane16_swap_b32 v41, v43
    v_permlane16_swap_b32 v60, v52
    v_mfma_f32_32x32x16_bf16 v[208:223], v[100:103], v[104:107], 0
    ds_read_b64_tr_b16 v[104:105], v5 offset:0
    ds_read_b64_tr_b16 v[106:107], v5 offset:384
    v_permlane16_swap_b32 v61, v53
    v_permlane16_swap_b32 v72, v74
    v_mfma_f32_32x32x16_bf16 v[192:207], v[108:111], v[116:119], v[192:207]
    v_permlane16_swap_b32 v73, v75
    v_cndmask_b32 v120, v52, v15, s[60:61]
    v_cndmask_b32 v121, v53, v15, s[60:61]
    v_permlane16_swap_b32 v44, v46
    v_mfma_f32_32x32x16_bf16 v[208:223], v[112:115], v[116:119], v[208:223]
    ds_read_b64_tr_b16 v[116:117], v5 offset:768
    ds_read_b64_tr_b16 v[118:119], v5 offset:1152
    v_permlane16_swap_b32 v45, v47
    v_cvt_pk_bf16_f32 v55, v254, v255
    v_mfma_f32_32x32x16_bf16 v[160:175], v[16:19], v[40:43], 0
    v_permlane16_swap_b32 v62, v54
    v_permlane16_swap_b32 v63, v55
    v_permlane16_swap_b32 v76, v78
    v_mfma_f32_32x32x16_bf16 v[160:175], v[20:23], v[52:55], v[160:175]
    v_permlane16_swap_b32 v77, v79
    v_cndmask_b32 v122, v54, v15, s[60:61]
    v_cndmask_b32 v123, v55, v15, s[60:61]
    v_cvt_pk_bf16_f32 v80, v128, v129
    v_cvt_pk_bf16_f32 v82, v132, v133
    v_cvt_pk_bf16_f32 v81, v130, v131
    v_pk_add_f32 v[186:187], v[186:187], v[182:183]
    v_pk_add_f32 v[188:189], v[188:189], v[240:241]
    v_pk_add_f32 v[186:187], v[186:187], v[184:185]
    v_pk_add_f32 v[188:189], v[188:189], v[242:243]
    v_add_f32 v186, v186, v187
    v_add_f32 v188, v188, v189
    v_exp_f32_e64 v224, -v160
    v_exp_f32_e64 v225, -v161
    v_permlane32_swap_b32 v186, v188
    v_add_f32 v186, v186, v188
    v_max_u32 v10, v10, v186
    v_rcp_f32 v186, v186
    v_exp_f32_e64 v226, -v162
    v_mov_b32 v188, v186
    v_exp_f32_e64 v227, -v163
    v_exp_f32 v160, v160
    v_permlane32_swap_b32 v186, v188
    v_pk_mul_f32 v[176:177], v[176:177], v[186:187] op_sel_hi:[1,0]
    v_pk_mul_f32 v[178:179], v[178:179], v[186:187] op_sel_hi:[1,0]
    v_cvt_pk_bf16_f32 v244, v176, v177
    v_cvt_pk_bf16_f32 v245, v178, v179
    ds_write_b64 v6, v[244:245] offset:0
    v_pk_mul_f32 v[180:181], v[180:181], v[186:187] op_sel_hi:[1,0]
    v_pk_mul_f32 v[182:183], v[182:183], v[186:187] op_sel_hi:[1,0]
    v_cvt_pk_bf16_f32 v246, v180, v181
    v_cvt_pk_bf16_f32 v247, v182, v183
    ds_write_b64 v6, v[246:247] offset:8
    v_pk_mul_f32 v[184:185], v[184:185], v[186:187] op_sel_hi:[1,0]
    v_pk_mul_f32 v[234:235], v[234:235], v[188:189] op_sel_hi:[1,0]
    v_cvt_pk_bf16_f32 v248, v184, v185
    v_cvt_pk_bf16_f32 v249, v234, v235
    ds_write_b64 v6, v[248:249] offset:16
    v_pk_mul_f32 v[236:237], v[236:237], v[188:189] op_sel_hi:[1,0]
    v_pk_mul_f32 v[238:239], v[238:239], v[188:189] op_sel_hi:[1,0]
    v_cvt_pk_bf16_f32 v250, v236, v237
    v_cvt_pk_bf16_f32 v251, v238, v239
    ds_write_b64 v6, v[250:251] offset:24
    v_pk_mul_f32 v[240:241], v[240:241], v[188:189] op_sel_hi:[1,0]
    v_pk_mul_f32 v[242:243], v[242:243], v[188:189] op_sel_hi:[1,0]
    v_cvt_pk_bf16_f32 v252, v240, v241
    v_cvt_pk_bf16_f32 v253, v242, v243
    ds_write_b64 v6, v[252:253] offset:32
    v_exp_f32 v161, v161
    v_exp_f32 v162, v162
    v_exp_f32 v163, v163
    ds_read_b64_tr_b16 v[96:97], v7 offset:0
    v_exp_f32_e64 v228, -v164
    ds_read_b64_tr_b16 v[100:101], v14 offset:32
    v_exp_f32_e64 v229, -v165
    ds_read_b64_tr_b16 v[98:99], v7 offset:640
    v_exp_f32 v164, v164
    ds_read_b64_tr_b16 v[102:103], v14 offset:672
    v_exp_f32 v165, v165
    ds_read_b64_tr_b16 v[108:109], v7 offset:1280
    v_exp_f32_e64 v230, -v166
    ds_read_b64_tr_b16 v[112:113], v14 offset:1312
    v_exp_f32_e64 v231, -v167
    ds_read_b64_tr_b16 v[110:111], v7 offset:1920
    v_exp_f32 v166, v166
    ds_read_b64_tr_b16 v[114:115], v14 offset:1952
    v_exp_f32 v167, v167
    ds_write_b128 v3, v[72:75]
    v_pk_add_f32 v[170:171], v[160:161], v[162:163]
    v_pk_add_f32 v[172:173], v[224:225], v[226:227]
    v_exp_f32_e64 v232, -v168
    v_exp_f32_e64 v233, -v169
    v_exp_f32 v168, v168
    v_exp_f32 v169, v169
    v_pk_add_f32 v[170:171], v[170:171], v[164:165]
    ds_write_b64 v4, v[120:121]
    v_pk_add_f32 v[172:173], v[172:173], v[228:229]
    s_waitcnt lgkmcnt(7)
    v_mfma_f32_32x32x16_bf16 v[192:207], v[96:99], v[104:107], v[192:207]
    v_cvt_pk_bf16_f32 v83, v134, v135
    v_cvt_pk_bf16_f32 v84, v136, v137
    v_cvt_pk_bf16_f32 v86, v140, v141
    v_cvt_pk_bf16_f32 v85, v138, v139
    v_cvt_pk_bf16_f32 v87, v142, v143
    s_waitcnt lgkmcnt(6)
    v_mfma_f32_32x32x16_bf16 v[208:223], v[100:103], v[104:107], v[208:223]
    ds_read_b64_tr_b16 v[104:105], v5 offset:0
    ds_read_b64_tr_b16 v[106:107], v5 offset:384
    v_cvt_pk_bf16_f32 v88, v144, v145
    v_cvt_pk_bf16_f32 v90, v148, v149
    v_cvt_pk_bf16_f32 v89, v146, v147
    s_waitcnt lgkmcnt(5)
    v_mfma_f32_32x32x16_bf16 v[192:207], v[108:111], v[116:119], v[192:207]
    v_cvt_pk_bf16_f32 v91, v150, v151
    v_cvt_pk_bf16_f32 v92, v152, v153
    v_cvt_pk_bf16_f32 v94, v156, v157
    v_cvt_pk_bf16_f32 v93, v154, v155
    v_cvt_pk_bf16_f32 v95, v158, v159
    s_waitcnt lgkmcnt(4)
    v_mfma_f32_32x32x16_bf16 v[208:223], v[112:115], v[116:119], v[208:223]
    ds_read_b64_tr_b16 v[116:117], v5 offset:768
    ds_read_b64_tr_b16 v[118:119], v5 offset:1152
    v_permlane16_swap_b32 v80, v82
    v_permlane16_swap_b32 v81, v83
    v_mfma_f32_32x32x16_bf16 v[176:191], v[16:19], v[44:47], 0
    v_permlane16_swap_b32 v84, v86
    v_permlane16_swap_b32 v85, v87
    v_permlane16_swap_b32 v88, v90
    v_mfma_f32_32x32x16_bf16 v[176:191], v[20:23], v[54:57], v[176:191]
    v_permlane16_swap_b32 v89, v91
    v_permlane16_swap_b32 v92, v94
    v_permlane16_swap_b32 v93, v95
    buffer_store_dword v26, v25, s[12:15], s69 offen sc1
    v_pk_add_f32 v[170:171], v[170:171], v[166:167]
    v_pk_add_f32 v[172:173], v[172:173], v[230:231]
    v_pk_add_f32 v[170:171], v[170:171], v[168:169]
    v_pk_add_f32 v[172:173], v[172:173], v[232:233]
    v_add_f32 v170, v170, v171
    v_add_f32 v172, v172, v173
    s_nop 1
    v_permlane32_swap_b32 v170, v172
    v_add_f32 v170, v170, v172
    v_max_u32 v10, v10, v170
    v_rcp_f32 v170, v170
    v_exp_f32_e64 v234, -v176
    v_mov_b32 v172, v170
    v_exp_f32_e64 v235, -v177
    v_exp_f32_e64 v236, -v178
    v_permlane32_swap_b32 v170, v172
    v_pk_mul_f32 v[160:161], v[160:161], v[170:171] op_sel_hi:[1,0]
    v_pk_mul_f32 v[162:163], v[162:163], v[170:171] op_sel_hi:[1,0]
    v_cvt_pk_bf16_f32 v244, v160, v161
    v_cvt_pk_bf16_f32 v245, v162, v163
    ds_write_b64 v6, v[244:245] offset:0
    v_pk_mul_f32 v[164:165], v[164:165], v[170:171] op_sel_hi:[1,0]
    v_pk_mul_f32 v[166:167], v[166:167], v[170:171] op_sel_hi:[1,0]
    v_cvt_pk_bf16_f32 v246, v164, v165
    v_cvt_pk_bf16_f32 v247, v166, v167
    ds_write_b64 v6, v[246:247] offset:8
    v_pk_mul_f32 v[168:169], v[168:169], v[170:171] op_sel_hi:[1,0]
    v_pk_mul_f32 v[224:225], v[224:225], v[172:173] op_sel_hi:[1,0]
    v_cvt_pk_bf16_f32 v248, v168, v169
    v_cvt_pk_bf16_f32 v249, v224, v225
    ds_write_b64 v6, v[248:249] offset:16
    v_pk_mul_f32 v[226:227], v[226:227], v[172:173] op_sel_hi:[1,0]
    v_pk_mul_f32 v[228:229], v[228:229], v[172:173] op_sel_hi:[1,0]
    v_cvt_pk_bf16_f32 v250, v226, v227
    v_cvt_pk_bf16_f32 v251, v228, v229
    ds_write_b64 v6, v[250:251] offset:24
    v_pk_mul_f32 v[230:231], v[230:231], v[172:173] op_sel_hi:[1,0]
    v_pk_mul_f32 v[232:233], v[232:233], v[172:173] op_sel_hi:[1,0]
    v_cvt_pk_bf16_f32 v252, v230, v231
    v_cvt_pk_bf16_f32 v253, v232, v233
    ds_write_b64 v6, v[252:253] offset:32
    v_exp_f32_e64 v237, -v179
    v_exp_f32 v176, v176
    v_exp_f32 v177, v177
    ds_read_b64_tr_b16 v[96:97], v7 offset:0
    v_exp_f32 v178, v178
    ds_read_b64_tr_b16 v[100:101], v14 offset:32
    v_exp_f32 v179, v179
    ds_read_b64_tr_b16 v[98:99], v7 offset:640
    v_exp_f32_e64 v238, -v180
    ds_read_b64_tr_b16 v[102:103], v14 offset:672
    v_exp_f32_e64 v239, -v181
    ds_read_b64_tr_b16 v[108:109], v7 offset:1280
    v_exp_f32 v180, v180
    ds_read_b64_tr_b16 v[112:113], v14 offset:1312
    v_exp_f32 v181, v181
    ds_read_b64_tr_b16 v[110:111], v7 offset:1920
    v_exp_f32_e64 v240, -v182
    ds_read_b64_tr_b16 v[114:115], v14 offset:1952
    v_exp_f32_e64 v241, -v183
    ds_write_b128 v3, v[76:79]
    v_exp_f32 v182, v182
    v_exp_f32 v183, v183
    v_pk_add_f32 v[186:187], v[176:177], v[178:179]
    v_pk_add_f32 v[188:189], v[234:235], v[236:237]
    v_exp_f32_e64 v242, -v184
    v_exp_f32_e64 v243, -v185
    v_exp_f32 v184, v184
    ds_write_b64 v4, v[122:123]
    v_exp_f32 v185, v185
    v_pk_add_f32 v[186:187], v[186:187], v[180:181]
    v_pk_add_f32 v[188:189], v[188:189], v[238:239]
    s_waitcnt lgkmcnt(7)
    v_mfma_f32_32x32x16_bf16 v[192:207], v[96:99], v[104:107], v[192:207]
    s_waitcnt lgkmcnt(6)
    v_mfma_f32_32x32x16_bf16 v[208:223], v[100:103], v[104:107], v[208:223]
    ds_read_b64_tr_b16 v[104:105], v5 offset:0
    ds_read_b64_tr_b16 v[106:107], v5 offset:384
    s_waitcnt lgkmcnt(5)
    v_mfma_f32_32x32x16_bf16 v[192:207], v[108:111], v[116:119], v[192:207]
    s_waitcnt lgkmcnt(3)
    v_mfma_f32_32x32x16_bf16 v[208:223], v[112:115], v[116:119], v[208:223]
    ds_read_b64_tr_b16 v[116:117], v5 offset:768
    ds_read_b64_tr_b16 v[118:119], v5 offset:1152
    v_mfma_f32_32x32x16_bf16 v[160:175], v[16:19], v[80:83], 0
    v_mfma_f32_32x32x16_bf16 v[160:175], v[20:23], v[56:59], v[160:175]
    v_pk_add_f32 v[186:187], v[186:187], v[182:183]
    v_pk_add_f32 v[188:189], v[188:189], v[240:241]
    v_pk_add_f32 v[186:187], v[186:187], v[184:185]
    v_pk_add_f32 v[188:189], v[188:189], v[242:243]
    v_add_f32 v186, v186, v187
    v_add_f32 v188, v188, v189
    s_nop 1
    v_permlane32_swap_b32 v186, v188
    v_add_f32 v186, v186, v188
    v_max_u32 v10, v10, v186
    v_rcp_f32 v186, v186
    v_cmp_le_u32 vcc, 0x5d800000, v10
    v_mov_b32 v188, v186
    v_exp_f32_e64 v224, -v160
    v_exp_f32_e64 v225, -v161
    v_permlane32_swap_b32 v186, v188
    v_pk_mul_f32 v[176:177], v[176:177], v[186:187] op_sel_hi:[1,0]
    v_pk_mul_f32 v[178:179], v[178:179], v[186:187] op_sel_hi:[1,0]
    v_cvt_pk_bf16_f32 v244, v176, v177
    v_cvt_pk_bf16_f32 v245, v178, v179
    ds_write_b64 v6, v[244:245] offset:0
    v_pk_mul_f32 v[180:181], v[180:181], v[186:187] op_sel_hi:[1,0]
    v_pk_mul_f32 v[182:183], v[182:183], v[186:187] op_sel_hi:[1,0]
    v_cvt_pk_bf16_f32 v246, v180, v181
    v_cvt_pk_bf16_f32 v247, v182, v183
    ds_write_b64 v6, v[246:247] offset:8
    v_pk_mul_f32 v[184:185], v[184:185], v[186:187] op_sel_hi:[1,0]
    v_pk_mul_f32 v[234:235], v[234:235], v[188:189] op_sel_hi:[1,0]
    v_cvt_pk_bf16_f32 v248, v184, v185
    v_cvt_pk_bf16_f32 v249, v234, v235
    ds_write_b64 v6, v[248:249] offset:16
    v_pk_mul_f32 v[236:237], v[236:237], v[188:189] op_sel_hi:[1,0]
    v_pk_mul_f32 v[238:239], v[238:239], v[188:189] op_sel_hi:[1,0]
    v_cvt_pk_bf16_f32 v250, v236, v237
    v_cvt_pk_bf16_f32 v251, v238, v239
    ds_write_b64 v6, v[250:251] offset:24
    v_pk_mul_f32 v[240:241], v[240:241], v[188:189] op_sel_hi:[1,0]
    v_pk_mul_f32 v[242:243], v[242:243], v[188:189] op_sel_hi:[1,0]
    v_cvt_pk_bf16_f32 v252, v240, v241
    v_cvt_pk_bf16_f32 v253, v242, v243
    ds_write_b64 v6, v[252:253] offset:32
    v_mfma_f32_32x32x16_bf16 v[176:191], v[16:19], v[84:87], 0
    v_exp_f32_e64 v226, -v162
    v_exp_f32_e64 v227, -v163
    ds_read_b64_tr_b16 v[96:97], v7 offset:0
    v_mfma_f32_32x32x16_bf16 v[176:191], v[20:23], v[58:61], v[176:191]
    ds_read_b64_tr_b16 v[100:101], v14 offset:32
    v_exp_f32 v160, v160
    ds_read_b64_tr_b16 v[98:99], v7 offset:640
    v_exp_f32 v161, v161
    ds_read_b64_tr_b16 v[102:103], v14 offset:672
    v_exp_f32 v162, v162
    ds_read_b64_tr_b16 v[108:109], v7 offset:1280
    v_exp_f32 v163, v163
    ds_read_b64_tr_b16 v[112:113], v14 offset:1312
    v_exp_f32_e64 v228, -v164
    ds_read_b64_tr_b16 v[110:111], v7 offset:1920
    v_exp_f32_e64 v229, -v165
    ds_read_b64_tr_b16 v[114:115], v14 offset:1952
    v_exp_f32_e64 v234, -v176
    v_exp_f32_e64 v235, -v177
    v_exp_f32_e64 v236, -v178
    v_exp_f32_e64 v237, -v179
    v_exp_f32 v176, v176
    s_waitcnt lgkmcnt(5)
    v_mfma_f32_32x32x16_bf16 v[192:207], v[96:99], v[104:107], v[192:207]
    v_exp_f32 v177, v177
    v_exp_f32 v178, v178
    v_exp_f32 v179, v179
    s_waitcnt lgkmcnt(4)
    v_mfma_f32_32x32x16_bf16 v[208:223], v[100:103], v[104:107], v[208:223]
    v_exp_f32 v164, v164
    v_exp_f32 v165, v165
    v_exp_f32_e64 v238, -v180
    s_waitcnt lgkmcnt(1)
    v_mfma_f32_32x32x16_bf16 v[192:207], v[108:111], v[116:119], v[192:207]
    v_exp_f32_e64 v239, -v181
    v_exp_f32_e64 v230, -v166
    v_exp_f32_e64 v231, -v167
    s_waitcnt lgkmcnt(0)
    v_mfma_f32_32x32x16_bf16 v[208:223], v[112:115], v[116:119], v[208:223]
    v_exp_f32 v180, v180
    v_exp_f32 v181, v181
    v_exp_f32 v166, v166
    v_exp_f32 v167, v167
    v_pk_add_f32 v[170:171], v[160:161], v[162:163]
    v_pk_add_f32 v[172:173], v[224:225], v[226:227]
    v_exp_f32_e64 v240, -v182
    v_cvt_pk_bf16_f32 v244, v192, v193
    v_cvt_pk_bf16_f32 v245, v194, v195
    v_cvt_pk_bf16_f32 v246, v196, v197
    v_cvt_pk_bf16_f32 v247, v198, v199
    v_cvt_pk_bf16_f32 v248, v200, v201
    v_cvt_pk_bf16_f32 v249, v202, v203
    v_cvt_pk_bf16_f32 v250, v204, v205
    v_cvt_pk_bf16_f32 v251, v206, v207
    v_cvt_pk_bf16_f32 v252, v208, v209
    v_cvt_pk_bf16_f32 v253, v210, v211
    buffer_store_dwordx4 v[244:247], v28, s[12:15], s67 offen sc1
    buffer_store_dwordx4 v[248:251], v28, s[12:15], s67 offen offset:576 sc1
    buffer_store_dwordx2 v[252:253], v29, s[12:15], s67 offen offset:384 sc1
    s_cbranch_vccnz L_A_slow
    v_mov_b32 v9, 163776
    s_mov_b64 exec, 1
    ds_add_u32 v9, v13 offset:0
    s_mov_b64 exec, -1
    v_exp_f32_e64 v241, -v183
    v_exp_f32_e64 v232, -v168
    v_exp_f32_e64 v233, -v169
    v_exp_f32 v182, v182
    v_exp_f32 v183, v183
    v_exp_f32 v168, v168
    v_exp_f32 v169, v169
    v_pk_add_f32 v[186:187], v[176:177], v[178:179]
    v_pk_add_f32 v[188:189], v[234:235], v[236:237]
    v_pk_add_f32 v[170:171], v[170:171], v[164:165]
    v_pk_add_f32 v[172:173], v[172:173], v[228:229]
    v_exp_f32_e64 v242, -v184
    v_exp_f32_e64 v243, -v185
    v_exp_f32 v184, v184
    v_exp_f32 v185, v185
    v_pk_add_f32 v[186:187], v[186:187], v[180:181]
    v_pk_add_f32 v[188:189], v[188:189], v[238:239]
    v_pk_add_f32 v[170:171], v[170:171], v[166:167]
    v_pk_add_f32 v[172:173], v[172:173], v[230:231]
    v_pk_add_f32 v[186:187], v[186:187], v[182:183]
    v_pk_add_f32 v[188:189], v[188:189], v[240:241]
    v_pk_add_f32 v[170:171], v[170:171], v[168:169]
    v_pk_add_f32 v[172:173], v[172:173], v[232:233]
    v_pk_add_f32 v[186:187], v[186:187], v[184:185]
    v_pk_add_f32 v[188:189], v[188:189], v[242:243]
    v_add_f32 v170, v170, v171
    v_add_f32 v172, v172, v173
    v_add_f32 v186, v186, v187
    v_add_f32 v188, v188, v189
    v_permlane32_swap_b32 v170, v172
    v_add_f32 v170, v170, v172
    v_permlane32_swap_b32 v186, v188
    v_max_u32 v10, v10, v170
    v_add_f32 v186, v186, v188
    v_rcp_f32 v170, v170
    v_max_u32 v10, v10, v186
    v_rcp_f32 v186, v186
    v_mov_b32 v172, v170
    v_mov_b32 v188, v186
    s_nop 0
    v_permlane32_swap_b32 v170, v172
    v_permlane32_swap_b32 v186, v188
    v_pk_mul_f32 v[160:161], v[160:161], v[170:171] op_sel_hi:[1,0]
    v_pk_mul_f32 v[162:163], v[162:163], v[170:171] op_sel_hi:[1,0]
    v_pk_mul_f32 v[164:165], v[164:165], v[170:171] op_sel_hi:[1,0]
    v_pk_mul_f32 v[166:167], v[166:167], v[170:171] op_sel_hi:[1,0]
    v_pk_mul_f32 v[168:169], v[168:169], v[170:171] op_sel_hi:[1,0]
    v_pk_mul_f32 v[176:177], v[176:177], v[186:187] op_sel_hi:[1,0]
    v_pk_mul_f32 v[178:179], v[178:179], v[186:187] op_sel_hi:[1,0]
    v_pk_mul_f32 v[180:181], v[180:181], v[186:187] op_sel_hi:[1,0]
    v_pk_mul_f32 v[182:183], v[182:183], v[186:187] op_sel_hi:[1,0]
    v_pk_mul_f32 v[184:185], v[184:185], v[186:187] op_sel_hi:[1,0]
    v_cvt_pk_bf16_f32 v128, v160, v161
    v_cvt_pk_bf16_f32 v129, v162, v163
    v_cvt_pk_bf16_f32 v130, v164, v165
    v_cvt_pk_bf16_f32 v131, v166, v167
    v_cvt_pk_bf16_f32 v132, v168, v169
    v_pk_mul_f32 v[224:225], v[224:225], v[172:173] op_sel_hi:[1,0]
    v_pk_mul_f32 v[226:227], v[226:227], v[172:173] op_sel_hi:[1,0]
    v_pk_mul_f32 v[228:229], v[228:229], v[172:173] op_sel_hi:[1,0]
    v_pk_mul_f32 v[230:231], v[230:231], v[172:173] op_sel_hi:[1,0]
    v_pk_mul_f32 v[232:233], v[232:233], v[172:173] op_sel_hi:[1,0]
    v_mfma_f32_32x32x16_bf16 v[160:175], v[16:19], v[88:91], 0
    v_cvt_pk_bf16_f32 v138, v176, v177
    v_cvt_pk_bf16_f32 v139, v178, v179
    v_cvt_pk_bf16_f32 v140, v180, v181
    v_cvt_pk_bf16_f32 v141, v182, v183
    v_cvt_pk_bf16_f32 v142, v184, v185
    v_mfma_f32_32x32x16_bf16 v[160:175], v[20:23], v[60:63], v[160:175]
    v_cvt_pk_bf16_f32 v133, v224, v225
    v_cvt_pk_bf16_f32 v134, v226, v227
    v_cvt_pk_bf16_f32 v135, v228, v229
    v_cvt_pk_bf16_f32 v136, v230, v231
    v_cvt_pk_bf16_f32 v137, v232, v233
    v_pk_mul_f32 v[234:235], v[234:235], v[188:189] op_sel_hi:[1,0]
    v_pk_mul_f32 v[236:237], v[236:237], v[188:189] op_sel_hi:[1,0]
    v_pk_mul_f32 v[238:239], v[238:239], v[188:189] op_sel_hi:[1,0]
    v_pk_mul_f32 v[240:241], v[240:241], v[188:189] op_sel_hi:[1,0]
    v_pk_mul_f32 v[242:243], v[242:243], v[188:189] op_sel_hi:[1,0]
    v_mfma_f32_32x32x16_bf16 v[176:191], v[16:19], v[92:95], 0
    v_cvt_pk_bf16_f32 v143, v234, v235
    v_exp_f32_e64 v224, -v160
    v_exp_f32_e64 v225, -v161
    v_mfma_f32_32x32x16_bf16 v[176:191], v[20:23], v[62:65], v[176:191]
    v_exp_f32_e64 v226, -v162
    v_exp_f32_e64 v227, -v163
    v_exp_f32 v160, v160
    v_exp_f32 v161, v161
    v_exp_f32 v162, v162
    v_exp_f32 v163, v163
    s_waitcnt vmcnt(0)
    v_mov_b32 v8, 163776
    s_mov_b64 exec, 1
    ds_add_rtn_u32 v11, v8, v13 offset:44
    s_mov_b64 exec, -1
    v_cvt_pk_bf16_f32 v144, v236, v237
    v_exp_f32_e64 v228, -v164
    v_exp_f32_e64 v229, -v165
    v_exp_f32_e64 v234, -v176
    v_exp_f32_e64 v235, -v177
    v_exp_f32_e64 v236, -v178
    v_exp_f32_e64 v237, -v179
    v_exp_f32 v176, v176
    v_exp_f32 v177, v177
    v_exp_f32 v178, v178
    v_exp_f32 v179, v179
    s_waitcnt lgkmcnt(0)
    v_subrev_u32 v11, 3, v11
    v_and_b32 v11, 0x80000000, v11
    v_or_b32 v12, v12, v11
    buffer_store_dword v13, v12, s[12:15], 0 offen sc1
    v_exp_f32 v164, v164
    v_exp_f32 v165, v165
    v_cvt_pk_bf16_f32 v145, v238, v239
    v_exp_f32_e64 v238, -v180
    v_exp_f32_e64 v239, -v181
    v_exp_f32_e64 v230, -v166
    v_exp_f32_e64 v231, -v167
    v_exp_f32 v180, v180
    v_exp_f32 v181, v181
    v_exp_f32 v166, v166
    v_exp_f32 v167, v167
    v_cvt_pk_bf16_f32 v146, v240, v241
    v_pk_add_f32 v[170:171], v[160:161], v[162:163]
    v_pk_add_f32 v[172:173], v[224:225], v[226:227]
    v_exp_f32_e64 v240, -v182
    v_exp_f32_e64 v241, -v183
    v_exp_f32_e64 v232, -v168
    v_exp_f32_e64 v233, -v169
    v_exp_f32 v182, v182
    v_exp_f32 v183, v183
    v_exp_f32 v168, v168
    v_exp_f32 v169, v169
    v_pk_add_f32 v[186:187], v[176:177], v[178:179]
    v_pk_add_f32 v[188:189], v[234:235], v[236:237]
    v_cvt_pk_bf16_f32 v147, v242, v243
    v_pk_add_f32 v[170:171], v[170:171], v[164:165]
    v_pk_add_f32 v[172:173], v[172:173], v[228:229]
    v_exp_f32_e64 v242, -v184
    v_exp_f32_e64 v243, -v185
    v_exp_f32 v184, v184
    v_exp_f32 v185, v185
    v_pk_add_f32 v[186:187], v[186:187], v[180:181]
    v_pk_add_f32 v[188:189], v[188:189], v[238:239]
    v_pk_add_f32 v[170:171], v[170:171], v[166:167]
    v_pk_add_f32 v[172:173], v[172:173], v[230:231]
    v_pk_add_f32 v[186:187], v[186:187], v[182:183]
    v_pk_add_f32 v[188:189], v[188:189], v[240:241]
    v_pk_add_f32 v[170:171], v[170:171], v[168:169]
    v_pk_add_f32 v[172:173], v[172:173], v[232:233]
    v_pk_add_f32 v[186:187], v[186:187], v[184:185]
    v_pk_add_f32 v[188:189], v[188:189], v[242:243]
    v_add_f32 v170, v170, v171
    v_add_f32 v172, v172, v173
    v_add_f32 v186, v186, v187
    v_add_f32 v188, v188, v189
    v_permlane32_swap_b32 v170, v172
    v_add_f32 v170, v170, v172
    v_permlane32_swap_b32 v186, v188
    v_max_u32 v10, v10, v170
    v_add_f32 v186, v186, v188
    v_max_u32 v10, v10, v186
    v_rcp_f32 v170, v170
    v_rcp_f32 v186, v186
    v_mov_b32 v172, v170
    v_mov_b32 v188, v186
    s_nop 0
    v_permlane32_swap_b32 v170, v172
    v_permlane32_swap_b32 v186, v188
    v_pk_mul_f32 v[160:161], v[160:161], v[170:171] op_sel_hi:[1,0]
    v_pk_mul_f32 v[162:163], v[162:163], v[170:171] op_sel_hi:[1,0]
    v_pk_mul_f32 v[164:165], v[164:165], v[170:171] op_sel_hi:[1,0]
    v_pk_mul_f32 v[166:167], v[166:167], v[170:171] op_sel_hi:[1,0]
    v_pk_mul_f32 v[168:169], v[168:169], v[170:171] op_sel_hi:[1,0]
    v_pk_mul_f32 v[224:225], v[224:225], v[172:173] op_sel_hi:[1,0]
    v_pk_mul_f32 v[226:227], v[226:227], v[172:173] op_sel_hi:[1,0]
    v_pk_mul_f32 v[228:229], v[228:229], v[172:173] op_sel_hi:[1,0]
    v_pk_mul_f32 v[230:231], v[230:231], v[172:173] op_sel_hi:[1,0]
    v_pk_mul_f32 v[232:233], v[232:233], v[172:173] op_sel_hi:[1,0]
    v_pk_mul_f32 v[176:177], v[176:177], v[186:187] op_sel_hi:[1,0]
    v_pk_mul_f32 v[178:179], v[178:179], v[186:187] op_sel_hi:[1,0]
    v_pk_mul_f32 v[180:181], v[180:181], v[186:187] op_sel_hi:[1,0]
    v_pk_mul_f32 v[182:183], v[182:183], v[186:187] op_sel_hi:[1,0]
    v_pk_mul_f32 v[184:185], v[184:185], v[186:187] op_sel_hi:[1,0]
    v_pk_mul_f32 v[234:235], v[234:235], v[188:189] op_sel_hi:[1,0]
    v_pk_mul_f32 v[236:237], v[236:237], v[188:189] op_sel_hi:[1,0]
    v_pk_mul_f32 v[238:239], v[238:239], v[188:189] op_sel_hi:[1,0]
    v_pk_mul_f32 v[240:241], v[240:241], v[188:189] op_sel_hi:[1,0]
    v_pk_mul_f32 v[242:243], v[242:243], v[188:189] op_sel_hi:[1,0]
    v_cvt_pk_bf16_f32 v148, v160, v161
    v_cvt_pk_bf16_f32 v149, v162, v163
    v_cvt_pk_bf16_f32 v150, v164, v165
    v_cvt_pk_bf16_f32 v151, v166, v167
    v_cvt_pk_bf16_f32 v152, v168, v169
    v_cvt_pk_bf16_f32 v153, v224, v225
    v_cvt_pk_bf16_f32 v154, v226, v227
    v_cvt_pk_bf16_f32 v155, v228, v229
    v_cvt_pk_bf16_f32 v156, v230, v231
    v_cvt_pk_bf16_f32 v157, v232, v233
    v_cvt_pk_bf16_f32 v244, v176, v177
    v_cvt_pk_bf16_f32 v245, v178, v179
    v_cvt_pk_bf16_f32 v246, v180, v181
    v_cvt_pk_bf16_f32 v247, v182, v183
    v_cvt_pk_bf16_f32 v248, v184, v185
    v_cvt_pk_bf16_f32 v249, v234, v235
    v_cvt_pk_bf16_f32 v250, v236, v237
    v_cvt_pk_bf16_f32 v251, v238, v239
    v_cvt_pk_bf16_f32 v252, v240, v241
    v_cvt_pk_bf16_f32 v253, v242, v243
    v_cmp_le_u32 vcc, 0x5d800000, v10
    s_nop 0
    s_cbranch_vccnz L_A_slowq
L_A_pre:
    v_mov_b32 v16, v30
    v_mov_b32 v17, v31
    v_mov_b32 v158, 0
    v_mov_b32 v159, 0
    v_mov_b32 v254, 0
    v_mov_b32 v255, 0
    v_and_b32 v8, 31, v0
    v_lshrrev_b32 v10, 5, v0
    v_mul_u32_u24 v10, 960, v10
    v_min_u32 v11, 23, v8
    v_lshl_add_u32 v11, v11, 4, v10
    v_lshl_add_u32 v9, v8, 4, v10
    v_cmp_ge_u32 vcc, 20, v8
    v_add_u32 v10, 48, v9
    v_lshrrev_b32 v8, 1, v8
    v_cndmask_b32 v9, v10, v9, vcc
    v_add_u32 v8, 21, v8
    v_and_b32 v10, 32, v0
    v_add_lshl_u32 v8, v8, v10, 2
    v_and_b32 v10, 1, v0
    v_cmp_eq_u32 s[70:71], 1, v10
    s_mov_b32 s67, s66
    s_add_u32 s69, s66, 30720
    s_and_b32 s28, s22, 7
    s_mul_i32 s28, s28, 3840
    s_add_u32 s66, s66, s28
    v_cmp_eq_u32 vcc, 0, v17
    s_nop 1
    v_cndmask_b32 v24, 0, v16, vcc
    v_cmp_eq_u32 vcc, 1, v17
    s_nop 1
    v_cndmask_b32 v25, 0, v16, vcc
    v_cmp_eq_u32 vcc, 2, v17
    s_nop 1
    v_cndmask_b32 v26, 0, v16, vcc
    v_cmp_eq_u32 vcc, 3, v17
    s_nop 1
    v_cndmask_b32 v27, 0, v16, vcc
    v_cmp_eq_u32 vcc, 4, v17
    s_nop 1
    v_cndmask_b32 v28, 0, v16, vcc
    v_cmp_eq_u32 vcc, 5, v17
    s_nop 1
    v_cndmask_b32 v29, 0, v16, vcc
    v_cmp_eq_u32 vcc, 6, v17
    s_nop 1
    v_cndmask_b32 v30, 0, v16, vcc
    v_cmp_eq_u32 vcc, 7, v17
    s_nop 1
    v_cndmask_b32 v31, 0, v16, vcc
    v_lshlrev_b32 v33, 7, v0
    v_mov_b32 v34, 163776
    s_cmp_lg_u32 s25, 0
    s_cbranch_scc1 L_a_np
    s_mov_b32 s29, 0
    s_mov_b64 exec, 0xffff
L_pollA:
    buffer_load_dword v32, v33, s[12:15], s68 offen sc1
    s_add_u32 s29, s29, 1
    s_cmp_ge_u32 s29, 2000000
    s_cbranch_scc1 L_goA
    s_waitcnt vmcnt(0)
    v_cmp_eq_u32 vcc, 0, v32
    s_nop 0
    s_cbranch_vccz L_goA
    s_mov_b64 exec, vcc
    s_sleep 5
    s_branch L_pollA
L_goA:
    s_mov_b64 exec, -1
    v_mov_b32 v32, 4
    ds_write_b32 v34, v32 offset:48
    s_branch L_lgap
L_a_np:
    s_mov_b32 s29, 0
L_lwap:
    ds_read_b32 v6, v34 offset:48
    s_add_u32 s29, s29, 1
    s_lshr_b32 s31, s29, 21
    s_waitcnt lgkmcnt(0)
    v_readfirstlane_b32 s28, v6
    s_max_u32 s28, s28, s31
    s_cmp_ge_u32 s28, 4
    s_cbranch_scc1 L_lgap
    s_branch L_lwap
L_lgap:
    buffer_load_dwordx4 v[32:35], v9, s[12:15], s66 offen offset:0 sc1
    buffer_load_dwordx4 v[36:39], v11, s[12:15], s66 offen offset:576 sc1
    buffer_load_dwordx4 v[40:43], v9, s[12:15], s66 offen offset:1920 sc1
    buffer_load_dwordx4 v[44:47], v11, s[12:15], s66 offen offset:2496 sc1
    s_add_u32 s66, s66, 3840
    s_cmp_eq_u32 s66, s69
    s_cselect_b32 s66, s67, s66
    buffer_load_dwordx4 v[48:51], v9, s[12:15], s66 offen offset:0 sc1
    buffer_load_dwordx4 v[52:55], v11, s[12:15], s66 offen offset:576 sc1
    buffer_load_dwordx4 v[56:59], v9, s[12:15], s66 offen offset:1920 sc1
    buffer_load_dwordx4 v[60:63], v11, s[12:15], s66 offen offset:2496 sc1
    s_add_u32 s66, s66, 3840
    s_cmp_eq_u32 s66, s69
    s_cselect_b32 s66, s67, s66
    buffer_load_dwordx4 v[64:67], v9, s[12:15], s66 offen offset:0 sc1
    buffer_load_dwordx4 v[68:71], v11, s[12:15], s66 offen offset:576 sc1
    buffer_load_dwordx4 v[72:75], v9, s[12:15], s66 offen offset:1920 sc1
    buffer_load_dwordx4 v[76:79], v11, s[12:15], s66 offen offset:2496 sc1
    s_add_u32 s66, s66, 3840
    s_cmp_eq_u32 s66, s69
    s_cselect_b32 s66, s67, s66
    s_waitcnt vmcnt(11)
    v_mfma_f32_32x32x16_bf16 v[224:239], v[24:27], v[32:35], 0
    s_waitcnt vmcnt(10)
    v_mfma_f32_32x32x16_bf16 v[224:239], v[28:31], v[36:39], v[224:239]
    s_waitcnt vmcnt(9)
    v_mfma_f32_32x32x16_bf16 v[224:239], v[24:27], v[40:43], v[224:239]
    s_waitcnt vmcnt(8)
    v_mfma_f32_32x32x16_bf16 v[224:239], v[28:31], v[44:47], v[224:239]
    buffer_load_dwordx4 v[80:83], v9, s[12:15], s66 offen offset:0 sc1
    buffer_load_dwordx4 v[84:87], v11, s[12:15], s66 offen offset:576 sc1
    buffer_load_dwordx4 v[88:91], v9, s[12:15], s66 offen offset:1920 sc1
    buffer_load_dwordx4 v[92:95], v11, s[12:15], s66 offen offset:2496 sc1
    s_add_u32 s66, s66, 3840
    s_cmp_eq_u32 s66, s69
    s_cselect_b32 s66, s67, s66
    s_waitcnt vmcnt(11)
    v_mfma_f32_32x32x16_bf16 v[224:239], v[24:27], v[48:51], v[224:239]
    s_waitcnt vmcnt(10)
    v_mfma_f32_32x32x16_bf16 v[224:239], v[28:31], v[52:55], v[224:239]
    s_waitcnt vmcnt(9)
    v_mfma_f32_32x32x16_bf16 v[224:239], v[24:27], v[56:59], v[224:239]
    s_waitcnt vmcnt(8)
    v_mfma_f32_32x32x16_bf16 v[224:239], v[28:31], v[60:63], v[224:239]
    buffer_load_dwordx4 v[96:99], v9, s[12:15], s66 offen offset:0 sc1
    buffer_load_dwordx4 v[100:103], v11, s[12:15], s66 offen offset:576 sc1
    buffer_load_dwordx4 v[104:107], v9, s[12:15], s66 offen offset:1920 sc1
    buffer_load_dwordx4 v[108:111], v11, s[12:15], s66 offen offset:2496 sc1
    s_add_u32 s66, s66, 3840
    s_cmp_eq_u32 s66, s69
    s_cselect_b32 s66, s67, s66
    s_waitcnt vmcnt(11)
    v_mfma_f32_32x32x16_bf16 v[224:239], v[24:27], v[64:67], v[224:239]
    s_waitcnt vmcnt(10)
    v_mfma_f32_32x32x16_bf16 v[224:239], v[28:31], v[68:71], v[224:239]
    s_waitcnt vmcnt(9)
    v_mfma_f32_32x32x16_bf16 v[224:239], v[24:27], v[72:75], v[224:239]
    s_waitcnt vmcnt(8)
    v_mfma_f32_32x32x16_bf16 v[224:239], v[28:31], v[76:79], v[224:239]
    buffer_load_dwordx4 v[112:115], v9, s[12:15], s66 offen offset:0 sc1
    buffer_load_dwordx4 v[116:119], v11, s[12:15], s66 offen offset:576 sc1
    buffer_load_dwordx4 v[120:123], v9, s[12:15], s66 offen offset:1920 sc1
    buffer_load_dwordx4 v[124:127], v11, s[12:15], s66 offen offset:2496 sc1
    s_add_u32 s66, s66, 3840
    s_cmp_eq_u32 s66, s69
    s_cselect_b32 s66, s67, s66
    s_waitcnt vmcnt(11)
    v_mfma_f32_32x32x16_bf16 v[224:239], v[24:27], v[80:83], v[224:239]
    s_waitcnt vmcnt(10)
    v_mfma_f32_32x32x16_bf16 v[224:239], v[28:31], v[84:87], v[224:239]
    s_waitcnt vmcnt(9)
    v_mfma_f32_32x32x16_bf16 v[224:239], v[24:27], v[88:91], v[224:239]
    s_waitcnt vmcnt(8)
    v_mfma_f32_32x32x16_bf16 v[224:239], v[28:31], v[92:95], v[224:239]
    buffer_load_dwordx4 v[160:163], v9, s[12:15], s66 offen offset:0 sc1
    buffer_load_dwordx4 v[164:167], v11, s[12:15], s66 offen offset:576 sc1
    buffer_load_dwordx4 v[168:171], v9, s[12:15], s66 offen offset:1920 sc1
    buffer_load_dwordx4 v[172:175], v11, s[12:15], s66 offen offset:2496 sc1
    s_add_u32 s66, s66, 3840
    s_cmp_eq_u32 s66, s69
    s_cselect_b32 s66, s67, s66
    s_waitcnt vmcnt(11)
    v_mfma_f32_32x32x16_bf16 v[224:239], v[24:27], v[96:99], v[224:239]
    s_waitcnt vmcnt(10)
    v_mfma_f32_32x32x16_bf16 v[224:239], v[28:31], v[100:103], v[224:239]
    s_waitcnt vmcnt(9)
    v_mfma_f32_32x32x16_bf16 v[224:239], v[24:27], v[104:107], v[224:239]
    s_waitcnt vmcnt(8)
    v_mfma_f32_32x32x16_bf16 v[224:239], v[28:31], v[108:111], v[224:239]
    buffer_load_dwordx4 v[176:179], v9, s[12:15], s66 offen offset:0 sc1
    buffer_load_dwordx4 v[180:183], v11, s[12:15], s66 offen offset:576 sc1
    buffer_load_dwordx4 v[184:187], v9, s[12:15], s66 offen offset:1920 sc1
    buffer_load_dwordx4 v[188:191], v11, s[12:15], s66 offen offset:2496 sc1
    s_add_u32 s66, s66, 3840
    s_cmp_eq_u32 s66, s69
    s_cselect_b32 s66, s67, s66
    v_mov_b32 v12, 163776
    s_mov_b64 exec, 1
    ds_add_u32 v12, v13 offset:24
    s_mov_b64 exec, -1
    s_waitcnt vmcnt(11)
    v_mfma_f32_32x32x16_bf16 v[224:239], v[24:27], v[112:115], v[224:239]
    s_waitcnt vmcnt(10)
    v_mfma_f32_32x32x16_bf16 v[224:239], v[28:31], v[116:119], v[224:239]
    s_waitcnt vmcnt(9)
    v_mfma_f32_32x32x16_bf16 v[224:239], v[24:27], v[120:123], v[224:239]
    s_waitcnt vmcnt(8)
    v_mfma_f32_32x32x16_bf16 v[224:239], v[28:31], v[124:127], v[224:239]
    s_waitcnt vmcnt(7)
    v_mfma_f32_32x32x16_bf16 v[224:239], v[24:27], v[160:163], v[224:239]
    s_waitcnt vmcnt(6)
    v_mfma_f32_32x32x16_bf16 v[224:239], v[28:31], v[164:167], v[224:239]
    s_waitcnt vmcnt(5)
    v_mfma_f32_32x32x16_bf16 v[224:239], v[24:27], v[168:171], v[224:239]
    s_waitcnt vmcnt(4)
    v_mfma_f32_32x32x16_bf16 v[224:239], v[28:31], v[172:175], v[224:239]
    s_waitcnt vmcnt(3)
    v_mfma_f32_32x32x16_bf16 v[224:239], v[24:27], v[176:179], v[224:239]
    s_waitcnt vmcnt(2)
    v_mfma_f32_32x32x16_bf16 v[224:239], v[28:31], v[180:183], v[224:239]
    s_waitcnt vmcnt(1)
    v_mfma_f32_32x32x16_bf16 v[224:239], v[24:27], v[184:187], v[224:239]
    s_waitcnt vmcnt(0)
    v_mfma_f32_32x32x16_bf16 v[224:239], v[28:31], v[188:191], v[224:239]
    s_nop 11
    v_cvt_pk_bf16_f32 v16, v224, v225
    v_cvt_pk_bf16_f32 v17, v226, v227
    v_cvt_pk_bf16_f32 v18, v228, v229
    v_cvt_pk_bf16_f32 v19, v230, v231
    v_cvt_pk_bf16_f32 v20, v232, v233
    v_cvt_pk_bf16_f32 v21, v234, v235
    v_cvt_pk_bf16_f32 v22, v236, v237
    v_cvt_pk_bf16_f32 v23, v238, v239
    ds_bpermute_b32 v24, v8, v16
    ds_bpermute_b32 v25, v8, v17
    ds_bpermute_b32 v28, v8, v18
    ds_bpermute_b32 v29, v8, v19
    v_mov_b32 v26, 0
    v_mov_b32 v27, 0
    v_mfma_f32_32x32x16_bf16 v[160:175], v[16:19], v[128:131], 0
    v_mfma_f32_32x32x16_bf16 v[160:175], v[20:23], v[132:135], v[160:175]
    v_mfma_f32_32x32x16_bf16 v[176:191], v[16:19], v[138:141], 0
    v_mfma_f32_32x32x16_bf16 v[176:191], v[20:23], v[142:145], v[176:191]
    s_waitcnt lgkmcnt(1)
    v_cndmask_b32 v24, v24, v28, s[70:71]
    s_waitcnt lgkmcnt(0)
    v_cndmask_b32 v25, v25, v29, s[70:71]
    v_mfma_f32_32x32x16_bf16 v[192:207], v[16:19], v[148:151], 0
    s_nop 0
    v_mfma_f32_32x32x16_bf16 v[160:175], v[24:27], v[136:139], v[160:175]
    v_mfma_f32_32x32x16_bf16 v[176:191], v[24:27], v[146:149], v[176:191]
    v_mfma_f32_32x32x16_bf16 v[192:207], v[20:23], v[152:155], v[192:207]
    v_mfma_f32_32x32x16_bf16 v[208:223], v[16:19], v[244:247], 0
    v_mfma_f32_32x32x16_bf16 v[192:207], v[24:27], v[156:159], v[192:207]
    v_mfma_f32_32x32x16_bf16 v[208:223], v[20:23], v[248:251], v[208:223]
    v_mfma_f32_32x32x16_bf16 v[208:223], v[24:27], v[252:255], v[208:223]
    s_nop 5
    v_add_f32 v172, 0x358637bd, v168
    v_add_f32 v174, 0x358637bd, v168
    v_add_f32 v188, 0x358637bd, v184
    v_add_f32 v190, 0x358637bd, v184
    v_permlane32_swap_b32 v174, v172
    v_rcp_f32 v172, v172
    v_permlane32_swap_b32 v190, v188
    v_mul_f32 v160, v160, v172
    v_mul_f32 v161, v161, v172
    v_mul_f32 v162, v162, v172
    v_mul_f32 v163, v163, v172
    v_mul_f32 v164, v164, v172
    v_mul_f32 v165, v165, v172
    v_mul_f32 v166, v166, v172
    v_mul_f32 v167, v167, v172
    v_cvt_pk_bf16_f32 v32, v160, v161
    v_cvt_pk_bf16_f32 v33, v162, v163
    v_cvt_pk_bf16_f32 v34, v164, v165
    v_cvt_pk_bf16_f32 v35, v166, v167
    buffer_store_dwordx4 v[32:35], v1, s[12:15], s76 offen offset:0 sc1
    v_rcp_f32 v188, v188
    v_mul_f32 v168, v168, v172
    v_mul_f32 v176, v176, v188
    v_mul_f32 v177, v177, v188
    v_mul_f32 v178, v178, v188
    v_mul_f32 v179, v179, v188
    v_mul_f32 v180, v180, v188
    v_mul_f32 v181, v181, v188
    v_mul_f32 v182, v182, v188
    v_mul_f32 v183, v183, v188
    v_cvt_pk_bf16_f32 v36, v176, v177
    v_cvt_pk_bf16_f32 v37, v178, v179
    v_cvt_pk_bf16_f32 v38, v180, v181
    v_cvt_pk_bf16_f32 v39, v182, v183
    buffer_store_dwordx4 v[36:39], v1, s[12:15], s76 offen offset:1024 sc1
    v_mul_f32 v169, v169, v172
    v_mul_f32 v170, v170, v172
    v_mul_f32 v171, v171, v172
    v_mul_f32 v184, v184, v188
    v_mul_f32 v185, v185, v188
    v_mul_f32 v186, v186, v188
    v_mul_f32 v187, v187, v188
    v_cvt_pk_bf16_f32 v48, v168, v169
    v_cvt_pk_bf16_f32 v49, v170, v171
    v_cvt_pk_bf16_f32 v50, v184, v185
    v_cvt_pk_bf16_f32 v51, v186, v187
    v_add_f32 v204, 0x358637bd, v200
    buffer_store_dwordx4 v[48:51], v2, s[12:15], s76 offen offset:2048 sc1
    v_add_f32 v206, 0x358637bd, v200
    v_add_f32 v220, 0x358637bd, v216
    v_add_f32 v222, 0x358637bd, v216
    v_permlane32_swap_b32 v206, v204
    v_rcp_f32 v204, v204
    v_permlane32_swap_b32 v222, v220
    v_pk_mul_f32 v[192:193], v[192:193], v[204:205] op_sel_hi:[1,0]
    v_pk_mul_f32 v[194:195], v[194:195], v[204:205] op_sel_hi:[1,0]
    v_pk_mul_f32 v[196:197], v[196:197], v[204:205] op_sel_hi:[1,0]
    v_pk_mul_f32 v[198:199], v[198:199], v[204:205] op_sel_hi:[1,0]
    v_cvt_pk_bf16_f32 v40, v192, v193
    v_cvt_pk_bf16_f32 v41, v194, v195
    v_cvt_pk_bf16_f32 v42, v196, v197
    v_cvt_pk_bf16_f32 v43, v198, v199
    buffer_store_dwordx4 v[40:43], v1, s[12:15], s77 offen offset:0 sc1
    v_rcp_f32 v220, v220
    v_pk_mul_f32 v[200:201], v[200:201], v[204:205] op_sel_hi:[1,0]
    v_pk_mul_f32 v[208:209], v[208:209], v[220:221] op_sel_hi:[1,0]
    v_pk_mul_f32 v[210:211], v[210:211], v[220:221] op_sel_hi:[1,0]
    v_pk_mul_f32 v[212:213], v[212:213], v[220:221] op_sel_hi:[1,0]
    v_pk_mul_f32 v[214:215], v[214:215], v[220:221] op_sel_hi:[1,0]
    v_cvt_pk_bf16_f32 v44, v208, v209
    v_cvt_pk_bf16_f32 v45, v210, v211
    v_cvt_pk_bf16_f32 v46, v212, v213
    v_cvt_pk_bf16_f32 v47, v214, v215
    buffer_store_dwordx4 v[44:47], v1, s[12:15], s77 offen offset:1024 sc1
    v_pk_mul_f32 v[202:203], v[202:203], v[204:205] op_sel_hi:[1,0]
    v_pk_mul_f32 v[216:217], v[216:217], v[220:221] op_sel_hi:[1,0]
    v_pk_mul_f32 v[218:219], v[218:219], v[220:221] op_sel_hi:[1,0]
    v_cvt_pk_bf16_f32 v52, v200, v201
    v_cvt_pk_bf16_f32 v53, v202, v203
    v_cvt_pk_bf16_f32 v54, v216, v217
    v_cvt_pk_bf16_f32 v55, v218, v219
    buffer_store_dwordx4 v[52:55], v2, s[12:15], s77 offen offset:2048 sc1
L_P3c:
    v_mov_b32 v2, 163776
    ds_read_b32 v4, v2 offset:16
    v_bfrev_b32 v14, 1
    v_writelane_b32 v14, s78, 0
    s_mov_b32 s35, 0
    v_lshrrev_b32 v12, 4, v0
    v_bfe_u32 v10, v0, 2, 2
    v_and_b32 v9, 3, v0
    v_lshlrev_b32 v9, 3, v9
    v_add_u32 v9, 51200, v9
    v_lshrrev_b32 v11, 5, v0
    v_mul_u32_u24 v11, 20, v11
    v_bfe_u32 v6, v0, 4, 1
    v_lshl_add_u32 v11, v6, 2, v11
    v_add_u32 v11, v11, v10
    v_mov_b32 v7, 160
    v_mad_u32_u24 v8, v11, v7, v9
    v_mad_u32_u24 v11, v12, 20, v10
    v_add_u32 v11, 16, v11
    v_mad_u32_u24 v9, v11, v7, v9
    s_waitcnt lgkmcnt(0)
    v_readfirstlane_b32 s79, v4
    s_cmp_ge_u32 s79, 4
    s_cbranch_scc1 L_lgp
    s_waitcnt vmcnt(0)
    s_mov_b64 exec, 1
    ds_add_rtn_u32 v6, v2, v13 offset:20
    s_mov_b64 exec, -1
    s_waitcnt lgkmcnt(0)
    v_readfirstlane_b32 s28, v6
    s_cmp_lg_u32 s28, 3
    s_cbranch_scc1 L_ofa
    buffer_store_dword v13, v14, s[12:15], 0 offen sc1
L_ofa:
    s_mov_b32 s29, 0
L_lwp:
    ds_read_b32 v6, v2 offset:16
    s_add_u32 s29, s29, 1
    s_lshr_b32 s31, s29, 21
    s_waitcnt lgkmcnt(0)
    v_readfirstlane_b32 s28, v6
    s_max_u32 s28, s28, s31
    s_cmp_ge_u32 s28, 4
    s_cbranch_scc1 L_lgp
    s_sleep 2
    s_branch L_lwp
L_lgp:
    s_waitcnt vmcnt(6)
    ds_read_b64_tr_b16 v[76:77], v8 offset:0
    ds_read_b64_tr_b16 v[78:79], v8 offset:1280
    ds_read_b64_tr_b16 v[80:81], v8 offset:32
    ds_read_b64_tr_b16 v[82:83], v8 offset:1312
    ds_read_b64_tr_b16 v[84:85], v8 offset:64
    ds_read_b64_tr_b16 v[86:87], v8 offset:1344
    ds_read_b64_tr_b16 v[88:89], v8 offset:96
    ds_read_b64_tr_b16 v[90:91], v8 offset:1376
    ds_read_b64_tr_b16 v[92:93], v8 offset:128
    ds_read_b64_tr_b16 v[94:95], v8 offset:1408
    ds_read_b64_tr_b16 v[96:97], v8 offset:6400
    ds_read_b64_tr_b16 v[98:99], v8 offset:7680
    ds_read_b64_tr_b16 v[100:101], v8 offset:6432
    ds_read_b64_tr_b16 v[102:103], v8 offset:7712
    ds_read_b64_tr_b16 v[104:105], v8 offset:6464
    ds_read_b64_tr_b16 v[106:107], v8 offset:7744
    ds_read_b64_tr_b16 v[108:109], v8 offset:6496
    ds_read_b64_tr_b16 v[110:111], v8 offset:7776
    ds_read_b64_tr_b16 v[112:113], v8 offset:6528
    ds_read_b64_tr_b16 v[114:115], v8 offset:7808
    ds_read_b64_tr_b16 v[116:117], v8 offset:12800
    ds_read_b64_tr_b16 v[118:119], v8 offset:14080
    ds_read_b64_tr_b16 v[120:121], v8 offset:12832
    ds_read_b64_tr_b16 v[122:123], v8 offset:14112
    ds_read_b64_tr_b16 v[124:125], v8 offset:12864
    ds_read_b64_tr_b16 v[126:127], v8 offset:14144
    ds_read_b64_tr_b16 v[128:129], v8 offset:12896
    ds_read_b64_tr_b16 v[130:131], v8 offset:14176
    ds_read_b64_tr_b16 v[132:133], v8 offset:12928
    ds_read_b64_tr_b16 v[134:135], v8 offset:14208
    ds_read_b64_tr_b16 v[136:137], v8 offset:19200
    ds_read_b64_tr_b16 v[138:139], v8 offset:20480
    ds_read_b64_tr_b16 v[140:141], v8 offset:19232
    ds_read_b64_tr_b16 v[142:143], v8 offset:20512
    ds_read_b64_tr_b16 v[144:145], v8 offset:19264
    ds_read_b64_tr_b16 v[146:147], v8 offset:20544
    ds_read_b64_tr_b16 v[148:149], v8 offset:19296
    ds_read_b64_tr_b16 v[150:151], v8 offset:20576
    ds_read_b64_tr_b16 v[152:153], v8 offset:19328
    ds_read_b64_tr_b16 v[154:155], v8 offset:20608
    v_and_b32 v4, 7, v0
    v_lshlrev_b32 v5, 7, v0
    v_bfe_u32 v6, v0, 3, 1
    v_lshlrev_b32 v11, 4, v4
    v_lshl_add_u32 v10, v6, 10, v11
    v_bfe_u32 v7, v0, 4, 1
    v_lshl_add_u32 v10, v7, 9, v10
    v_lshrrev_b32 v7, 5, v0
    v_mul_u32_u24 v7, 2560, v7
    v_add_u32 v10, v10, v7
    v_lshrrev_b32 v7, 4, v0
    v_lshl_add_u32 v7, v6, 2, v7
    v_mul_u32_u24 v7, 2560, v7
    v_add_u32 v11, v11, v7
    v_lshl_add_u32 v4, v6, 5, v4
    s_and_b32 s73, s25, 3
    s_mul_i32 s74, s56, 163840
    s_add_u32 s74, s74, 7225344
    s_lshl_b32 s28, s73, 7
    s_add_u32 s74, s74, s28
    s_mul_i32 s30, s73, 6144
    s_add_u32 s28, s35, 0
    s_and_b32 s28, s28, 3
    s_mul_i32 s28, s28, 20480
    s_add_u32 s64, s28, s74
    s_add_u32 s28, s35, 1
    s_and_b32 s28, s28, 3
    s_mul_i32 s28, s28, 20480
    s_add_u32 s65, s28, s74
    s_add_u32 s28, s35, 2
    s_and_b32 s28, s28, 3
    s_mul_i32 s28, s28, 20480
    s_add_u32 s66, s28, s74
    s_add_u32 s28, s35, 3
    s_and_b32 s28, s28, 3
    s_mul_i32 s28, s28, 20480
    s_add_u32 s67, s28, s74
    s_lshr_b32 s28, s56, 1
    s_lshl_b32 s28, s28, 11
    s_add_u32 s74, s28, 17408
    v_lshl_add_u32 v12, v0, 4, s30
    s_waitcnt vmcnt(0)
    s_cmp_lt_u32 s79, 4
    s_cbranch_scc1 L_P3_nf
    s_mov_b64 exec, 1
    ds_add_rtn_u32 v6, v2, v13 offset:20
    s_mov_b64 exec, -1
    s_waitcnt lgkmcnt(0)
    v_readfirstlane_b32 s28, v6
    s_cmp_lg_u32 s28, 3
    s_cbranch_scc1 L_ofb
    buffer_store_dword v13, v14, s[12:15], 0 offen sc1
L_ofb:
L_P3_nf:
    ds_read_b64_tr_b16 v[156:157], v9 offset:0
    ds_read_b64_tr_b16 v[158:159], v9 offset:12800
    ds_read_b64_tr_b16 v[160:161], v9 offset:32
    ds_read_b64_tr_b16 v[162:163], v9 offset:12832
    ds_read_b64_tr_b16 v[164:165], v9 offset:64
    ds_read_b64_tr_b16 v[166:167], v9 offset:12864
    ds_read_b64_tr_b16 v[168:169], v9 offset:96
    ds_read_b64_tr_b16 v[170:171], v9 offset:12896
    ds_read_b64_tr_b16 v[172:173], v9 offset:128
    ds_read_b64_tr_b16 v[174:175], v9 offset:12928
    ds_read_b64_tr_b16 v[176:177], v8 offset:25600
    ds_read_b64_tr_b16 v[178:179], v8 offset:26880
    ds_read_b64_tr_b16 v[180:181], v8 offset:25632
    ds_read_b64_tr_b16 v[182:183], v8 offset:26912
    ds_read_b64_tr_b16 v[184:185], v8 offset:25664
    ds_read_b64_tr_b16 v[186:187], v8 offset:26944
    ds_read_b64_tr_b16 v[188:189], v8 offset:25696
    ds_read_b64_tr_b16 v[190:191], v8 offset:26976
    ds_read_b64_tr_b16 v[192:193], v8 offset:25728
    ds_read_b64_tr_b16 v[194:195], v8 offset:27008
    ds_read_b64_tr_b16 v[196:197], v8 offset:32000
    ds_read_b64_tr_b16 v[198:199], v8 offset:33280
    ds_read_b64_tr_b16 v[200:201], v8 offset:32032
    ds_read_b64_tr_b16 v[202:203], v8 offset:33312
    ds_read_b64_tr_b16 v[204:205], v8 offset:32064
    ds_read_b64_tr_b16 v[206:207], v8 offset:33344
    ds_read_b64_tr_b16 v[208:209], v8 offset:32096
    ds_read_b64_tr_b16 v[210:211], v8 offset:33376
    ds_read_b64_tr_b16 v[212:213], v8 offset:32128
    ds_read_b64_tr_b16 v[214:215], v8 offset:33408
    ds_read_b64_tr_b16 v[216:217], v8 offset:38400
    ds_read_b64_tr_b16 v[218:219], v8 offset:39680
    ds_read_b64_tr_b16 v[220:221], v8 offset:38432
    ds_read_b64_tr_b16 v[222:223], v8 offset:39712
    ds_read_b64_tr_b16 v[224:225], v8 offset:38464
    ds_read_b64_tr_b16 v[226:227], v8 offset:39744
    ds_read_b64_tr_b16 v[228:229], v8 offset:38496
    ds_read_b64_tr_b16 v[230:231], v8 offset:39776
    ds_read_b64_tr_b16 v[232:233], v8 offset:38528
    ds_read_b64_tr_b16 v[234:235], v8 offset:39808
    ds_read_b64_tr_b16 v[236:237], v8 offset:44800
    ds_read_b64_tr_b16 v[238:239], v8 offset:46080
    ds_read_b64_tr_b16 v[240:241], v8 offset:44832
    ds_read_b64_tr_b16 v[242:243], v8 offset:46112
    ds_read_b64_tr_b16 v[244:245], v8 offset:44864
    ds_read_b64_tr_b16 v[246:247], v8 offset:46144
    ds_read_b64_tr_b16 v[248:249], v8 offset:44896
    ds_read_b64_tr_b16 v[250:251], v8 offset:46176
    ds_read_b64_tr_b16 v[252:253], v8 offset:44928
    ds_read_b64_tr_b16 v[254:255], v8 offset:46208
    s_mov_b32 s29, 0
L_lwq:
    ds_read_b32 v6, v2 offset:28
    s_add_u32 s29, s29, 1
    s_lshr_b32 s31, s29, 21
    s_waitcnt lgkmcnt(0)
    v_readfirstlane_b32 s28, v6
    s_max_u32 s28, s28, s31
    s_cmp_ge_u32 s28, 4
    s_cbranch_scc1 L_lgq
    s_sleep 2
    s_branch L_lwq
L_lgq:
    v_mov_b32 v7, 163776
    s_cmp_lg_u32 s25, 0
    s_cbranch_scc1 L_c_np
    s_mov_b32 s29, 0
    s_mov_b64 exec, 0xff
L_pollP:
    buffer_load_dword v16, v5, s[12:15], s74 offen sc1
    s_add_u32 s29, s29, 1
    s_cmp_ge_u32 s29, 2000000
    s_cbranch_scc1 L_goP
    s_waitcnt vmcnt(0)
    v_cmp_eq_u32 vcc, 0, v16
    s_nop 0
    s_cbranch_vccz L_goP
    s_mov_b64 exec, vcc
    s_sleep 5
    s_branch L_pollP
L_goP:
    s_mov_b64 exec, -1
    v_mov_b32 v16, 4
    ds_write_b32 v7, v16 offset:40
    s_branch L_lgcp
L_c_np:
    s_mov_b32 s29, 0
L_lwcp:
    ds_read_b32 v6, v7 offset:40
    s_add_u32 s29, s29, 1
    s_lshr_b32 s31, s29, 21
    s_waitcnt lgkmcnt(0)
    v_readfirstlane_b32 s28, v6
    s_max_u32 s28, s28, s31
    s_cmp_ge_u32 s28, 4
    s_cbranch_scc1 L_lgcp
    s_branch L_lwcp
L_lgcp:
    s_setprio 0
    buffer_load_dwordx4 v[16:19], v10, s[12:15], s64 offen sc1
    s_add_u32 s64, s64, 5120
    buffer_load_dwordx4 v[20:23], v10, s[12:15], s64 offen sc1
    s_add_u32 s64, s64, 5120
    buffer_load_dwordx4 v[24:27], v10, s[12:15], s64 offen sc1
    s_add_u32 s64, s64, 5120
    buffer_load_dwordx4 v[28:31], v10, s[12:15], s64 offen sc1
    s_sub_u32 s64, s64, 15360
    buffer_load_dwordx4 v[32:35], v11, s[12:15], s64 offen offset:2048 sc1
    s_lshl_b32 s28, s56, 6
    s_mul_i32 s30, s73, 3072
    s_add_u32 s30, s30, 25600
    v_and_b32 v2, 15, v0
    v_mul_u32_u24 v2, 160, v2
    v_lshrrev_b32 v3, 4, v0
    v_lshlrev_b32 v3, 3, v3
    v_add3_u32 v2, v2, v3, s30
    v_add_u32 v3, s30, v1
    s_lshl_b32 s29, s73, 3
    s_add_u32 s28, s28, s29
    s_mul_i32 s28, s28, 1280
    s_mul_i32 s29, s57, 160
    s_add_u32 s72, s28, s29
    v_add_u32 v6, 0, v0
    v_mul_u32_u24 v7, 205, v6
    v_lshrrev_b32 v7, 11, v7
    v_lshlrev_b32 v6, 4, v6
    v_mul_u32_u24 v1, 1120, v7
    v_lshrrev_b32 v7, 3, v7
    v_mul_u32_u24 v7, 30720, v7
    v_add3_u32 v1, v1, v6, v7
    v_add_u32 v6, 64, v0
    v_mul_u32_u24 v7, 205, v6
    v_lshrrev_b32 v7, 11, v7
    v_lshlrev_b32 v6, 4, v6
    v_mul_u32_u24 v4, 1120, v7
    v_lshrrev_b32 v7, 3, v7
    v_mul_u32_u24 v7, 30720, v7
    v_add3_u32 v4, v4, v6, v7
    v_add_u32 v6, 128, v0
    v_mul_u32_u24 v7, 205, v6
    v_lshrrev_b32 v7, 11, v7
    v_lshlrev_b32 v6, 4, v6
    v_mul_u32_u24 v15, 1120, v7
    v_lshrrev_b32 v7, 3, v7
    v_mul_u32_u24 v7, 30720, v7
    v_add3_u32 v15, v15, v6, v7
    v_bfrev_b32 v6, 1
    v_cndmask_b32 v15, v6, v15, s[60:61]
    s_mov_b32 s16, s50
    s_mov_b32 s17, s51
    s_mov_b32 s18, 2621440
    s_waitcnt vmcnt(4)
    v_mfma_f32_16x16x32_bf16 v[56:59], v[76:79], v[16:19], 0
    buffer_load_dwordx4 v[36:39], v10, s[12:15], s65 offen sc1
    s_add_u32 s65, s65, 5120
    v_mfma_f32_16x16x32_bf16 v[60:63], v[80:83], v[16:19], 0
    v_mfma_f32_16x16x32_bf16 v[64:67], v[84:87], v[16:19], 0
    v_mfma_f32_16x16x32_bf16 v[68:71], v[88:91], v[16:19], 0
    v_mfma_f32_16x16x32_bf16 v[72:75], v[92:95], v[16:19], 0
    s_waitcnt vmcnt(4)
    v_mfma_f32_16x16x32_bf16 v[56:59], v[96:99], v[20:23], v[56:59]
    buffer_load_dwordx4 v[40:43], v10, s[12:15], s65 offen sc1
    s_add_u32 s65, s65, 5120
    ds_read_b64_tr_b16 v[76:77], v9 offset:25600
    ds_read_b64_tr_b16 v[78:79], v9 offset:38400
    v_mfma_f32_16x16x32_bf16 v[60:63], v[100:103], v[20:23], v[60:63]
    ds_read_b64_tr_b16 v[80:81], v9 offset:25632
    ds_read_b64_tr_b16 v[82:83], v9 offset:38432
    v_mfma_f32_16x16x32_bf16 v[64:67], v[104:107], v[20:23], v[64:67]
    ds_read_b64_tr_b16 v[84:85], v9 offset:25664
    ds_read_b64_tr_b16 v[86:87], v9 offset:38464
    v_mfma_f32_16x16x32_bf16 v[68:71], v[108:111], v[20:23], v[68:71]
    ds_read_b64_tr_b16 v[88:89], v9 offset:25696
    v_mfma_f32_16x16x32_bf16 v[72:75], v[112:115], v[20:23], v[72:75]
    ds_read_b64_tr_b16 v[90:91], v9 offset:38496
    s_waitcnt vmcnt(4)
    v_mfma_f32_16x16x32_bf16 v[56:59], v[116:119], v[24:27], v[56:59]
    buffer_load_dwordx4 v[44:47], v10, s[12:15], s65 offen sc1
    s_add_u32 s65, s65, 5120
    ds_read_b64_tr_b16 v[92:93], v9 offset:25728
    ds_read_b64_tr_b16 v[94:95], v9 offset:38528
    v_mfma_f32_16x16x32_bf16 v[60:63], v[120:123], v[24:27], v[60:63]
    v_add_u32 v8, 51200, v8
    v_add_u32 v9, 51200, v9
    v_mfma_f32_16x16x32_bf16 v[64:67], v[124:127], v[24:27], v[64:67]
    ds_read_b64_tr_b16 v[96:97], v8 offset:0
    ds_read_b64_tr_b16 v[98:99], v8 offset:1280
    v_mfma_f32_16x16x32_bf16 v[68:71], v[128:131], v[24:27], v[68:71]
    ds_read_b64_tr_b16 v[100:101], v8 offset:32
    v_mfma_f32_16x16x32_bf16 v[72:75], v[132:135], v[24:27], v[72:75]
    ds_read_b64_tr_b16 v[102:103], v8 offset:1312
    s_waitcnt vmcnt(4)
    v_mfma_f32_16x16x32_bf16 v[56:59], v[136:139], v[28:31], v[56:59]
    buffer_load_dwordx4 v[48:51], v10, s[12:15], s65 offen sc1
    s_sub_u32 s65, s65, 15360
    ds_read_b64_tr_b16 v[104:105], v8 offset:64
    ds_read_b64_tr_b16 v[106:107], v8 offset:1344
    v_mfma_f32_16x16x32_bf16 v[60:63], v[140:143], v[28:31], v[60:63]
    ds_read_b64_tr_b16 v[108:109], v8 offset:96
    ds_read_b64_tr_b16 v[110:111], v8 offset:1376
    v_mfma_f32_16x16x32_bf16 v[64:67], v[144:147], v[28:31], v[64:67]
    ds_read_b64_tr_b16 v[112:113], v8 offset:128
    ds_read_b64_tr_b16 v[114:115], v8 offset:1408
    v_mfma_f32_16x16x32_bf16 v[68:71], v[148:151], v[28:31], v[68:71]
    ds_read_b64_tr_b16 v[116:117], v8 offset:6400
    v_mfma_f32_16x16x32_bf16 v[72:75], v[152:155], v[28:31], v[72:75]
    ds_read_b64_tr_b16 v[118:119], v8 offset:7680
    s_waitcnt vmcnt(4)
    v_mov_b32 v6, v34
    v_mov_b32 v7, v35
    v_mov_b32_dpp v34, v32 row_ror:8 row_mask:0xf bank_mask:0x3
    v_mov_b32_dpp v35, v33 row_ror:8 row_mask:0xf bank_mask:0x3
    v_mov_b32_dpp v32, v6 row_ror:8 row_mask:0xf bank_mask:0xc
    v_mov_b32_dpp v33, v7 row_ror:8 row_mask:0xf bank_mask:0xc
    s_nop 1
    v_mfma_f32_16x16x32_bf16 v[56:59], v[156:159], v[32:35], v[56:59]
    buffer_load_dwordx4 v[52:55], v11, s[12:15], s65 offen offset:2048 sc1
    ds_read_b64_tr_b16 v[120:121], v8 offset:6432
    ds_read_b64_tr_b16 v[122:123], v8 offset:7712
    v_mfma_f32_16x16x32_bf16 v[60:63], v[160:163], v[32:35], v[60:63]
    ds_read_b64_tr_b16 v[124:125], v8 offset:6464
    ds_read_b64_tr_b16 v[126:127], v8 offset:7744
    v_mfma_f32_16x16x32_bf16 v[64:67], v[164:167], v[32:35], v[64:67]
    ds_read_b64_tr_b16 v[128:129], v8 offset:6496
    ds_read_b64_tr_b16 v[130:131], v8 offset:7776
    v_mfma_f32_16x16x32_bf16 v[68:71], v[168:171], v[32:35], v[68:71]
    ds_read_b64_tr_b16 v[132:133], v8 offset:6528
    v_mfma_f32_16x16x32_bf16 v[72:75], v[172:175], v[32:35], v[72:75]
    ds_read_b64_tr_b16 v[134:135], v8 offset:7808
    s_waitcnt vmcnt(4)
    v_mfma_f32_16x16x32_bf16 v[56:59], v[176:179], v[36:39], v[56:59]
    buffer_load_dwordx4 v[16:19], v10, s[12:15], s66 offen sc1
    s_add_u32 s66, s66, 5120
    ds_read_b64_tr_b16 v[136:137], v8 offset:12800
    ds_read_b64_tr_b16 v[138:139], v8 offset:14080
    v_mfma_f32_16x16x32_bf16 v[60:63], v[180:183], v[36:39], v[60:63]
    ds_read_b64_tr_b16 v[140:141], v8 offset:12832
    ds_read_b64_tr_b16 v[142:143], v8 offset:14112
    v_mfma_f32_16x16x32_bf16 v[64:67], v[184:187], v[36:39], v[64:67]
    ds_read_b64_tr_b16 v[144:145], v8 offset:12864
    ds_read_b64_tr_b16 v[146:147], v8 offset:14144
    v_mfma_f32_16x16x32_bf16 v[68:71], v[188:191], v[36:39], v[68:71]
    ds_read_b64_tr_b16 v[148:149], v8 offset:12896
    v_mfma_f32_16x16x32_bf16 v[72:75], v[192:195], v[36:39], v[72:75]
    ds_read_b64_tr_b16 v[150:151], v8 offset:14176
    s_waitcnt vmcnt(4)
    v_mfma_f32_16x16x32_bf16 v[56:59], v[196:199], v[40:43], v[56:59]
    buffer_load_dwordx4 v[20:23], v10, s[12:15], s66 offen sc1
    s_add_u32 s66, s66, 5120
    ds_read_b64_tr_b16 v[152:153], v8 offset:12928
    ds_read_b64_tr_b16 v[154:155], v8 offset:14208
    v_mfma_f32_16x16x32_bf16 v[60:63], v[200:203], v[40:43], v[60:63]
    ds_read_b64_tr_b16 v[156:157], v8 offset:19200
    ds_read_b64_tr_b16 v[158:159], v8 offset:20480
    v_mfma_f32_16x16x32_bf16 v[64:67], v[204:207], v[40:43], v[64:67]
    ds_read_b64_tr_b16 v[160:161], v8 offset:19232
    ds_read_b64_tr_b16 v[162:163], v8 offset:20512
    v_mfma_f32_16x16x32_bf16 v[68:71], v[208:211], v[40:43], v[68:71]
    ds_read_b64_tr_b16 v[164:165], v8 offset:19264
    v_mfma_f32_16x16x32_bf16 v[72:75], v[212:215], v[40:43], v[72:75]
    ds_read_b64_tr_b16 v[166:167], v8 offset:20544
    s_waitcnt vmcnt(4)
    v_mfma_f32_16x16x32_bf16 v[56:59], v[216:219], v[44:47], v[56:59]
    buffer_load_dwordx4 v[24:27], v10, s[12:15], s66 offen sc1
    s_add_u32 s66, s66, 5120
    ds_read_b64_tr_b16 v[168:169], v8 offset:19296
    ds_read_b64_tr_b16 v[170:171], v8 offset:20576
    v_mfma_f32_16x16x32_bf16 v[60:63], v[220:223], v[44:47], v[60:63]
    ds_read_b64_tr_b16 v[172:173], v8 offset:19328
    ds_read_b64_tr_b16 v[174:175], v8 offset:20608
    v_mfma_f32_16x16x32_bf16 v[64:67], v[224:227], v[44:47], v[64:67]
    ds_read_b64_tr_b16 v[176:177], v9 offset:0
    ds_read_b64_tr_b16 v[178:179], v9 offset:12800
    v_mfma_f32_16x16x32_bf16 v[68:71], v[228:231], v[44:47], v[68:71]
    ds_read_b64_tr_b16 v[180:181], v9 offset:32
    v_mfma_f32_16x16x32_bf16 v[72:75], v[232:235], v[44:47], v[72:75]
    ds_read_b64_tr_b16 v[182:183], v9 offset:12832
    s_waitcnt vmcnt(4)
    v_mfma_f32_16x16x32_bf16 v[56:59], v[236:239], v[48:51], v[56:59]
    buffer_load_dwordx4 v[28:31], v10, s[12:15], s66 offen sc1
    s_sub_u32 s66, s66, 15360
    ds_read_b64_tr_b16 v[184:185], v9 offset:64
    ds_read_b64_tr_b16 v[186:187], v9 offset:12864
    v_mfma_f32_16x16x32_bf16 v[60:63], v[240:243], v[48:51], v[60:63]
    ds_read_b64_tr_b16 v[188:189], v9 offset:96
    ds_read_b64_tr_b16 v[190:191], v9 offset:12896
    v_mfma_f32_16x16x32_bf16 v[64:67], v[244:247], v[48:51], v[64:67]
    ds_read_b64_tr_b16 v[192:193], v9 offset:128
    ds_read_b64_tr_b16 v[194:195], v9 offset:12928
    v_mfma_f32_16x16x32_bf16 v[68:71], v[248:251], v[48:51], v[68:71]
    ds_read_b64_tr_b16 v[196:197], v8 offset:25600
    v_mfma_f32_16x16x32_bf16 v[72:75], v[252:255], v[48:51], v[72:75]
    ds_read_b64_tr_b16 v[198:199], v8 offset:26880
    s_waitcnt vmcnt(4)
    v_mov_b32 v6, v54
    v_mov_b32 v7, v55
    v_mov_b32_dpp v54, v52 row_ror:8 row_mask:0xf bank_mask:0x3
    v_mov_b32_dpp v55, v53 row_ror:8 row_mask:0xf bank_mask:0x3
    v_mov_b32_dpp v52, v6 row_ror:8 row_mask:0xf bank_mask:0xc
    v_mov_b32_dpp v53, v7 row_ror:8 row_mask:0xf bank_mask:0xc
    s_waitcnt lgkmcnt(10)
    s_nop 0
    v_mfma_f32_16x16x32_bf16 v[56:59], v[76:79], v[52:55], v[56:59]
    buffer_load_dwordx4 v[32:35], v11, s[12:15], s66 offen offset:2048 sc1
    ds_read_b64_tr_b16 v[200:201], v8 offset:25632
    ds_read_b64_tr_b16 v[202:203], v8 offset:26912
    v_mfma_f32_16x16x32_bf16 v[60:63], v[80:83], v[52:55], v[60:63]
    ds_read_b64_tr_b16 v[204:205], v8 offset:25664
    ds_read_b64_tr_b16 v[206:207], v8 offset:26944
    v_mfma_f32_16x16x32_bf16 v[64:67], v[84:87], v[52:55], v[64:67]
    ds_read_b64_tr_b16 v[208:209], v8 offset:25696
    ds_read_b64_tr_b16 v[210:211], v8 offset:26976
    v_mfma_f32_16x16x32_bf16 v[68:71], v[88:91], v[52:55], v[68:71]
    ds_read_b64_tr_b16 v[212:213], v8 offset:25728
    v_mfma_f32_16x16x32_bf16 v[72:75], v[92:95], v[52:55], v[72:75]
    ds_read_b64_tr_b16 v[214:215], v8 offset:27008
    s_waitcnt vmcnt(4)
    v_mfma_f32_16x16x32_bf16 v[56:59], v[96:99], v[16:19], v[56:59]
    buffer_load_dwordx4 v[36:39], v10, s[12:15], s67 offen sc1
    s_add_u32 s67, s67, 5120
    ds_read_b64_tr_b16 v[216:217], v8 offset:32000
    ds_read_b64_tr_b16 v[218:219], v8 offset:33280
    v_mfma_f32_16x16x32_bf16 v[60:63], v[100:103], v[16:19], v[60:63]
    ds_read_b64_tr_b16 v[220:221], v8 offset:32032
    ds_read_b64_tr_b16 v[222:223], v8 offset:33312
    v_mfma_f32_16x16x32_bf16 v[64:67], v[104:107], v[16:19], v[64:67]
    ds_read_b64_tr_b16 v[224:225], v8 offset:32064
    ds_read_b64_tr_b16 v[226:227], v8 offset:33344
    v_mfma_f32_16x16x32_bf16 v[68:71], v[108:111], v[16:19], v[68:71]
    ds_read_b64_tr_b16 v[228:229], v8 offset:32096
    v_mfma_f32_16x16x32_bf16 v[72:75], v[112:115], v[16:19], v[72:75]
    ds_read_b64_tr_b16 v[230:231], v8 offset:33376
    s_waitcnt vmcnt(4)
    v_mfma_f32_16x16x32_bf16 v[56:59], v[116:119], v[20:23], v[56:59]
    buffer_load_dwordx4 v[40:43], v10, s[12:15], s67 offen sc1
    s_add_u32 s67, s67, 5120
    ds_read_b64_tr_b16 v[232:233], v8 offset:32128
    ds_read_b64_tr_b16 v[234:235], v8 offset:33408
    v_mfma_f32_16x16x32_bf16 v[60:63], v[120:123], v[20:23], v[60:63]
    ds_read_b64_tr_b16 v[236:237], v8 offset:38400
    ds_read_b64_tr_b16 v[238:239], v8 offset:39680
    v_mfma_f32_16x16x32_bf16 v[64:67], v[124:127], v[20:23], v[64:67]
    ds_read_b64_tr_b16 v[240:241], v8 offset:38432
    ds_read_b64_tr_b16 v[242:243], v8 offset:39712
    v_mfma_f32_16x16x32_bf16 v[68:71], v[128:131], v[20:23], v[68:71]
    ds_read_b64_tr_b16 v[244:245], v8 offset:38464
    v_mfma_f32_16x16x32_bf16 v[72:75], v[132:135], v[20:23], v[72:75]
    ds_read_b64_tr_b16 v[246:247], v8 offset:39744
    s_waitcnt vmcnt(4)
    v_mfma_f32_16x16x32_bf16 v[56:59], v[136:139], v[24:27], v[56:59]
    buffer_load_dwordx4 v[44:47], v10, s[12:15], s67 offen sc1
    s_add_u32 s67, s67, 5120
    ds_read_b64_tr_b16 v[248:249], v8 offset:38496
    ds_read_b64_tr_b16 v[250:251], v8 offset:39776
    v_mfma_f32_16x16x32_bf16 v[60:63], v[140:143], v[24:27], v[60:63]
    ds_read_b64_tr_b16 v[252:253], v8 offset:38528
    ds_read_b64_tr_b16 v[254:255], v8 offset:39808
    v_mfma_f32_16x16x32_bf16 v[64:67], v[144:147], v[24:27], v[64:67]
    ds_read_b64_tr_b16 v[76:77], v8 offset:44800
    ds_read_b64_tr_b16 v[78:79], v8 offset:46080
    v_mfma_f32_16x16x32_bf16 v[68:71], v[148:151], v[24:27], v[68:71]
    ds_read_b64_tr_b16 v[80:81], v8 offset:44832
    v_mfma_f32_16x16x32_bf16 v[72:75], v[152:155], v[24:27], v[72:75]
    ds_read_b64_tr_b16 v[82:83], v8 offset:46112
    s_waitcnt vmcnt(4)
    v_mfma_f32_16x16x32_bf16 v[56:59], v[156:159], v[28:31], v[56:59]
    buffer_load_dwordx4 v[48:51], v10, s[12:15], s67 offen sc1
    s_sub_u32 s67, s67, 15360
    ds_read_b64_tr_b16 v[84:85], v8 offset:44864
    ds_read_b64_tr_b16 v[86:87], v8 offset:46144
    v_mfma_f32_16x16x32_bf16 v[60:63], v[160:163], v[28:31], v[60:63]
    ds_read_b64_tr_b16 v[88:89], v8 offset:44896
    ds_read_b64_tr_b16 v[90:91], v8 offset:46176
    v_mfma_f32_16x16x32_bf16 v[64:67], v[164:167], v[28:31], v[64:67]
    ds_read_b64_tr_b16 v[92:93], v8 offset:44928
    ds_read_b64_tr_b16 v[94:95], v8 offset:46208
    v_mfma_f32_16x16x32_bf16 v[68:71], v[168:171], v[28:31], v[68:71]
    ds_read_b64_tr_b16 v[96:97], v9 offset:25600
    v_mfma_f32_16x16x32_bf16 v[72:75], v[172:175], v[28:31], v[72:75]
    ds_read_b64_tr_b16 v[98:99], v9 offset:38400
    s_waitcnt vmcnt(4)
    v_mov_b32 v6, v34
    v_mov_b32 v7, v35
    v_mov_b32_dpp v34, v32 row_ror:8 row_mask:0xf bank_mask:0x3
    v_mov_b32_dpp v35, v33 row_ror:8 row_mask:0xf bank_mask:0x3
    v_mov_b32_dpp v32, v6 row_ror:8 row_mask:0xf bank_mask:0xc
    v_mov_b32_dpp v33, v7 row_ror:8 row_mask:0xf bank_mask:0xc
    s_nop 1
    v_mfma_f32_16x16x32_bf16 v[56:59], v[176:179], v[32:35], v[56:59]
    buffer_load_dwordx4 v[52:55], v11, s[12:15], s67 offen offset:2048 sc1
    ds_read_b64_tr_b16 v[100:101], v9 offset:25632
    ds_read_b64_tr_b16 v[102:103], v9 offset:38432
    s_waitcnt lgkmcnt(8)
    v_mfma_f32_16x16x32_bf16 v[60:63], v[180:183], v[32:35], v[60:63]
    ds_read_b64_tr_b16 v[104:105], v9 offset:25664
    ds_read_b64_tr_b16 v[106:107], v9 offset:38464
    v_mfma_f32_16x16x32_bf16 v[64:67], v[184:187], v[32:35], v[64:67]
    ds_read_b64_tr_b16 v[108:109], v9 offset:25696
    ds_read_b64_tr_b16 v[110:111], v9 offset:38496
    v_mfma_f32_16x16x32_bf16 v[68:71], v[188:191], v[32:35], v[68:71]
    ds_read_b64_tr_b16 v[112:113], v9 offset:25728
    v_mfma_f32_16x16x32_bf16 v[72:75], v[192:195], v[32:35], v[72:75]
    ds_read_b64_tr_b16 v[114:115], v9 offset:38528
    s_waitcnt vmcnt(4)
    v_mfma_f32_16x16x32_bf16 v[56:59], v[196:199], v[36:39], v[56:59]
    v_mfma_f32_16x16x32_bf16 v[60:63], v[200:203], v[36:39], v[60:63]
    v_mfma_f32_16x16x32_bf16 v[64:67], v[204:207], v[36:39], v[64:67]
    v_mfma_f32_16x16x32_bf16 v[68:71], v[208:211], v[36:39], v[68:71]
    v_mfma_f32_16x16x32_bf16 v[72:75], v[212:215], v[36:39], v[72:75]
    s_waitcnt vmcnt(3)
    v_mfma_f32_16x16x32_bf16 v[56:59], v[216:219], v[40:43], v[56:59]
    v_mfma_f32_16x16x32_bf16 v[60:63], v[220:223], v[40:43], v[60:63]
    v_mfma_f32_16x16x32_bf16 v[64:67], v[224:227], v[40:43], v[64:67]
    v_mfma_f32_16x16x32_bf16 v[68:71], v[228:231], v[40:43], v[68:71]
    v_mfma_f32_16x16x32_bf16 v[72:75], v[232:235], v[40:43], v[72:75]
    s_waitcnt vmcnt(2)
    v_mfma_f32_16x16x32_bf16 v[56:59], v[236:239], v[44:47], v[56:59]
    v_mfma_f32_16x16x32_bf16 v[60:63], v[240:243], v[44:47], v[60:63]
    v_mfma_f32_16x16x32_bf16 v[64:67], v[244:247], v[44:47], v[64:67]
    v_mfma_f32_16x16x32_bf16 v[68:71], v[248:251], v[44:47], v[68:71]
    v_mfma_f32_16x16x32_bf16 v[72:75], v[252:255], v[44:47], v[72:75]
    s_waitcnt vmcnt(1)
    v_mfma_f32_16x16x32_bf16 v[56:59], v[76:79], v[48:51], v[56:59]
    v_mfma_f32_16x16x32_bf16 v[60:63], v[80:83], v[48:51], v[60:63]
    v_mfma_f32_16x16x32_bf16 v[64:67], v[84:87], v[48:51], v[64:67]
    s_waitcnt lgkmcnt(0)
    v_mfma_f32_16x16x32_bf16 v[68:71], v[88:91], v[48:51], v[68:71]
    v_mfma_f32_16x16x32_bf16 v[72:75], v[92:95], v[48:51], v[72:75]
    s_waitcnt vmcnt(0)
    v_mov_b32 v6, v54
    v_mov_b32 v7, v55
    v_mov_b32_dpp v54, v52 row_ror:8 row_mask:0xf bank_mask:0x3
    v_mov_b32_dpp v55, v53 row_ror:8 row_mask:0xf bank_mask:0x3
    v_mov_b32_dpp v52, v6 row_ror:8 row_mask:0xf bank_mask:0xc
    v_mov_b32_dpp v53, v7 row_ror:8 row_mask:0xf bank_mask:0xc
    s_nop 1
    v_mfma_f32_16x16x32_bf16 v[56:59], v[96:99], v[52:55], v[56:59]
    v_mfma_f32_16x16x32_bf16 v[60:63], v[100:103], v[52:55], v[60:63]
    v_mfma_f32_16x16x32_bf16 v[64:67], v[104:107], v[52:55], v[64:67]
    v_mfma_f32_16x16x32_bf16 v[68:71], v[108:111], v[52:55], v[68:71]
    v_mfma_f32_16x16x32_bf16 v[72:75], v[112:115], v[52:55], v[72:75]
    s_barrier
    ds_read_b32 v8, v12 offset:5120
    ds_read_b128 v[16:19], v12 offset:0
    ds_read_b128 v[20:23], v12 offset:1024
    ds_read_b128 v[24:27], v12 offset:2048
    ds_read_b128 v[28:31], v12 offset:3072
    ds_read_b128 v[32:35], v12 offset:4096
    s_waitcnt lgkmcnt(4)
    v_pk_fma_f32 v[16:17], v[56:57], v[8:9], v[16:17] op_sel_hi:[1,0,1]
    v_pk_fma_f32 v[18:19], v[58:59], v[8:9], v[18:19] op_sel_hi:[1,0,1]
    v_cvt_pk_bf16_f32 v100, v16, v17
    v_cvt_pk_bf16_f32 v101, v18, v19
    ds_write_b64 v2, v[100:101] offset:0
    s_waitcnt lgkmcnt(4)
    v_pk_fma_f32 v[20:21], v[60:61], v[8:9], v[20:21] op_sel_hi:[1,0,1]
    v_pk_fma_f32 v[22:23], v[62:63], v[8:9], v[22:23] op_sel_hi:[1,0,1]
    v_cvt_pk_bf16_f32 v102, v20, v21
    v_cvt_pk_bf16_f32 v103, v22, v23
    ds_write_b64 v2, v[102:103] offset:32
    s_waitcnt lgkmcnt(4)
    v_pk_fma_f32 v[24:25], v[64:65], v[8:9], v[24:25] op_sel_hi:[1,0,1]
    v_pk_fma_f32 v[26:27], v[66:67], v[8:9], v[26:27] op_sel_hi:[1,0,1]
    v_cvt_pk_bf16_f32 v104, v24, v25
    v_cvt_pk_bf16_f32 v105, v26, v27
    ds_write_b64 v2, v[104:105] offset:64
    s_waitcnt lgkmcnt(4)
    v_pk_fma_f32 v[28:29], v[68:69], v[8:9], v[28:29] op_sel_hi:[1,0,1]
    v_pk_fma_f32 v[30:31], v[70:71], v[8:9], v[30:31] op_sel_hi:[1,0,1]
    v_cvt_pk_bf16_f32 v106, v28, v29
    v_cvt_pk_bf16_f32 v107, v30, v31
    ds_write_b64 v2, v[106:107] offset:96
    s_waitcnt lgkmcnt(4)
    v_pk_fma_f32 v[32:33], v[72:73], v[8:9], v[32:33] op_sel_hi:[1,0,1]
    v_pk_fma_f32 v[34:35], v[74:75], v[8:9], v[34:35] op_sel_hi:[1,0,1]
    v_cvt_pk_bf16_f32 v108, v32, v33
    v_cvt_pk_bf16_f32 v109, v34, v35
    ds_write_b64 v2, v[108:109] offset:128
    ds_read_b128 v[112:115], v3 offset:0
    ds_read_b128 v[116:119], v3 offset:1024
    ds_read_b128 v[120:123], v3 offset:2048
    s_waitcnt lgkmcnt(2)
    buffer_store_dwordx4 v[112:115], v1, s[16:19], s72 offen nt
    s_waitcnt lgkmcnt(1)
    buffer_store_dwordx4 v[116:119], v4, s[16:19], s72 offen nt
    s_waitcnt lgkmcnt(0)
    buffer_store_dwordx4 v[120:123], v15, s[16:19], s72 offen nt
    s_endpgm
L_h_post:
    v_lshlrev_b32 v29, 4, v0
    v_add_u32 v29, 156608, v29
    ds_read_b128 v[4:7], v29
    ds_read_b128 v[8:11], v29 offset:1024
    s_lshl2_add_u32 s56, s56, s26
    s_lshl2_add_u32 s57, s57, s27
    s_mov_b32 s14, 0x10000000
    s_mov_b32 s12, s54
    s_mov_b32 s13, s55
    s_cmp_lt_u32 s35, 2
    s_cselect_b32 s16, s42, s46
    s_cselect_b32 s17, s43, s47
    s_mov_b32 s18, 819200
    s_lshl_b32 s28, s21, 1
    s_and_b32 s29, s35, 1
    s_add_u32 s28, s28, s29
    s_mul_i32 s28, s28, 12800
    s_and_b32 s29, s20, 1
    s_mul_i32 s29, s29, 640
    s_add_u32 s28, s28, s29
    s_mov_b32 s72, s52
    s_mov_b32 s73, s53
    s_movk_i32 s74, 256
    v_min_u32 v14, 21, v0
    v_mul_u32_u24 v14, 12, v14
    buffer_load_dword v15, v14, s[72:75], 0 offen sc1
    s_waitcnt lgkmcnt(0)
    buffer_load_dword v13, v6, s[16:19], s28 offen
    v_mov_b32 v1, v7
    s_setprio 0
    s_waitcnt vmcnt(6)
    s_barrier
    s_waitcnt vmcnt(2)
    s_barrier
    s_mul_i32 s62, s35, 6400
    s_mov_b32 s16, s42
    s_mov_b32 s17, s43
    s_mov_b32 s18, 819200
    s_mov_b32 s8, s46
    s_mov_b32 s9, s47
    s_mov_b32 s10, 819200
    s_mul_i32 s28, s57, 160
    s_mul_i32 s63, s35, 51200
    s_add_u32 s63, s63, s28
    s_mov_b32 s61, 0x0003ffff
    s_mov_b32 s35, 0
    v_mov_b32 v2, 163776
    v_mov_b32 v3, 1
    s_waitcnt vmcnt(1)
    v_cmp_eq_u32 vcc, 0, v15
    s_nop 0
    s_cbranch_vccz L_goI
    s_mov_b32 s29, 0
    s_mov_b64 exec, -1
L_pollI:
    buffer_load_dword v15, v14, s[72:75], 0 offen sc1
    s_add_u32 s29, s29, 1
    s_cmp_ge_u32 s29, 2000000
    s_cbranch_scc1 L_goI
    s_waitcnt vmcnt(0)
    v_cmp_eq_u32 vcc, 0, v15
    s_nop 0
    s_cbranch_vccz L_goI
    s_mov_b64 exec, vcc
    s_sleep 5
    s_branch L_pollI
L_goI:
    s_mov_b64 exec, -1
    s_barrier
    s_and_b32 s73, s25, 3
    s_mul_i32 s74, s56, 163840
    s_add_u32 s74, s74, 7143424
    s_lshl_b32 s28, s73, 7
    s_add_u32 s74, s74, s28
    s_mul_i32 s30, s73, 6144
    s_add_u32 s28, s35, 0
    s_and_b32 s28, s28, 3
    s_mul_i32 s28, s28, 20480
    s_add_u32 s64, s28, s74
    s_add_u32 s28, s35, 1
    s_and_b32 s28, s28, 3
    s_mul_i32 s28, s28, 20480
    s_add_u32 s65, s28, s74
    s_add_u32 s28, s35, 2
    s_and_b32 s28, s28, 3
    s_mul_i32 s28, s28, 20480
    s_add_u32 s66, s28, s74
    s_add_u32 s28, s35, 3
    s_and_b32 s28, s28, 3
    s_mul_i32 s28, s28, 20480
    s_add_u32 s67, s28, s74
    s_lshr_b32 s28, s56, 1
    s_lshl_b32 s28, s28, 11
    s_add_u32 s74, s28, 16384
    v_lshl_add_u32 v12, v0, 4, s30
    s_mov_b64 vcc, 0
    s_cmp_eq_u32 s23, 0
    s_cbranch_scc1 L_h_sA
    s_add_u32 s28, s35, 0
    s_and_b32 s28, s28, 3
    s_mul_i32 s75, s28, 204800
    s_add_u32 s75, s75, s63
    s_add_u32 m0, s62, 0
    s_mov_b64 exec, s[60:61]
    buffer_load_dwordx4 v4, s[16:19], s75 offen offset:0 lds
    s_waitcnt vmcnt(0)
    s_add_u32 s75, s75, 5600
    buffer_load_dwordx4 v4, s[16:19], s75 offen offset:800 lds
    s_waitcnt vmcnt(0)
    s_add_u32 s75, s75, 5600
    buffer_load_dwordx4 v4, s[16:19], s75 offen offset:1600 lds
    s_waitcnt vmcnt(0)
    s_add_u32 s75, s75, 5600
    buffer_load_dwordx4 v4, s[16:19], s75 offen offset:2400 lds
    s_waitcnt vmcnt(0)
    s_add_u32 m0, m0, 3200
    s_add_u32 s75, s75, 8800
    buffer_load_dwordx4 v4, s[16:19], s75 offen offset:0 lds
    s_waitcnt vmcnt(0)
    s_add_u32 s75, s75, 5600
    buffer_load_dwordx4 v4, s[16:19], s75 offen offset:800 lds
    s_waitcnt vmcnt(0)
    s_add_u32 s75, s75, 5600
    buffer_load_dwordx4 v4, s[16:19], s75 offen offset:1600 lds
    s_waitcnt vmcnt(0)
    s_add_u32 s75, s75, 5600
    buffer_load_dwordx4 v4, s[16:19], s75 offen offset:2400 lds
    s_waitcnt vmcnt(0)
    s_mov_b64 exec, -1
    s_mov_b32 s29, 0
L_lwh1b:
    ds_read_b32 v6, v2 offset:24
    s_add_u32 s29, s29, 1
    s_lshr_b32 s31, s29, 21
    s_waitcnt lgkmcnt(0)
    s_setprio 3
    v_readfirstlane_b32 s28, v6
    s_setprio 0
    s_max_u32 s28, s28, s31
    s_cmp_ge_u32 s28, 4
    s_cbranch_scc1 L_lgh1b
    s_sleep 4
    s_branch L_lwh1b
L_lgh1b:
    s_add_u32 s28, s35, 1
    s_and_b32 s28, s28, 3
    s_mul_i32 s75, s28, 204800
    s_add_u32 s75, s75, s63
    s_add_u32 m0, s62, 25600
    s_mov_b64 exec, s[60:61]
    buffer_load_dwordx4 v4, s[16:19], s75 offen offset:0 lds
    s_waitcnt vmcnt(3)
    s_add_u32 s75, s75, 5600
    buffer_load_dwordx4 v4, s[16:19], s75 offen offset:800 lds
    s_waitcnt vmcnt(3)
    s_add_u32 s75, s75, 5600
    buffer_load_dwordx4 v4, s[16:19], s75 offen offset:1600 lds
    s_waitcnt vmcnt(3)
    s_add_u32 s75, s75, 5600
    buffer_load_dwordx4 v4, s[16:19], s75 offen offset:2400 lds
    s_waitcnt vmcnt(3)
    s_add_u32 m0, m0, 3200
    s_add_u32 s75, s75, 8800
    buffer_load_dwordx4 v4, s[16:19], s75 offen offset:0 lds
    s_waitcnt vmcnt(3)
    s_add_u32 s75, s75, 5600
    buffer_load_dwordx4 v4, s[16:19], s75 offen offset:800 lds
    s_waitcnt vmcnt(3)
    s_add_u32 s75, s75, 5600
    buffer_load_dwordx4 v4, s[16:19], s75 offen offset:1600 lds
    s_waitcnt vmcnt(3)
    s_add_u32 s75, s75, 5600
    buffer_load_dwordx4 v4, s[16:19], s75 offen offset:2400 lds
    s_waitcnt vmcnt(3)
    s_mov_b64 exec, -1
    s_add_u32 s28, s35, 0
    s_and_b32 s28, s28, 3
    s_mul_i32 s75, s28, 204800
    s_add_u32 s75, s75, s63
    s_add_u32 m0, s62, 51200
    s_mov_b64 exec, s[60:61]
    buffer_load_dwordx4 v4, s[8:11], s75 offen offset:0 lds
    s_waitcnt vmcnt(3)
    s_add_u32 s75, s75, 5600
    buffer_load_dwordx4 v4, s[8:11], s75 offen offset:800 lds
    s_waitcnt vmcnt(3)
    s_add_u32 s75, s75, 5600
    buffer_load_dwordx4 v4, s[8:11], s75 offen offset:1600 lds
    s_waitcnt vmcnt(3)
    s_add_u32 s75, s75, 5600
    buffer_load_dwordx4 v4, s[8:11], s75 offen offset:2400 lds
    s_waitcnt vmcnt(3)
    s_add_u32 m0, m0, 3200
    s_add_u32 s75, s75, 8800
    buffer_load_dwordx4 v4, s[8:11], s75 offen offset:0 lds
    s_waitcnt vmcnt(3)
    s_add_u32 s75, s75, 5600
    buffer_load_dwordx4 v4, s[8:11], s75 offen offset:800 lds
    s_mov_b64 exec, -1
    s_waitcnt vmcnt(6)
    s_mov_b64 exec, 1
    ds_add_u32 v2, v3 offset:4
    s_mov_b64 exec, -1
    s_mov_b64 exec, s[60:61]
    s_waitcnt vmcnt(3)
    s_add_u32 s75, s75, 5600
    buffer_load_dwordx4 v4, s[8:11], s75 offen offset:1600 lds
    s_waitcnt vmcnt(3)
    s_add_u32 s75, s75, 5600
    buffer_load_dwordx4 v4, s[8:11], s75 offen offset:2400 lds
    s_waitcnt vmcnt(3)
    s_mov_b64 exec, -1
    s_add_u32 s28, s35, 1
    s_and_b32 s28, s28, 3
    s_mul_i32 s75, s28, 204800
    s_add_u32 s75, s75, s63
    s_add_u32 m0, s62, 76800
    s_mov_b64 exec, s[60:61]
    buffer_load_dwordx4 v4, s[8:11], s75 offen offset:0 lds
    s_waitcnt vmcnt(3)
    s_add_u32 s75, s75, 5600
    buffer_load_dwordx4 v4, s[8:11], s75 offen offset:800 lds
    s_waitcnt vmcnt(3)
    s_add_u32 s75, s75, 5600
    buffer_load_dwordx4 v4, s[8:11], s75 offen offset:1600 lds
    s_mov_b64 exec, -1
    s_mov_b32 s29, 0
L_lwc0b:
    ds_read_b32 v6, v2 offset:0
    s_add_u32 s29, s29, 1
    s_lshr_b32 s31, s29, 21
    s_waitcnt lgkmcnt(0)
    s_setprio 3
    v_readfirstlane_b32 s28, v6
    s_setprio 0
    s_max_u32 s28, s28, s31
    s_cmp_ge_u32 s28, 4
    s_cbranch_scc1 L_lgc0b
    s_sleep 2
    s_branch L_lwc0b
L_lgc0b:
    s_mov_b32 s29, 0
L_lwc1b:
    ds_read_b32 v6, v2 offset:4
    s_add_u32 s29, s29, 1
    s_lshr_b32 s31, s29, 21
    s_waitcnt lgkmcnt(0)
    s_setprio 3
    v_readfirstlane_b32 s28, v6
    s_setprio 0
    s_max_u32 s28, s28, s31
    s_cmp_ge_u32 s28, 4
    s_cbranch_scc1 L_lgc1b
    s_sleep 2
    s_branch L_lwc1b
L_lgc1b:
    ds_read_b64_tr_b16 v[56:57], v8 offset:0
    ds_read_b64_tr_b16 v[58:59], v8 offset:1280
    ds_read_b64_tr_b16 v[60:61], v8 offset:32
    ds_read_b64_tr_b16 v[62:63], v8 offset:1312
    ds_read_b64_tr_b16 v[64:65], v8 offset:64
    ds_read_b64_tr_b16 v[66:67], v8 offset:1344
    s_mov_b64 exec, s[60:61]
    s_waitcnt vmcnt(3)
    s_add_u32 s75, s75, 5600
    buffer_load_dwordx4 v4, s[8:11], s75 offen offset:2400 lds
    s_mov_b64 exec, -1
    ds_read_b64_tr_b16 v[68:69], v8 offset:96
    ds_read_b64_tr_b16 v[70:71], v8 offset:1376
    ds_read_b64_tr_b16 v[72:73], v8 offset:128
    ds_read_b64_tr_b16 v[74:75], v8 offset:1408
    ds_read_b64_tr_b16 v[76:77], v8 offset:6400
    ds_read_b64_tr_b16 v[78:79], v8 offset:7680
    s_mov_b64 exec, s[60:61]
    s_waitcnt vmcnt(3)
    s_add_u32 m0, m0, 3200
    s_add_u32 s75, s75, 8800
    buffer_load_dwordx4 v4, s[8:11], s75 offen offset:0 lds
    s_mov_b64 exec, -1
    ds_read_b64_tr_b16 v[80:81], v8 offset:6432
    ds_read_b64_tr_b16 v[82:83], v8 offset:7712
    ds_read_b64_tr_b16 v[84:85], v8 offset:6464
    ds_read_b64_tr_b16 v[86:87], v8 offset:7744
    ds_read_b64_tr_b16 v[88:89], v8 offset:6496
    ds_read_b64_tr_b16 v[90:91], v8 offset:7776
    s_mov_b64 exec, s[60:61]
    s_waitcnt vmcnt(3)
    s_add_u32 s75, s75, 5600
    buffer_load_dwordx4 v4, s[8:11], s75 offen offset:800 lds
    s_mov_b64 exec, -1
    ds_read_b64_tr_b16 v[92:93], v8 offset:6528
    ds_read_b64_tr_b16 v[94:95], v8 offset:7808
    ds_read_b64_tr_b16 v[96:97], v8 offset:12800
    ds_read_b64_tr_b16 v[98:99], v8 offset:14080
    ds_read_b64_tr_b16 v[100:101], v8 offset:12832
    ds_read_b64_tr_b16 v[102:103], v8 offset:14112
    s_mov_b64 exec, s[60:61]
    s_waitcnt vmcnt(3)
    s_add_u32 s75, s75, 5600
    buffer_load_dwordx4 v4, s[8:11], s75 offen offset:1600 lds
    s_mov_b64 exec, -1
    ds_read_b64_tr_b16 v[104:105], v8 offset:12864
    ds_read_b64_tr_b16 v[106:107], v8 offset:14144
    ds_read_b64_tr_b16 v[108:109], v8 offset:12896
    ds_read_b64_tr_b16 v[110:111], v8 offset:14176
    ds_read_b64_tr_b16 v[112:113], v8 offset:12928
    ds_read_b64_tr_b16 v[114:115], v8 offset:14208
    s_mov_b64 exec, s[60:61]
    s_waitcnt vmcnt(3)
    s_add_u32 s75, s75, 5600
    buffer_load_dwordx4 v4, s[8:11], s75 offen offset:2400 lds
    s_mov_b64 exec, -1
    ds_read_b64_tr_b16 v[116:117], v8 offset:19200
    ds_read_b64_tr_b16 v[118:119], v8 offset:20480
    ds_read_b64_tr_b16 v[120:121], v8 offset:19232
    ds_read_b64_tr_b16 v[122:123], v8 offset:20512
    ds_read_b64_tr_b16 v[124:125], v8 offset:19264
    ds_read_b64_tr_b16 v[126:127], v8 offset:20544
    s_mov_b64 exec, s[60:61]
    s_waitcnt vmcnt(3)
    s_mov_b64 exec, -1
    s_add_u32 s28, s35, 2
    s_and_b32 s28, s28, 3
    s_mul_i32 s75, s28, 204800
    s_add_u32 s75, s75, s63
    s_add_u32 m0, s62, 102400
    s_mov_b64 exec, s[60:61]
    buffer_load_dwordx4 v4, s[8:11], s75 offen offset:0 lds
    s_mov_b64 exec, -1
    ds_read_b64_tr_b16 v[128:129], v8 offset:19296
    ds_read_b64_tr_b16 v[130:131], v8 offset:20576
    ds_read_b64_tr_b16 v[132:133], v8 offset:19328
    ds_read_b64_tr_b16 v[134:135], v8 offset:20608
    ds_read_b64_tr_b16 v[136:137], v9 offset:0
    ds_read_b64_tr_b16 v[138:139], v9 offset:12800
    s_mov_b64 exec, s[60:61]
    s_waitcnt vmcnt(3)
    s_add_u32 s75, s75, 5600
    buffer_load_dwordx4 v4, s[8:11], s75 offen offset:800 lds
    s_mov_b64 exec, -1
    ds_read_b64_tr_b16 v[140:141], v9 offset:32
    ds_read_b64_tr_b16 v[142:143], v9 offset:12832
    ds_read_b64_tr_b16 v[144:145], v9 offset:64
    ds_read_b64_tr_b16 v[146:147], v9 offset:12864
    ds_read_b64_tr_b16 v[148:149], v9 offset:96
    ds_read_b64_tr_b16 v[150:151], v9 offset:12896
    s_mov_b64 exec, s[60:61]
    s_waitcnt vmcnt(3)
    s_add_u32 s75, s75, 5600
    buffer_load_dwordx4 v4, s[8:11], s75 offen offset:1600 lds
    s_mov_b64 exec, -1
    ds_read_b64_tr_b16 v[152:153], v9 offset:128
    ds_read_b64_tr_b16 v[154:155], v9 offset:12928
    ds_read_b64_tr_b16 v[156:157], v8 offset:25600
    ds_read_b64_tr_b16 v[158:159], v8 offset:26880
    ds_read_b64_tr_b16 v[160:161], v8 offset:25632
    ds_read_b64_tr_b16 v[162:163], v8 offset:26912
    s_mov_b64 exec, s[60:61]
    s_waitcnt vmcnt(3)
    s_add_u32 s75, s75, 5600
    buffer_load_dwordx4 v4, s[8:11], s75 offen offset:2400 lds
    s_mov_b64 exec, -1
    ds_read_b64_tr_b16 v[164:165], v8 offset:25664
    ds_read_b64_tr_b16 v[166:167], v8 offset:26944
    ds_read_b64_tr_b16 v[168:169], v8 offset:25696
    ds_read_b64_tr_b16 v[170:171], v8 offset:26976
    ds_read_b64_tr_b16 v[172:173], v8 offset:25728
    ds_read_b64_tr_b16 v[174:175], v8 offset:27008
    s_mov_b64 exec, s[60:61]
    s_waitcnt vmcnt(3)
    s_add_u32 m0, m0, 3200
    s_add_u32 s75, s75, 8800
    buffer_load_dwordx4 v4, s[8:11], s75 offen offset:0 lds
    s_mov_b64 exec, -1
    ds_read_b64_tr_b16 v[176:177], v8 offset:32000
    ds_read_b64_tr_b16 v[178:179], v8 offset:33280
    ds_read_b64_tr_b16 v[180:181], v8 offset:32032
    ds_read_b64_tr_b16 v[182:183], v8 offset:33312
    ds_read_b64_tr_b16 v[184:185], v8 offset:32064
    ds_read_b64_tr_b16 v[186:187], v8 offset:33344
    s_mov_b64 exec, s[60:61]
    s_waitcnt vmcnt(3)
    s_add_u32 s75, s75, 5600
    buffer_load_dwordx4 v4, s[8:11], s75 offen offset:800 lds
    s_mov_b64 exec, -1
    s_waitcnt vmcnt(6)
    s_mov_b64 exec, 1
    ds_add_u32 v2, v3 offset:16
    s_mov_b64 exec, -1
    ds_read_b64_tr_b16 v[188:189], v8 offset:32096
    ds_read_b64_tr_b16 v[190:191], v8 offset:33376
    ds_read_b64_tr_b16 v[192:193], v8 offset:32128
    ds_read_b64_tr_b16 v[194:195], v8 offset:33408
    ds_read_b64_tr_b16 v[196:197], v8 offset:38400
    ds_read_b64_tr_b16 v[198:199], v8 offset:39680
    s_mov_b64 exec, s[60:61]
    s_waitcnt vmcnt(3)
    s_add_u32 s75, s75, 5600
    buffer_load_dwordx4 v4, s[8:11], s75 offen offset:1600 lds
    s_mov_b64 exec, -1
    ds_read_b64_tr_b16 v[200:201], v8 offset:38432
    ds_read_b64_tr_b16 v[202:203], v8 offset:39712
    ds_read_b64_tr_b16 v[204:205], v8 offset:38464
    ds_read_b64_tr_b16 v[206:207], v8 offset:39744
    ds_read_b64_tr_b16 v[208:209], v8 offset:38496
    ds_read_b64_tr_b16 v[210:211], v8 offset:39776
    s_mov_b64 exec, s[60:61]
    s_waitcnt vmcnt(3)
    s_add_u32 s75, s75, 5600
    buffer_load_dwordx4 v4, s[8:11], s75 offen offset:2400 lds
    s_mov_b64 exec, -1
    ds_read_b64_tr_b16 v[212:213], v8 offset:38528
    ds_read_b64_tr_b16 v[214:215], v8 offset:39808
    ds_read_b64_tr_b16 v[216:217], v8 offset:44800
    ds_read_b64_tr_b16 v[218:219], v8 offset:46080
    ds_read_b64_tr_b16 v[220:221], v8 offset:44832
    ds_read_b64_tr_b16 v[222:223], v8 offset:46112
    s_mov_b64 exec, s[60:61]
    s_waitcnt vmcnt(3)
    s_mov_b64 exec, -1
    s_add_u32 s28, s35, 3
    s_and_b32 s28, s28, 3
    s_mul_i32 s75, s28, 204800
    s_add_u32 s75, s75, s63
    s_add_u32 m0, s62, 128000
    s_mov_b64 exec, s[60:61]
    buffer_load_dwordx4 v4, s[8:11], s75 offen offset:0 lds
    s_mov_b64 exec, -1
    ds_read_b64_tr_b16 v[224:225], v8 offset:44864
    ds_read_b64_tr_b16 v[226:227], v8 offset:46144
    ds_read_b64_tr_b16 v[228:229], v8 offset:44896
    ds_read_b64_tr_b16 v[230:231], v8 offset:46176
    ds_read_b64_tr_b16 v[232:233], v8 offset:44928
    ds_read_b64_tr_b16 v[234:235], v8 offset:46208
    s_mov_b64 exec, s[60:61]
    s_waitcnt vmcnt(3)
    s_add_u32 s75, s75, 5600
    buffer_load_dwordx4 v4, s[8:11], s75 offen offset:800 lds
    s_mov_b64 exec, -1
    ds_read_b64_tr_b16 v[236:237], v9 offset:25600
    ds_read_b64_tr_b16 v[238:239], v9 offset:38400
    ds_read_b64_tr_b16 v[240:241], v9 offset:25632
    ds_read_b64_tr_b16 v[242:243], v9 offset:38432
    ds_read_b64_tr_b16 v[244:245], v9 offset:25664
    ds_read_b64_tr_b16 v[246:247], v9 offset:38464
    s_mov_b64 exec, s[60:61]
    s_waitcnt vmcnt(3)
    s_add_u32 s75, s75, 5600
    buffer_load_dwordx4 v4, s[8:11], s75 offen offset:1600 lds
    s_mov_b64 exec, -1
    ds_read_b64_tr_b16 v[248:249], v9 offset:25696
    ds_read_b64_tr_b16 v[250:251], v9 offset:38496
    ds_read_b64_tr_b16 v[252:253], v9 offset:25728
    ds_read_b64_tr_b16 v[254:255], v9 offset:38528
    s_mov_b64 exec, s[60:61]
    s_waitcnt vmcnt(3)
    s_add_u32 s75, s75, 5600
    buffer_load_dwordx4 v4, s[8:11], s75 offen offset:2400 lds
    s_mov_b64 exec, -1
    s_waitcnt lgkmcnt(0)
    s_mov_b64 exec, 1
    ds_add_u32 v2, v3 offset:8
    s_mov_b64 exec, -1
    s_mov_b64 exec, s[60:61]
    s_waitcnt vmcnt(3)
    s_add_u32 m0, m0, 3200
    s_add_u32 s75, s75, 8800
    buffer_load_dwordx4 v4, s[8:11], s75 offen offset:0 lds
    s_waitcnt vmcnt(3)
    s_add_u32 s75, s75, 5600
    buffer_load_dwordx4 v4, s[8:11], s75 offen offset:800 lds
    s_waitcnt vmcnt(3)
    s_add_u32 s75, s75, 5600
    buffer_load_dwordx4 v4, s[8:11], s75 offen offset:1600 lds
    s_waitcnt vmcnt(3)
    s_add_u32 s75, s75, 5600
    buffer_load_dwordx4 v4, s[8:11], s75 offen offset:2400 lds
    s_waitcnt vmcnt(3)
    s_mov_b64 exec, -1
    s_mov_b32 s29, 0
L_lwc2b:
    ds_read_b32 v6, v2 offset:8
    s_add_u32 s29, s29, 1
    s_lshr_b32 s31, s29, 21
    s_waitcnt lgkmcnt(0)
    s_setprio 3
    v_readfirstlane_b32 s28, v6
    s_setprio 0
    s_max_u32 s28, s28, s31
    s_cmp_ge_u32 s28, 4
    s_cbranch_scc1 L_lgc2b
    s_sleep 2
    s_branch L_lwc2b
L_lgc2b:
    s_add_u32 s28, s35, 2
    s_and_b32 s28, s28, 3
    s_mul_i32 s75, s28, 204800
    s_add_u32 s75, s75, s63
    s_add_u32 m0, s62, 0
    s_mov_b64 exec, s[60:61]
    buffer_load_dwordx4 v4, s[16:19], s75 offen offset:0 lds
    s_waitcnt vmcnt(3)
    s_add_u32 s75, s75, 5600
    buffer_load_dwordx4 v4, s[16:19], s75 offen offset:800 lds
    s_waitcnt vmcnt(3)
    s_add_u32 s75, s75, 5600
    buffer_load_dwordx4 v4, s[16:19], s75 offen offset:1600 lds
    s_waitcnt vmcnt(3)
    s_add_u32 s75, s75, 5600
    buffer_load_dwordx4 v4, s[16:19], s75 offen offset:2400 lds
    s_waitcnt vmcnt(3)
    s_add_u32 m0, m0, 3200
    s_add_u32 s75, s75, 8800
    buffer_load_dwordx4 v4, s[16:19], s75 offen offset:0 lds
    s_waitcnt vmcnt(3)
    s_add_u32 s75, s75, 5600
    buffer_load_dwordx4 v4, s[16:19], s75 offen offset:800 lds
    s_mov_b64 exec, -1
    s_waitcnt vmcnt(6)
    s_mov_b64 exec, 1
    ds_add_u32 v2, v3 offset:28
    s_mov_b64 exec, -1
    s_mov_b64 exec, s[60:61]
    s_waitcnt vmcnt(3)
    s_add_u32 s75, s75, 5600
    buffer_load_dwordx4 v4, s[16:19], s75 offen offset:1600 lds
    s_waitcnt vmcnt(3)
    s_add_u32 s75, s75, 5600
    buffer_load_dwordx4 v4, s[16:19], s75 offen offset:2400 lds
    s_waitcnt vmcnt(3)
    s_mov_b64 exec, -1
    s_add_u32 s28, s35, 3
    s_and_b32 s28, s28, 3
    s_mul_i32 s75, s28, 204800
    s_add_u32 s75, s75, s63
    s_add_u32 m0, s62, 25600
    s_mov_b64 exec, s[60:61]
    buffer_load_dwordx4 v4, s[16:19], s75 offen offset:0 lds
    s_waitcnt vmcnt(3)
    s_add_u32 s75, s75, 5600
    buffer_load_dwordx4 v4, s[16:19], s75 offen offset:800 lds
    s_waitcnt vmcnt(3)
    s_add_u32 s75, s75, 5600
    buffer_load_dwordx4 v4, s[16:19], s75 offen offset:1600 lds
    s_waitcnt vmcnt(3)
    s_add_u32 s75, s75, 5600
    buffer_load_dwordx4 v4, s[16:19], s75 offen offset:2400 lds
    s_waitcnt vmcnt(3)
    s_add_u32 m0, m0, 3200
    s_add_u32 s75, s75, 8800
    buffer_load_dwordx4 v4, s[16:19], s75 offen offset:0 lds
    s_waitcnt vmcnt(3)
    s_add_u32 s75, s75, 5600
    buffer_load_dwordx4 v4, s[16:19], s75 offen offset:800 lds
    s_waitcnt vmcnt(3)
    s_add_u32 s75, s75, 5600
    buffer_load_dwordx4 v4, s[16:19], s75 offen offset:1600 lds
    s_waitcnt vmcnt(3)
    s_add_u32 s75, s75, 5600
    buffer_load_dwordx4 v4, s[16:19], s75 offen offset:2400 lds
    s_waitcnt vmcnt(3)
    s_mov_b64 exec, -1
    s_branch L_h_sJ
L_h_sA:
    s_add_u32 s28, s35, 0
    s_and_b32 s28, s28, 3
    s_mul_i32 s75, s28, 204800
    s_add_u32 s75, s75, s63
    s_add_u32 m0, s62, 0
    s_mov_b64 exec, s[60:61]
    buffer_load_dwordx4 v4, s[16:19], s75 offen offset:0 lds
    s_waitcnt vmcnt(1)
    s_add_u32 s75, s75, 5600
    buffer_load_dwordx4 v4, s[16:19], s75 offen offset:800 lds
    s_waitcnt vmcnt(1)
    s_add_u32 s75, s75, 5600
    buffer_load_dwordx4 v4, s[16:19], s75 offen offset:1600 lds
    s_waitcnt vmcnt(1)
    s_add_u32 s75, s75, 5600
    buffer_load_dwordx4 v4, s[16:19], s75 offen offset:2400 lds
    s_waitcnt vmcnt(1)
    s_add_u32 m0, m0, 3200
    s_add_u32 s75, s75, 8800
    buffer_load_dwordx4 v4, s[16:19], s75 offen offset:0 lds
    s_waitcnt vmcnt(1)
    s_add_u32 s75, s75, 5600
    buffer_load_dwordx4 v4, s[16:19], s75 offen offset:800 lds
    s_waitcnt vmcnt(1)
    s_add_u32 s75, s75, 5600
    buffer_load_dwordx4 v4, s[16:19], s75 offen offset:1600 lds
    s_waitcnt vmcnt(1)
    s_add_u32 s75, s75, 5600
    buffer_load_dwordx4 v4, s[16:19], s75 offen offset:2400 lds
    s_waitcnt vmcnt(1)
    s_mov_b64 exec, -1
    s_add_u32 s28, s35, 1
    s_and_b32 s28, s28, 3
    s_mul_i32 s75, s28, 204800
    s_add_u32 s75, s75, s63
    s_add_u32 m0, s62, 25600
    s_mov_b64 exec, s[60:61]
    buffer_load_dwordx4 v4, s[16:19], s75 offen offset:0 lds
    s_waitcnt vmcnt(1)
    s_add_u32 s75, s75, 5600
    buffer_load_dwordx4 v4, s[16:19], s75 offen offset:800 lds
    s_waitcnt vmcnt(1)
    s_add_u32 s75, s75, 5600
    buffer_load_dwordx4 v4, s[16:19], s75 offen offset:1600 lds
    s_waitcnt vmcnt(1)
    s_add_u32 s75, s75, 5600
    buffer_load_dwordx4 v4, s[16:19], s75 offen offset:2400 lds
    s_waitcnt vmcnt(1)
    s_add_u32 m0, m0, 3200
    s_add_u32 s75, s75, 8800
    buffer_load_dwordx4 v4, s[16:19], s75 offen offset:0 lds
    s_waitcnt vmcnt(1)
    s_add_u32 s75, s75, 5600
    buffer_load_dwordx4 v4, s[16:19], s75 offen offset:800 lds
    s_waitcnt vmcnt(1)
    s_add_u32 s75, s75, 5600
    buffer_load_dwordx4 v4, s[16:19], s75 offen offset:1600 lds
    s_waitcnt vmcnt(1)
    s_add_u32 s75, s75, 5600
    buffer_load_dwordx4 v4, s[16:19], s75 offen offset:2400 lds
    s_waitcnt vmcnt(1)
    s_mov_b64 exec, -1
    s_add_u32 s28, s35, 0
    s_and_b32 s28, s28, 3
    s_mul_i32 s75, s28, 204800
    s_add_u32 s75, s75, s63
    s_add_u32 m0, s62, 51200
    s_mov_b64 exec, s[60:61]
    buffer_load_dwordx4 v4, s[8:11], s75 offen offset:0 lds
    s_waitcnt vmcnt(1)
    s_add_u32 s75, s75, 5600
    buffer_load_dwordx4 v4, s[8:11], s75 offen offset:800 lds
    s_waitcnt vmcnt(1)
    s_add_u32 s75, s75, 5600
    buffer_load_dwordx4 v4, s[8:11], s75 offen offset:1600 lds
    s_waitcnt vmcnt(1)
    s_add_u32 s75, s75, 5600
    buffer_load_dwordx4 v4, s[8:11], s75 offen offset:2400 lds
    s_waitcnt vmcnt(1)
    s_add_u32 m0, m0, 3200
    s_add_u32 s75, s75, 8800
    buffer_load_dwordx4 v4, s[8:11], s75 offen offset:0 lds
    s_waitcnt vmcnt(1)
    s_add_u32 s75, s75, 5600
    buffer_load_dwordx4 v4, s[8:11], s75 offen offset:800 lds
    s_mov_b64 exec, -1
    s_waitcnt vmcnt(6)
    s_mov_b64 exec, 1
    ds_add_u32 v2, v3 offset:4
    s_mov_b64 exec, -1
    s_mov_b64 exec, s[60:61]
    s_waitcnt vmcnt(1)
    s_add_u32 s75, s75, 5600
    buffer_load_dwordx4 v4, s[8:11], s75 offen offset:1600 lds
    s_waitcnt vmcnt(1)
    s_add_u32 s75, s75, 5600
    buffer_load_dwordx4 v4, s[8:11], s75 offen offset:2400 lds
    s_waitcnt vmcnt(1)
    s_mov_b64 exec, -1
    s_add_u32 s28, s35, 1
    s_and_b32 s28, s28, 3
    s_mul_i32 s75, s28, 204800
    s_add_u32 s75, s75, s63
    s_add_u32 m0, s62, 76800
    s_mov_b64 exec, s[60:61]
    buffer_load_dwordx4 v4, s[8:11], s75 offen offset:0 lds
    s_waitcnt vmcnt(1)
    s_add_u32 s75, s75, 5600
    buffer_load_dwordx4 v4, s[8:11], s75 offen offset:800 lds
    s_waitcnt vmcnt(1)
    s_add_u32 s75, s75, 5600
    buffer_load_dwordx4 v4, s[8:11], s75 offen offset:1600 lds
    s_waitcnt vmcnt(1)
    s_add_u32 s75, s75, 5600
    buffer_load_dwordx4 v4, s[8:11], s75 offen offset:2400 lds
    s_waitcnt vmcnt(1)
    s_add_u32 m0, m0, 3200
    s_add_u32 s75, s75, 8800
    buffer_load_dwordx4 v4, s[8:11], s75 offen offset:0 lds
    s_waitcnt vmcnt(1)
    s_add_u32 s75, s75, 5600
    buffer_load_dwordx4 v4, s[8:11], s75 offen offset:800 lds
    s_waitcnt vmcnt(1)
    s_add_u32 s75, s75, 5600
    buffer_load_dwordx4 v4, s[8:11], s75 offen offset:1600 lds
    s_waitcnt vmcnt(1)
    s_add_u32 s75, s75, 5600
    buffer_load_dwordx4 v4, s[8:11], s75 offen offset:2400 lds
    s_waitcnt vmcnt(1)
    s_mov_b64 exec, -1
    s_mov_b32 s29, 0
L_lwc0a:
    ds_read_b32 v6, v2 offset:0
    s_add_u32 s29, s29, 1
    s_lshr_b32 s31, s29, 21
    s_waitcnt lgkmcnt(0)
    s_setprio 3
    v_readfirstlane_b32 s28, v6
    s_setprio 0
    s_max_u32 s28, s28, s31
    s_cmp_ge_u32 s28, 4
    s_cbranch_scc1 L_lgc0a
    s_sleep 2
    s_branch L_lwc0a
L_lgc0a:
    s_mov_b32 s29, 0
L_lwc1a:
    ds_read_b32 v6, v2 offset:4
    s_add_u32 s29, s29, 1
    s_lshr_b32 s31, s29, 21
    s_waitcnt lgkmcnt(0)
    s_setprio 3
    v_readfirstlane_b32 s28, v6
    s_setprio 0
    s_max_u32 s28, s28, s31
    s_cmp_ge_u32 s28, 4
    s_cbranch_scc1 L_lgc1a
    s_sleep 2
    s_branch L_lwc1a
L_lgc1a:
    ds_read_b64_tr_b16 v[56:57], v8 offset:0
    ds_read_b64_tr_b16 v[58:59], v8 offset:1280
    ds_read_b64_tr_b16 v[60:61], v8 offset:32
    ds_read_b64_tr_b16 v[62:63], v8 offset:1312
    ds_read_b64_tr_b16 v[64:65], v8 offset:64
    ds_read_b64_tr_b16 v[66:67], v8 offset:1344
    ds_read_b64_tr_b16 v[68:69], v8 offset:96
    ds_read_b64_tr_b16 v[70:71], v8 offset:1376
    ds_read_b64_tr_b16 v[72:73], v8 offset:128
    ds_read_b64_tr_b16 v[74:75], v8 offset:1408
    ds_read_b64_tr_b16 v[76:77], v8 offset:6400
    ds_read_b64_tr_b16 v[78:79], v8 offset:7680
    ds_read_b64_tr_b16 v[80:81], v8 offset:6432
    ds_read_b64_tr_b16 v[82:83], v8 offset:7712
    ds_read_b64_tr_b16 v[84:85], v8 offset:6464
    ds_read_b64_tr_b16 v[86:87], v8 offset:7744
    ds_read_b64_tr_b16 v[88:89], v8 offset:6496
    ds_read_b64_tr_b16 v[90:91], v8 offset:7776
    ds_read_b64_tr_b16 v[92:93], v8 offset:6528
    ds_read_b64_tr_b16 v[94:95], v8 offset:7808
    ds_read_b64_tr_b16 v[96:97], v8 offset:12800
    ds_read_b64_tr_b16 v[98:99], v8 offset:14080
    ds_read_b64_tr_b16 v[100:101], v8 offset:12832
    ds_read_b64_tr_b16 v[102:103], v8 offset:14112
    ds_read_b64_tr_b16 v[104:105], v8 offset:12864
    ds_read_b64_tr_b16 v[106:107], v8 offset:14144
    ds_read_b64_tr_b16 v[108:109], v8 offset:12896
    ds_read_b64_tr_b16 v[110:111], v8 offset:14176
    ds_read_b64_tr_b16 v[112:113], v8 offset:12928
    ds_read_b64_tr_b16 v[114:115], v8 offset:14208
    ds_read_b64_tr_b16 v[116:117], v8 offset:19200
    ds_read_b64_tr_b16 v[118:119], v8 offset:20480
    ds_read_b64_tr_b16 v[120:121], v8 offset:19232
    ds_read_b64_tr_b16 v[122:123], v8 offset:20512
    ds_read_b64_tr_b16 v[124:125], v8 offset:19264
    ds_read_b64_tr_b16 v[126:127], v8 offset:20544
    ds_read_b64_tr_b16 v[128:129], v8 offset:19296
    ds_read_b64_tr_b16 v[130:131], v8 offset:20576
    ds_read_b64_tr_b16 v[132:133], v8 offset:19328
    ds_read_b64_tr_b16 v[134:135], v8 offset:20608
    ds_read_b64_tr_b16 v[136:137], v9 offset:0
    ds_read_b64_tr_b16 v[138:139], v9 offset:12800
    ds_read_b64_tr_b16 v[140:141], v9 offset:32
    ds_read_b64_tr_b16 v[142:143], v9 offset:12832
    ds_read_b64_tr_b16 v[144:145], v9 offset:64
    ds_read_b64_tr_b16 v[146:147], v9 offset:12864
    ds_read_b64_tr_b16 v[148:149], v9 offset:96
    ds_read_b64_tr_b16 v[150:151], v9 offset:12896
    ds_read_b64_tr_b16 v[152:153], v9 offset:128
    ds_read_b64_tr_b16 v[154:155], v9 offset:12928
    ds_read_b64_tr_b16 v[156:157], v8 offset:25600
    ds_read_b64_tr_b16 v[158:159], v8 offset:26880
    ds_read_b64_tr_b16 v[160:161], v8 offset:25632
    ds_read_b64_tr_b16 v[162:163], v8 offset:26912
    ds_read_b64_tr_b16 v[164:165], v8 offset:25664
    ds_read_b64_tr_b16 v[166:167], v8 offset:26944
    ds_read_b64_tr_b16 v[168:169], v8 offset:25696
    ds_read_b64_tr_b16 v[170:171], v8 offset:26976
    ds_read_b64_tr_b16 v[172:173], v8 offset:25728
    ds_read_b64_tr_b16 v[174:175], v8 offset:27008
    ds_read_b64_tr_b16 v[176:177], v8 offset:32000
    ds_read_b64_tr_b16 v[178:179], v8 offset:33280
    ds_read_b64_tr_b16 v[180:181], v8 offset:32032
    ds_read_b64_tr_b16 v[182:183], v8 offset:33312
    ds_read_b64_tr_b16 v[184:185], v8 offset:32064
    ds_read_b64_tr_b16 v[186:187], v8 offset:33344
    ds_read_b64_tr_b16 v[188:189], v8 offset:32096
    ds_read_b64_tr_b16 v[190:191], v8 offset:33376
    ds_read_b64_tr_b16 v[192:193], v8 offset:32128
    ds_read_b64_tr_b16 v[194:195], v8 offset:33408
    ds_read_b64_tr_b16 v[196:197], v8 offset:38400
    ds_read_b64_tr_b16 v[198:199], v8 offset:39680
    ds_read_b64_tr_b16 v[200:201], v8 offset:38432
    ds_read_b64_tr_b16 v[202:203], v8 offset:39712
    ds_read_b64_tr_b16 v[204:205], v8 offset:38464
    ds_read_b64_tr_b16 v[206:207], v8 offset:39744
    ds_read_b64_tr_b16 v[208:209], v8 offset:38496
    ds_read_b64_tr_b16 v[210:211], v8 offset:39776
    ds_read_b64_tr_b16 v[212:213], v8 offset:38528
    ds_read_b64_tr_b16 v[214:215], v8 offset:39808
    ds_read_b64_tr_b16 v[216:217], v8 offset:44800
    ds_read_b64_tr_b16 v[218:219], v8 offset:46080
    ds_read_b64_tr_b16 v[220:221], v8 offset:44832
    ds_read_b64_tr_b16 v[222:223], v8 offset:46112
    ds_read_b64_tr_b16 v[224:225], v8 offset:44864
    ds_read_b64_tr_b16 v[226:227], v8 offset:46144
    ds_read_b64_tr_b16 v[228:229], v8 offset:44896
    ds_read_b64_tr_b16 v[230:231], v8 offset:46176
    ds_read_b64_tr_b16 v[232:233], v8 offset:44928
    ds_read_b64_tr_b16 v[234:235], v8 offset:46208
    ds_read_b64_tr_b16 v[236:237], v9 offset:25600
    ds_read_b64_tr_b16 v[238:239], v9 offset:38400
    ds_read_b64_tr_b16 v[240:241], v9 offset:25632
    ds_read_b64_tr_b16 v[242:243], v9 offset:38432
    ds_read_b64_tr_b16 v[244:245], v9 offset:25664
    ds_read_b64_tr_b16 v[246:247], v9 offset:38464
    ds_read_b64_tr_b16 v[248:249], v9 offset:25696
    ds_read_b64_tr_b16 v[250:251], v9 offset:38496
    ds_read_b64_tr_b16 v[252:253], v9 offset:25728
    ds_read_b64_tr_b16 v[254:255], v9 offset:38528
    s_waitcnt vmcnt(0) lgkmcnt(0)
    s_mov_b64 exec, 1
    ds_add_u32 v2, v3 offset:8
    s_mov_b64 exec, -1
    s_mov_b64 exec, 1
    ds_add_u32 v2, v3 offset:16
    s_mov_b64 exec, -1
    s_add_u32 s28, s35, 2
    s_and_b32 s28, s28, 3
    s_mul_i32 s75, s28, 204800
    s_add_u32 s75, s75, s63
    s_add_u32 m0, s62, 102400
    s_mov_b64 exec, s[60:61]
    buffer_load_dwordx4 v4, s[8:11], s75 offen offset:0 lds
    s_waitcnt vmcnt(1)
    s_add_u32 s75, s75, 5600
    buffer_load_dwordx4 v4, s[8:11], s75 offen offset:800 lds
    s_waitcnt vmcnt(1)
    s_add_u32 s75, s75, 5600
    buffer_load_dwordx4 v4, s[8:11], s75 offen offset:1600 lds
    s_waitcnt vmcnt(1)
    s_add_u32 s75, s75, 5600
    buffer_load_dwordx4 v4, s[8:11], s75 offen offset:2400 lds
    s_waitcnt vmcnt(1)
    s_add_u32 m0, m0, 3200
    s_add_u32 s75, s75, 8800
    buffer_load_dwordx4 v4, s[8:11], s75 offen offset:0 lds
    s_waitcnt vmcnt(1)
    s_add_u32 s75, s75, 5600
    buffer_load_dwordx4 v4, s[8:11], s75 offen offset:800 lds
    s_waitcnt vmcnt(1)
    s_add_u32 s75, s75, 5600
    buffer_load_dwordx4 v4, s[8:11], s75 offen offset:1600 lds
    s_waitcnt vmcnt(1)
    s_add_u32 s75, s75, 5600
    buffer_load_dwordx4 v4, s[8:11], s75 offen offset:2400 lds
    s_waitcnt vmcnt(1)
    s_mov_b64 exec, -1
    s_mov_b32 s29, 0
L_lwh5a:
    ds_read_b32 v6, v2 offset:24
    s_add_u32 s29, s29, 1
    s_lshr_b32 s31, s29, 21
    s_waitcnt lgkmcnt(0)
    s_setprio 3
    v_readfirstlane_b32 s28, v6
    s_setprio 0
    s_max_u32 s28, s28, s31
    s_cmp_ge_u32 s28, 4
    s_cbranch_scc1 L_lgh5a
    s_sleep 4
    s_branch L_lwh5a
L_lgh5a:
    s_add_u32 s28, s35, 3
    s_and_b32 s28, s28, 3
    s_mul_i32 s75, s28, 204800
    s_add_u32 s75, s75, s63
    s_add_u32 m0, s62, 128000
    s_mov_b64 exec, s[60:61]
    buffer_load_dwordx4 v4, s[8:11], s75 offen offset:0 lds
    s_waitcnt vmcnt(3)
    s_add_u32 s75, s75, 5600
    buffer_load_dwordx4 v4, s[8:11], s75 offen offset:800 lds
    s_waitcnt vmcnt(3)
    s_add_u32 s75, s75, 5600
    buffer_load_dwordx4 v4, s[8:11], s75 offen offset:1600 lds
    s_waitcnt vmcnt(3)
    s_add_u32 s75, s75, 5600
    buffer_load_dwordx4 v4, s[8:11], s75 offen offset:2400 lds
    s_waitcnt vmcnt(3)
    s_add_u32 m0, m0, 3200
    s_add_u32 s75, s75, 8800
    buffer_load_dwordx4 v4, s[8:11], s75 offen offset:0 lds
    s_waitcnt vmcnt(3)
    s_add_u32 s75, s75, 5600
    buffer_load_dwordx4 v4, s[8:11], s75 offen offset:800 lds
    s_waitcnt vmcnt(3)
    s_add_u32 s75, s75, 5600
    buffer_load_dwordx4 v4, s[8:11], s75 offen offset:1600 lds
    s_waitcnt vmcnt(3)
    s_add_u32 s75, s75, 5600
    buffer_load_dwordx4 v4, s[8:11], s75 offen offset:2400 lds
    s_waitcnt vmcnt(3)
    s_mov_b64 exec, -1
    s_mov_b32 s29, 0
L_lwc2a:
    ds_read_b32 v6, v2 offset:8
    s_add_u32 s29, s29, 1
    s_lshr_b32 s31, s29, 21
    s_waitcnt lgkmcnt(0)
    s_setprio 3
    v_readfirstlane_b32 s28, v6
    s_setprio 0
    s_max_u32 s28, s28, s31
    s_cmp_ge_u32 s28, 4
    s_cbranch_scc1 L_lgc2a
    s_sleep 2
    s_branch L_lwc2a
L_lgc2a:
    s_add_u32 s28, s35, 2
    s_and_b32 s28, s28, 3
    s_mul_i32 s75, s28, 204800
    s_add_u32 s75, s75, s63
    s_add_u32 m0, s62, 0
    s_mov_b64 exec, s[60:61]
    buffer_load_dwordx4 v4, s[16:19], s75 offen offset:0 lds
    s_waitcnt vmcnt(3)
    s_add_u32 s75, s75, 5600
    buffer_load_dwordx4 v4, s[16:19], s75 offen offset:800 lds
    s_waitcnt vmcnt(3)
    s_add_u32 s75, s75, 5600
    buffer_load_dwordx4 v4, s[16:19], s75 offen offset:1600 lds
    s_waitcnt vmcnt(3)
    s_add_u32 s75, s75, 5600
    buffer_load_dwordx4 v4, s[16:19], s75 offen offset:2400 lds
    s_waitcnt vmcnt(3)
    s_add_u32 m0, m0, 3200
    s_add_u32 s75, s75, 8800
    buffer_load_dwordx4 v4, s[16:19], s75 offen offset:0 lds
    s_waitcnt vmcnt(3)
    s_add_u32 s75, s75, 5600
    buffer_load_dwordx4 v4, s[16:19], s75 offen offset:800 lds
    s_mov_b64 exec, -1
    s_waitcnt vmcnt(6)
    s_mov_b64 exec, 1
    ds_add_u32 v2, v3 offset:28
    s_mov_b64 exec, -1
    s_mov_b64 exec, s[60:61]
    s_waitcnt vmcnt(3)
    s_add_u32 s75, s75, 5600
    buffer_load_dwordx4 v4, s[16:19], s75 offen offset:1600 lds
    s_waitcnt vmcnt(3)
    s_add_u32 s75, s75, 5600
    buffer_load_dwordx4 v4, s[16:19], s75 offen offset:2400 lds
    s_waitcnt vmcnt(3)
    s_mov_b64 exec, -1
    s_add_u32 s28, s35, 3
    s_and_b32 s28, s28, 3
    s_mul_i32 s75, s28, 204800
    s_add_u32 s75, s75, s63
    s_add_u32 m0, s62, 25600
    s_mov_b64 exec, s[60:61]
    buffer_load_dwordx4 v4, s[16:19], s75 offen offset:0 lds
    s_waitcnt vmcnt(3)
    s_add_u32 s75, s75, 5600
    buffer_load_dwordx4 v4, s[16:19], s75 offen offset:800 lds
    s_waitcnt vmcnt(3)
    s_add_u32 s75, s75, 5600
    buffer_load_dwordx4 v4, s[16:19], s75 offen offset:1600 lds
    s_waitcnt vmcnt(3)
    s_add_u32 s75, s75, 5600
    buffer_load_dwordx4 v4, s[16:19], s75 offen offset:2400 lds
    s_waitcnt vmcnt(3)
    s_add_u32 m0, m0, 3200
    s_add_u32 s75, s75, 8800
    buffer_load_dwordx4 v4, s[16:19], s75 offen offset:0 lds
    s_waitcnt vmcnt(3)
    s_add_u32 s75, s75, 5600
    buffer_load_dwordx4 v4, s[16:19], s75 offen offset:800 lds
    s_waitcnt vmcnt(3)
    s_add_u32 s75, s75, 5600
    buffer_load_dwordx4 v4, s[16:19], s75 offen offset:1600 lds
    s_waitcnt vmcnt(3)
    s_add_u32 s75, s75, 5600
    buffer_load_dwordx4 v4, s[16:19], s75 offen offset:2400 lds
    s_waitcnt vmcnt(3)
    s_mov_b64 exec, -1
L_h_sJ:
    s_waitcnt vmcnt(0)
    s_mov_b64 exec, 1
    ds_add_u32 v2, v3 offset:32
    s_mov_b64 exec, -1
    s_cmp_lg_u32 s25, 4
    s_cbranch_scc1 L_h_np
    s_mov_b32 s29, 0
    s_mov_b64 exec, 0xff
L_pollH:
    buffer_load_dword v16, v5, s[12:15], s74 offen sc1
    s_add_u32 s29, s29, 1
    s_cmp_ge_u32 s29, 2000000
    s_cbranch_scc1 L_goH
    s_waitcnt vmcnt(0)
    v_cmp_eq_u32 vcc, 0, v16
    s_nop 0
    s_cbranch_vccz L_goH
    s_mov_b64 exec, vcc
    s_sleep 5
    s_branch L_pollH
L_goH:
    s_mov_b64 exec, -1
    v_mov_b32 v14, 4
    s_mov_b64 exec, 1
    ds_add_u32 v2, v14 offset:36
    s_mov_b64 exec, -1
L_h_np:
    s_mov_b32 s29, 0
L_lwc3:
    ds_read_b32 v6, v2 offset:32
    s_add_u32 s29, s29, 1
    s_lshr_b32 s31, s29, 21
    s_waitcnt lgkmcnt(0)
    v_readfirstlane_b32 s28, v6
    s_max_u32 s28, s28, s31
    s_cmp_ge_u32 s28, 4
    s_cbranch_scc1 L_lgc3
    s_sleep 2
    s_branch L_lwc3
L_lgc3:
    s_mov_b32 s29, 0
L_lwc5:
    ds_read_b32 v6, v2 offset:36
    s_add_u32 s29, s29, 1
    s_lshr_b32 s31, s29, 21
    s_waitcnt lgkmcnt(0)
    v_readfirstlane_b32 s28, v6
    s_max_u32 s28, s28, s31
    s_cmp_ge_u32 s28, 4
    s_cbranch_scc1 L_lgc5
    s_branch L_lwc5
L_lgc5:
    s_setprio 1
    buffer_load_dwordx4 v[16:19], v10, s[12:15], s64 offen sc1
    s_add_u32 s64, s64, 5120
    buffer_load_dwordx4 v[20:23], v10, s[12:15], s64 offen sc1
    s_add_u32 s64, s64, 5120
    buffer_load_dwordx4 v[24:27], v10, s[12:15], s64 offen sc1
    s_add_u32 s64, s64, 5120
    buffer_load_dwordx4 v[28:31], v10, s[12:15], s64 offen sc1
    s_sub_u32 s64, s64, 15360
    s_lshl_b32 s28, s56, 8
    s_lshl_b32 s29, s73, 5
    s_add_u32 s28, s28, s29
    s_add_u32 s28, s28, 327680
    buffer_load_dword v14, v1, s[12:15], s28 offen sc1
    s_waitcnt vmcnt(4)
    v_mfma_f32_16x16x32_bf16 v[36:39], v[56:59], v[16:19], 0
    buffer_load_dwordx4 v[32:35], v11, s[12:15], s64 offen offset:2048 sc1
    v_mfma_f32_16x16x32_bf16 v[40:43], v[60:63], v[16:19], 0
    v_mfma_f32_16x16x32_bf16 v[44:47], v[64:67], v[16:19], 0
    v_mfma_f32_16x16x32_bf16 v[48:51], v[68:71], v[16:19], 0
    v_mfma_f32_16x16x32_bf16 v[52:55], v[72:75], v[16:19], 0
    s_waitcnt vmcnt(4)
    v_mfma_f32_16x16x32_bf16 v[36:39], v[76:79], v[20:23], v[36:39]
    buffer_load_dwordx4 v[16:19], v10, s[12:15], s65 offen sc1
    s_add_u32 s65, s65, 5120
    ds_read_b64_tr_b16 v[56:57], v8 offset:0
    ds_read_b64_tr_b16 v[58:59], v8 offset:1280
    v_mfma_f32_16x16x32_bf16 v[40:43], v[80:83], v[20:23], v[40:43]
    ds_read_b64_tr_b16 v[60:61], v8 offset:32
    ds_read_b64_tr_b16 v[62:63], v8 offset:1312
    v_mfma_f32_16x16x32_bf16 v[44:47], v[84:87], v[20:23], v[44:47]
    ds_read_b64_tr_b16 v[64:65], v8 offset:64
    ds_read_b64_tr_b16 v[66:67], v8 offset:1344
    v_mfma_f32_16x16x32_bf16 v[48:51], v[88:91], v[20:23], v[48:51]
    ds_read_b64_tr_b16 v[68:69], v8 offset:96
    v_mfma_f32_16x16x32_bf16 v[52:55], v[92:95], v[20:23], v[52:55]
    ds_read_b64_tr_b16 v[70:71], v8 offset:1376
    s_waitcnt vmcnt(4)
    v_mfma_f32_16x16x32_bf16 v[36:39], v[96:99], v[24:27], v[36:39]
    buffer_load_dwordx4 v[20:23], v10, s[12:15], s65 offen sc1
    s_add_u32 s65, s65, 5120
    ds_read_b64_tr_b16 v[72:73], v8 offset:128
    ds_read_b64_tr_b16 v[74:75], v8 offset:1408
    v_mfma_f32_16x16x32_bf16 v[40:43], v[100:103], v[24:27], v[40:43]
    ds_read_b64_tr_b16 v[76:77], v8 offset:6400
    ds_read_b64_tr_b16 v[78:79], v8 offset:7680
    v_mfma_f32_16x16x32_bf16 v[44:47], v[104:107], v[24:27], v[44:47]
    ds_read_b64_tr_b16 v[80:81], v8 offset:6432
    ds_read_b64_tr_b16 v[82:83], v8 offset:7712
    v_mfma_f32_16x16x32_bf16 v[48:51], v[108:111], v[24:27], v[48:51]
    ds_read_b64_tr_b16 v[84:85], v8 offset:6464
    v_mfma_f32_16x16x32_bf16 v[52:55], v[112:115], v[24:27], v[52:55]
    ds_read_b64_tr_b16 v[86:87], v8 offset:7744
    s_waitcnt vmcnt(4)
    v_mfma_f32_16x16x32_bf16 v[36:39], v[116:119], v[28:31], v[36:39]
    buffer_load_dwordx4 v[24:27], v10, s[12:15], s65 offen sc1
    s_add_u32 s65, s65, 5120
    ds_read_b64_tr_b16 v[88:89], v8 offset:6496
    ds_read_b64_tr_b16 v[90:91], v8 offset:7776
    v_mfma_f32_16x16x32_bf16 v[40:43], v[120:123], v[28:31], v[40:43]
    ds_read_b64_tr_b16 v[92:93], v8 offset:6528
    ds_read_b64_tr_b16 v[94:95], v8 offset:7808
    v_mfma_f32_16x16x32_bf16 v[44:47], v[124:127], v[28:31], v[44:47]
    ds_read_b64_tr_b16 v[96:97], v8 offset:12800
    ds_read_b64_tr_b16 v[98:99], v8 offset:14080
    v_mfma_f32_16x16x32_bf16 v[48:51], v[128:131], v[28:31], v[48:51]
    ds_read_b64_tr_b16 v[100:101], v8 offset:12832
    v_mfma_f32_16x16x32_bf16 v[52:55], v[132:135], v[28:31], v[52:55]
    ds_read_b64_tr_b16 v[102:103], v8 offset:14112
    s_waitcnt vmcnt(3)
    v_mov_b32 v6, v34
    v_mov_b32 v7, v35
    v_mov_b32_dpp v34, v32 row_ror:8 row_mask:0xf bank_mask:0x3
    v_mov_b32_dpp v35, v33 row_ror:8 row_mask:0xf bank_mask:0x3
    v_mov_b32_dpp v32, v6 row_ror:8 row_mask:0xf bank_mask:0xc
    v_mov_b32_dpp v33, v7 row_ror:8 row_mask:0xf bank_mask:0xc
    s_nop 1
    v_mfma_f32_16x16x32_bf16 v[36:39], v[136:139], v[32:35], v[36:39]
    buffer_load_dwordx4 v[28:31], v10, s[12:15], s65 offen sc1
    s_sub_u32 s65, s65, 15360
    ds_read_b64_tr_b16 v[104:105], v8 offset:12864
    ds_read_b64_tr_b16 v[106:107], v8 offset:14144
    v_mfma_f32_16x16x32_bf16 v[40:43], v[140:143], v[32:35], v[40:43]
    ds_read_b64_tr_b16 v[108:109], v8 offset:12896
    ds_read_b64_tr_b16 v[110:111], v8 offset:14176
    v_mfma_f32_16x16x32_bf16 v[44:47], v[144:147], v[32:35], v[44:47]
    ds_read_b64_tr_b16 v[112:113], v8 offset:12928
    ds_read_b64_tr_b16 v[114:115], v8 offset:14208
    v_mfma_f32_16x16x32_bf16 v[48:51], v[148:151], v[32:35], v[48:51]
    ds_read_b64_tr_b16 v[116:117], v8 offset:19200
    v_mfma_f32_16x16x32_bf16 v[52:55], v[152:155], v[32:35], v[52:55]
    ds_read_b64_tr_b16 v[118:119], v8 offset:20480
    s_waitcnt vmcnt(3)
    v_mfma_f32_16x16x32_bf16 v[36:39], v[156:159], v[16:19], v[36:39]
    buffer_load_dwordx4 v[32:35], v11, s[12:15], s65 offen offset:2048 sc1
    ds_read_b64_tr_b16 v[120:121], v8 offset:19232
    ds_read_b64_tr_b16 v[122:123], v8 offset:20512
    v_mfma_f32_16x16x32_bf16 v[40:43], v[160:163], v[16:19], v[40:43]
    ds_read_b64_tr_b16 v[124:125], v8 offset:19264
    ds_read_b64_tr_b16 v[126:127], v8 offset:20544
    v_mfma_f32_16x16x32_bf16 v[44:47], v[164:167], v[16:19], v[44:47]
    ds_read_b64_tr_b16 v[128:129], v8 offset:19296
    ds_read_b64_tr_b16 v[130:131], v8 offset:20576
    v_mfma_f32_16x16x32_bf16 v[48:51], v[168:171], v[16:19], v[48:51]
    ds_read_b64_tr_b16 v[132:133], v8 offset:19328
    v_mfma_f32_16x16x32_bf16 v[52:55], v[172:175], v[16:19], v[52:55]
    ds_read_b64_tr_b16 v[134:135], v8 offset:20608
    s_waitcnt vmcnt(3)
    v_mfma_f32_16x16x32_bf16 v[36:39], v[176:179], v[20:23], v[36:39]
    buffer_load_dwordx4 v[16:19], v10, s[12:15], s66 offen sc1
    s_add_u32 s66, s66, 5120
    ds_read_b64_tr_b16 v[136:137], v9 offset:0
    ds_read_b64_tr_b16 v[138:139], v9 offset:12800
    v_mfma_f32_16x16x32_bf16 v[40:43], v[180:183], v[20:23], v[40:43]
    ds_read_b64_tr_b16 v[140:141], v9 offset:32
    ds_read_b64_tr_b16 v[142:143], v9 offset:12832
    v_mfma_f32_16x16x32_bf16 v[44:47], v[184:187], v[20:23], v[44:47]
    ds_read_b64_tr_b16 v[144:145], v9 offset:64
    ds_read_b64_tr_b16 v[146:147], v9 offset:12864
    v_mfma_f32_16x16x32_bf16 v[48:51], v[188:191], v[20:23], v[48:51]
    ds_read_b64_tr_b16 v[148:149], v9 offset:96
    v_mfma_f32_16x16x32_bf16 v[52:55], v[192:195], v[20:23], v[52:55]
    ds_read_b64_tr_b16 v[150:151], v9 offset:12896
    s_waitcnt vmcnt(3)
    v_mfma_f32_16x16x32_bf16 v[36:39], v[196:199], v[24:27], v[36:39]
    buffer_load_dwordx4 v[20:23], v10, s[12:15], s66 offen sc1
    s_add_u32 s66, s66, 5120
    ds_read_b64_tr_b16 v[152:153], v9 offset:128
    ds_read_b64_tr_b16 v[154:155], v9 offset:12928
    v_mfma_f32_16x16x32_bf16 v[40:43], v[200:203], v[24:27], v[40:43]
    ds_read_b64_tr_b16 v[156:157], v8 offset:25600
    ds_read_b64_tr_b16 v[158:159], v8 offset:26880
    v_mfma_f32_16x16x32_bf16 v[44:47], v[204:207], v[24:27], v[44:47]
    ds_read_b64_tr_b16 v[160:161], v8 offset:25632
    ds_read_b64_tr_b16 v[162:163], v8 offset:26912
    v_mfma_f32_16x16x32_bf16 v[48:51], v[208:211], v[24:27], v[48:51]
    ds_read_b64_tr_b16 v[164:165], v8 offset:25664
    v_mfma_f32_16x16x32_bf16 v[52:55], v[212:215], v[24:27], v[52:55]
    ds_read_b64_tr_b16 v[166:167], v8 offset:26944
    s_waitcnt vmcnt(3)
    v_mfma_f32_16x16x32_bf16 v[36:39], v[216:219], v[28:31], v[36:39]
    buffer_load_dwordx4 v[24:27], v10, s[12:15], s66 offen sc1
    s_add_u32 s66, s66, 5120
    ds_read_b64_tr_b16 v[168:169], v8 offset:25696
    ds_read_b64_tr_b16 v[170:171], v8 offset:26976
    v_mfma_f32_16x16x32_bf16 v[40:43], v[220:223], v[28:31], v[40:43]
    ds_read_b64_tr_b16 v[172:173], v8 offset:25728
    ds_read_b64_tr_b16 v[174:175], v8 offset:27008
    v_mfma_f32_16x16x32_bf16 v[44:47], v[224:227], v[28:31], v[44:47]
    ds_read_b64_tr_b16 v[176:177], v8 offset:32000
    ds_read_b64_tr_b16 v[178:179], v8 offset:33280
    v_mfma_f32_16x16x32_bf16 v[48:51], v[228:231], v[28:31], v[48:51]
    ds_read_b64_tr_b16 v[180:181], v8 offset:32032
    v_mfma_f32_16x16x32_bf16 v[52:55], v[232:235], v[28:31], v[52:55]
    ds_read_b64_tr_b16 v[182:183], v8 offset:33312
    v_mul_f32 v14, 0xbfb8aa3b, v14
    v_exp_f32 v14, v14
    s_waitcnt vmcnt(3)
    v_mov_b32 v6, v34
    v_mov_b32 v7, v35
    v_mov_b32_dpp v34, v32 row_ror:8 row_mask:0xf bank_mask:0x3
    v_mov_b32_dpp v35, v33 row_ror:8 row_mask:0xf bank_mask:0x3
    v_mov_b32_dpp v32, v6 row_ror:8 row_mask:0xf bank_mask:0xc
    v_mov_b32_dpp v33, v7 row_ror:8 row_mask:0xf bank_mask:0xc
    s_nop 1
    v_mfma_f32_16x16x32_bf16 v[36:39], v[236:239], v[32:35], v[36:39]
    buffer_load_dwordx4 v[28:31], v10, s[12:15], s66 offen sc1
    s_sub_u32 s66, s66, 15360
    ds_read_b64_tr_b16 v[184:185], v8 offset:32064
    ds_read_b64_tr_b16 v[186:187], v8 offset:33344
    v_mfma_f32_16x16x32_bf16 v[40:43], v[240:243], v[32:35], v[40:43]
    ds_read_b64_tr_b16 v[188:189], v8 offset:32096
    ds_read_b64_tr_b16 v[190:191], v8 offset:33376
    v_mfma_f32_16x16x32_bf16 v[44:47], v[244:247], v[32:35], v[44:47]
    ds_read_b64_tr_b16 v[192:193], v8 offset:32128
    ds_read_b64_tr_b16 v[194:195], v8 offset:33408
    v_mfma_f32_16x16x32_bf16 v[48:51], v[248:251], v[32:35], v[48:51]
    ds_read_b64_tr_b16 v[196:197], v8 offset:38400
    v_mfma_f32_16x16x32_bf16 v[52:55], v[252:255], v[32:35], v[52:55]
    ds_read_b64_tr_b16 v[198:199], v8 offset:39680
    v_add_f32 v14, 1.0, v14
    v_rcp_f32 v14, v14
    s_waitcnt lgkmcnt(9) vmcnt(3)
    v_mfma_f32_16x16x32_bf16 v[36:39], v[56:59], v[16:19], v[36:39]
    buffer_load_dwordx4 v[32:35], v11, s[12:15], s66 offen offset:2048 sc1
    ds_read_b64_tr_b16 v[200:201], v8 offset:38432
    ds_read_b64_tr_b16 v[202:203], v8 offset:39712
    v_mfma_f32_16x16x32_bf16 v[40:43], v[60:63], v[16:19], v[40:43]
    ds_read_b64_tr_b16 v[204:205], v8 offset:38464
    ds_read_b64_tr_b16 v[206:207], v8 offset:39744
    v_mfma_f32_16x16x32_bf16 v[44:47], v[64:67], v[16:19], v[44:47]
    ds_read_b64_tr_b16 v[208:209], v8 offset:38496
    ds_read_b64_tr_b16 v[210:211], v8 offset:39776
    v_mfma_f32_16x16x32_bf16 v[48:51], v[68:71], v[16:19], v[48:51]
    ds_read_b64_tr_b16 v[212:213], v8 offset:38528
    v_mfma_f32_16x16x32_bf16 v[52:55], v[72:75], v[16:19], v[52:55]
    ds_read_b64_tr_b16 v[214:215], v8 offset:39808
    v_sub_f32 v15, 1.0, v14
    s_waitcnt vmcnt(3)
    v_mfma_f32_16x16x32_bf16 v[36:39], v[76:79], v[20:23], v[36:39]
    buffer_load_dwordx4 v[16:19], v10, s[12:15], s67 offen sc1
    s_add_u32 s67, s67, 5120
    ds_read_b64_tr_b16 v[216:217], v8 offset:44800
    ds_read_b64_tr_b16 v[218:219], v8 offset:46080
    v_mfma_f32_16x16x32_bf16 v[40:43], v[80:83], v[20:23], v[40:43]
    ds_read_b64_tr_b16 v[220:221], v8 offset:44832
    ds_read_b64_tr_b16 v[222:223], v8 offset:46112
    v_mfma_f32_16x16x32_bf16 v[44:47], v[84:87], v[20:23], v[44:47]
    ds_read_b64_tr_b16 v[224:225], v8 offset:44864
    ds_read_b64_tr_b16 v[226:227], v8 offset:46144
    v_mfma_f32_16x16x32_bf16 v[48:51], v[88:91], v[20:23], v[48:51]
    ds_read_b64_tr_b16 v[228:229], v8 offset:44896
    v_mfma_f32_16x16x32_bf16 v[52:55], v[92:95], v[20:23], v[52:55]
    ds_read_b64_tr_b16 v[230:231], v8 offset:46176
    s_waitcnt vmcnt(3)
    v_mfma_f32_16x16x32_bf16 v[36:39], v[96:99], v[24:27], v[36:39]
    buffer_load_dwordx4 v[20:23], v10, s[12:15], s67 offen sc1
    s_add_u32 s67, s67, 5120
    ds_read_b64_tr_b16 v[232:233], v8 offset:44928
    ds_read_b64_tr_b16 v[234:235], v8 offset:46208
    v_mfma_f32_16x16x32_bf16 v[40:43], v[100:103], v[24:27], v[40:43]
    ds_read_b64_tr_b16 v[236:237], v9 offset:25600
    ds_read_b64_tr_b16 v[238:239], v9 offset:38400
    v_mfma_f32_16x16x32_bf16 v[44:47], v[104:107], v[24:27], v[44:47]
    ds_read_b64_tr_b16 v[240:241], v9 offset:25632
    ds_read_b64_tr_b16 v[242:243], v9 offset:38432
    v_mfma_f32_16x16x32_bf16 v[48:51], v[108:111], v[24:27], v[48:51]
    ds_read_b64_tr_b16 v[244:245], v9 offset:25664
    v_mfma_f32_16x16x32_bf16 v[52:55], v[112:115], v[24:27], v[52:55]
    ds_read_b64_tr_b16 v[246:247], v9 offset:38464
    s_waitcnt vmcnt(3)
    v_mfma_f32_16x16x32_bf16 v[36:39], v[116:119], v[28:31], v[36:39]
    buffer_load_dwordx4 v[24:27], v10, s[12:15], s67 offen sc1
    s_add_u32 s67, s67, 5120
    ds_read_b64_tr_b16 v[248:249], v9 offset:25696
    v_mfma_f32_16x16x32_bf16 v[40:43], v[120:123], v[28:31], v[40:43]
    ds_read_b64_tr_b16 v[250:251], v9 offset:38496
    v_mfma_f32_16x16x32_bf16 v[44:47], v[124:127], v[28:31], v[44:47]
    ds_read_b64_tr_b16 v[252:253], v9 offset:25728
    v_mfma_f32_16x16x32_bf16 v[48:51], v[128:131], v[28:31], v[48:51]
    ds_read_b64_tr_b16 v[254:255], v9 offset:38528
    v_mfma_f32_16x16x32_bf16 v[52:55], v[132:135], v[28:31], v[52:55]
    s_waitcnt vmcnt(3)
    v_mov_b32 v6, v34
    v_mov_b32 v7, v35
    v_mov_b32_dpp v34, v32 row_ror:8 row_mask:0xf bank_mask:0x3
    v_mov_b32_dpp v35, v33 row_ror:8 row_mask:0xf bank_mask:0x3
    v_mov_b32_dpp v32, v6 row_ror:8 row_mask:0xf bank_mask:0xc
    v_mov_b32_dpp v33, v7 row_ror:8 row_mask:0xf bank_mask:0xc
    s_nop 1
    v_mfma_f32_16x16x32_bf16 v[36:39], v[136:139], v[32:35], v[36:39]
    buffer_load_dwordx4 v[28:31], v10, s[12:15], s67 offen sc1
    s_sub_u32 s67, s67, 15360
    v_mfma_f32_16x16x32_bf16 v[40:43], v[140:143], v[32:35], v[40:43]
    v_mfma_f32_16x16x32_bf16 v[44:47], v[144:147], v[32:35], v[44:47]
    v_mfma_f32_16x16x32_bf16 v[48:51], v[148:151], v[32:35], v[48:51]
    v_mfma_f32_16x16x32_bf16 v[52:55], v[152:155], v[32:35], v[52:55]
    s_mov_b64 exec, 1
    ds_add_u32 v2, v3 offset:12
    s_mov_b64 exec, -1
    s_waitcnt vmcnt(3)
    v_mfma_f32_16x16x32_bf16 v[36:39], v[156:159], v[16:19], v[36:39]
    buffer_load_dwordx4 v[32:35], v11, s[12:15], s67 offen offset:2048 sc1
    v_mfma_f32_16x16x32_bf16 v[40:43], v[160:163], v[16:19], v[40:43]
    v_mfma_f32_16x16x32_bf16 v[44:47], v[164:167], v[16:19], v[44:47]
    v_mfma_f32_16x16x32_bf16 v[48:51], v[168:171], v[16:19], v[48:51]
    v_mfma_f32_16x16x32_bf16 v[52:55], v[172:175], v[16:19], v[52:55]
    s_waitcnt vmcnt(3)
    v_mfma_f32_16x16x32_bf16 v[36:39], v[176:179], v[20:23], v[36:39]
    s_waitcnt lgkmcnt(0)
    v_mfma_f32_16x16x32_bf16 v[40:43], v[180:183], v[20:23], v[40:43]
    v_mfma_f32_16x16x32_bf16 v[44:47], v[184:187], v[20:23], v[44:47]
    v_mfma_f32_16x16x32_bf16 v[48:51], v[188:191], v[20:23], v[48:51]
    v_mfma_f32_16x16x32_bf16 v[52:55], v[192:195], v[20:23], v[52:55]
    s_waitcnt vmcnt(2)
    v_mfma_f32_16x16x32_bf16 v[36:39], v[196:199], v[24:27], v[36:39]
    v_mfma_f32_16x16x32_bf16 v[40:43], v[200:203], v[24:27], v[40:43]
    v_mfma_f32_16x16x32_bf16 v[44:47], v[204:207], v[24:27], v[44:47]
    v_mfma_f32_16x16x32_bf16 v[48:51], v[208:211], v[24:27], v[48:51]
    v_mfma_f32_16x16x32_bf16 v[52:55], v[212:215], v[24:27], v[52:55]
    ds_read_b32 v13, v2 offset:12
    s_waitcnt vmcnt(1)
    v_mfma_f32_16x16x32_bf16 v[36:39], v[216:219], v[28:31], v[36:39]
    v_mfma_f32_16x16x32_bf16 v[40:43], v[220:223], v[28:31], v[40:43]
    v_mfma_f32_16x16x32_bf16 v[44:47], v[224:227], v[28:31], v[44:47]
    v_mfma_f32_16x16x32_bf16 v[48:51], v[228:231], v[28:31], v[48:51]
    v_mfma_f32_16x16x32_bf16 v[52:55], v[232:235], v[28:31], v[52:55]
    s_waitcnt vmcnt(0)
    v_mov_b32 v6, v34
    v_mov_b32 v7, v35
    v_mov_b32_dpp v34, v32 row_ror:8 row_mask:0xf bank_mask:0x3
    v_mov_b32_dpp v35, v33 row_ror:8 row_mask:0xf bank_mask:0x3
    v_mov_b32_dpp v32, v6 row_ror:8 row_mask:0xf bank_mask:0xc
    v_mov_b32_dpp v33, v7 row_ror:8 row_mask:0xf bank_mask:0xc
    s_nop 1
    v_mfma_f32_16x16x32_bf16 v[36:39], v[236:239], v[32:35], v[36:39]
    v_mfma_f32_16x16x32_bf16 v[40:43], v[240:243], v[32:35], v[40:43]
    v_mfma_f32_16x16x32_bf16 v[44:47], v[244:247], v[32:35], v[44:47]
    v_mfma_f32_16x16x32_bf16 v[48:51], v[248:251], v[32:35], v[48:51]
    v_mfma_f32_16x16x32_bf16 v[52:55], v[252:255], v[32:35], v[52:55]
    s_waitcnt lgkmcnt(0)
    v_readfirstlane_b32 s28, v13
    s_cmp_ge_u32 s28, 4
    s_cbranch_scc1 L_lgc4
    s_mov_b32 s29, 0
L_lwc4:
    ds_read_b32 v6, v2 offset:12
    s_add_u32 s29, s29, 1
    s_lshr_b32 s31, s29, 21
    s_waitcnt lgkmcnt(0)
    v_readfirstlane_b32 s28, v6
    s_max_u32 s28, s28, s31
    s_cmp_ge_u32 s28, 4
    s_cbranch_scc1 L_lgc4
    s_branch L_lwc4
L_lgc4:
    ds_write_b32 v12, v15 offset:5120
    s_nop 3
    v_pk_mul_f32 v[36:37], v[36:37], v[14:15] op_sel_hi:[1,0]
    v_pk_mul_f32 v[38:39], v[38:39], v[14:15] op_sel_hi:[1,0]
    ds_write_b128 v12, v[36:39] offset:0
    v_pk_mul_f32 v[40:41], v[40:41], v[14:15] op_sel_hi:[1,0]
    v_pk_mul_f32 v[42:43], v[42:43], v[14:15] op_sel_hi:[1,0]
    ds_write_b128 v12, v[40:43] offset:1024
    v_pk_mul_f32 v[44:45], v[44:45], v[14:15] op_sel_hi:[1,0]
    v_pk_mul_f32 v[46:47], v[46:47], v[14:15] op_sel_hi:[1,0]
    ds_write_b128 v12, v[44:47] offset:2048
    v_pk_mul_f32 v[48:49], v[48:49], v[14:15] op_sel_hi:[1,0]
    v_pk_mul_f32 v[50:51], v[50:51], v[14:15] op_sel_hi:[1,0]
    ds_write_b128 v12, v[48:51] offset:3072
    v_pk_mul_f32 v[52:53], v[52:53], v[14:15] op_sel_hi:[1,0]
    v_pk_mul_f32 v[54:55], v[54:55], v[14:15] op_sel_hi:[1,0]
    ds_write_b128 v12, v[52:55] offset:4096
    s_waitcnt lgkmcnt(0)
    s_barrier
    s_endpgm
L_A_slow:
    s_waitcnt vmcnt(0) lgkmcnt(0)
    s_nop 15
    v_mfma_f32_32x32x16_bf16 v[160:175], v[16:19], v[32:35], 0
    v_mfma_f32_32x32x16_bf16 v[160:175], v[20:23], v[48:51], v[160:175]
    s_nop 11
    v_max3_f32 v170, v160, v161, v162
    v_max3_f32 v172, -v160, -v161, -v162
    v_max3_f32 v170, v170, v163, v164
    v_max3_f32 v172, v172, -v163, -v164
    v_max3_f32 v170, v170, v165, v166
    v_max3_f32 v172, v172, -v165, -v166
    v_max3_f32 v170, v170, v167, v168
    v_max3_f32 v172, v172, -v167, -v168
    v_max_f32 v170, v170, v169
    v_max_f32_e64 v172, v172, -v169
    s_nop 1
    v_permlane32_swap_b32 v170, v172
    v_max_f32 v170, v170, v172
    v_mov_b32 v172, v170
    s_nop 1
    v_permlane32_swap_b32 v170, v172
    v_add_f32 v224, v160, v172
    v_sub_f32 v160, v160, v170
    v_exp_f32_e64 v224, -v224
    v_exp_f32 v160, v160
    v_add_f32 v225, v161, v172
    v_sub_f32 v161, v161, v170
    v_exp_f32_e64 v225, -v225
    v_exp_f32 v161, v161
    v_add_f32 v226, v162, v172
    v_sub_f32 v162, v162, v170
    v_exp_f32_e64 v226, -v226
    v_exp_f32 v162, v162
    v_add_f32 v227, v163, v172
    v_sub_f32 v163, v163, v170
    v_exp_f32_e64 v227, -v227
    v_exp_f32 v163, v163
    v_add_f32 v228, v164, v172
    v_sub_f32 v164, v164, v170
    v_exp_f32_e64 v228, -v228
    v_exp_f32 v164, v164
    v_add_f32 v229, v165, v172
    v_sub_f32 v165, v165, v170
    v_exp_f32_e64 v229, -v229
    v_exp_f32 v165, v165
    v_add_f32 v230, v166, v172
    v_sub_f32 v166, v166, v170
    v_exp_f32_e64 v230, -v230
    v_exp_f32 v166, v166
    v_add_f32 v231, v167, v172
    v_sub_f32 v167, v167, v170
    v_exp_f32_e64 v231, -v231
    v_exp_f32 v167, v167
    v_add_f32 v232, v168, v172
    v_sub_f32 v168, v168, v170
    v_exp_f32_e64 v232, -v232
    v_exp_f32 v168, v168
    v_add_f32 v233, v169, v172
    v_sub_f32 v169, v169, v170
    v_exp_f32_e64 v233, -v233
    v_exp_f32 v169, v169
    v_pk_add_f32 v[170:171], v[160:161], v[162:163]
    v_pk_add_f32 v[172:173], v[224:225], v[226:227]
    v_pk_add_f32 v[170:171], v[170:171], v[164:165]
    v_pk_add_f32 v[172:173], v[172:173], v[228:229]
    v_pk_add_f32 v[170:171], v[170:171], v[166:167]
    v_pk_add_f32 v[172:173], v[172:173], v[230:231]
    v_pk_add_f32 v[170:171], v[170:171], v[168:169]
    v_pk_add_f32 v[172:173], v[172:173], v[232:233]
    v_add_f32 v170, v170, v171
    v_add_f32 v172, v172, v173
    s_nop 1
    v_permlane32_swap_b32 v170, v172
    v_add_f32 v170, v170, v172
    v_rcp_f32 v170, v170
    s_nop 0
    v_mov_b32 v172, v170
    s_nop 1
    v_permlane32_swap_b32 v170, v172
    v_pk_mul_f32 v[160:161], v[160:161], v[170:171] op_sel_hi:[1,0]
    v_cvt_pk_bf16_f32 v244, v160, v161
    v_pk_mul_f32 v[162:163], v[162:163], v[170:171] op_sel_hi:[1,0]
    v_cvt_pk_bf16_f32 v245, v162, v163
    v_pk_mul_f32 v[164:165], v[164:165], v[170:171] op_sel_hi:[1,0]
    v_cvt_pk_bf16_f32 v246, v164, v165
    v_pk_mul_f32 v[166:167], v[166:167], v[170:171] op_sel_hi:[1,0]
    v_cvt_pk_bf16_f32 v247, v166, v167
    v_pk_mul_f32 v[168:169], v[168:169], v[170:171] op_sel_hi:[1,0]
    v_cvt_pk_bf16_f32 v248, v168, v169
    v_pk_mul_f32 v[224:225], v[224:225], v[172:173] op_sel_hi:[1,0]
    v_cvt_pk_bf16_f32 v249, v224, v225
    v_pk_mul_f32 v[226:227], v[226:227], v[172:173] op_sel_hi:[1,0]
    v_cvt_pk_bf16_f32 v250, v226, v227
    v_pk_mul_f32 v[228:229], v[228:229], v[172:173] op_sel_hi:[1,0]
    v_cvt_pk_bf16_f32 v251, v228, v229
    v_pk_mul_f32 v[230:231], v[230:231], v[172:173] op_sel_hi:[1,0]
    v_cvt_pk_bf16_f32 v252, v230, v231
    v_pk_mul_f32 v[232:233], v[232:233], v[172:173] op_sel_hi:[1,0]
    v_cvt_pk_bf16_f32 v253, v232, v233
    v_cndmask_b32 v120, v48, v15, s[60:61]
    v_cndmask_b32 v121, v49, v15, s[60:61]
    ds_write_b128 v3, v[64:67]
    ds_write_b64 v4, v[120:121]
    ds_read_b64_tr_b16 v[104:105], v5 offset:0
    ds_read_b64_tr_b16 v[106:107], v5 offset:384
    ds_read_b64_tr_b16 v[116:117], v5 offset:768
    ds_read_b64_tr_b16 v[118:119], v5 offset:1152
    ds_write_b64 v6, v[244:245] offset:0
    ds_write_b64 v6, v[246:247] offset:8
    ds_write_b64 v6, v[248:249] offset:16
    ds_write_b64 v6, v[250:251] offset:24
    ds_write_b64 v6, v[252:253] offset:32
    ds_read_b64_tr_b16 v[96:97], v7 offset:0
    ds_read_b64_tr_b16 v[100:101], v14 offset:32
    ds_read_b64_tr_b16 v[98:99], v7 offset:640
    ds_read_b64_tr_b16 v[102:103], v14 offset:672
    ds_read_b64_tr_b16 v[108:109], v7 offset:1280
    ds_read_b64_tr_b16 v[112:113], v14 offset:1312
    ds_read_b64_tr_b16 v[110:111], v7 offset:1920
    ds_read_b64_tr_b16 v[114:115], v14 offset:1952
    s_waitcnt lgkmcnt(5)
    v_mfma_f32_32x32x16_bf16 v[192:207], v[96:99], v[104:107], 0
    s_waitcnt lgkmcnt(4)
    v_mfma_f32_32x32x16_bf16 v[208:223], v[100:103], v[104:107], 0
    s_waitcnt lgkmcnt(1)
    v_mfma_f32_32x32x16_bf16 v[192:207], v[108:111], v[116:119], v[192:207]
    s_waitcnt lgkmcnt(0)
    v_mfma_f32_32x32x16_bf16 v[208:223], v[112:115], v[116:119], v[208:223]
    v_mfma_f32_32x32x16_bf16 v[176:191], v[16:19], v[36:39], 0
    v_mfma_f32_32x32x16_bf16 v[176:191], v[20:23], v[50:53], v[176:191]
    s_nop 11
    v_max3_f32 v186, v176, v177, v178
    v_max3_f32 v188, -v176, -v177, -v178
    v_max3_f32 v186, v186, v179, v180
    v_max3_f32 v188, v188, -v179, -v180
    v_max3_f32 v186, v186, v181, v182
    v_max3_f32 v188, v188, -v181, -v182
    v_max3_f32 v186, v186, v183, v184
    v_max3_f32 v188, v188, -v183, -v184
    v_max_f32 v186, v186, v185
    v_max_f32_e64 v188, v188, -v185
    s_nop 1
    v_permlane32_swap_b32 v186, v188
    v_max_f32 v186, v186, v188
    v_mov_b32 v188, v186
    s_nop 1
    v_permlane32_swap_b32 v186, v188
    v_add_f32 v234, v176, v188
    v_sub_f32 v176, v176, v186
    v_exp_f32_e64 v234, -v234
    v_exp_f32 v176, v176
    v_add_f32 v235, v177, v188
    v_sub_f32 v177, v177, v186
    v_exp_f32_e64 v235, -v235
    v_exp_f32 v177, v177
    v_add_f32 v236, v178, v188
    v_sub_f32 v178, v178, v186
    v_exp_f32_e64 v236, -v236
    v_exp_f32 v178, v178
    v_add_f32 v237, v179, v188
    v_sub_f32 v179, v179, v186
    v_exp_f32_e64 v237, -v237
    v_exp_f32 v179, v179
    v_add_f32 v238, v180, v188
    v_sub_f32 v180, v180, v186
    v_exp_f32_e64 v238, -v238
    v_exp_f32 v180, v180
    v_add_f32 v239, v181, v188
    v_sub_f32 v181, v181, v186
    v_exp_f32_e64 v239, -v239
    v_exp_f32 v181, v181
    v_add_f32 v240, v182, v188
    v_sub_f32 v182, v182, v186
    v_exp_f32_e64 v240, -v240
    v_exp_f32 v182, v182
    v_add_f32 v241, v183, v188
    v_sub_f32 v183, v183, v186
    v_exp_f32_e64 v241, -v241
    v_exp_f32 v183, v183
    v_add_f32 v242, v184, v188
    v_sub_f32 v184, v184, v186
    v_exp_f32_e64 v242, -v242
    v_exp_f32 v184, v184
    v_add_f32 v243, v185, v188
    v_sub_f32 v185, v185, v186
    v_exp_f32_e64 v243, -v243
    v_exp_f32 v185, v185
    v_pk_add_f32 v[186:187], v[176:177], v[178:179]
    v_pk_add_f32 v[188:189], v[234:235], v[236:237]
    v_pk_add_f32 v[186:187], v[186:187], v[180:181]
    v_pk_add_f32 v[188:189], v[188:189], v[238:239]
    v_pk_add_f32 v[186:187], v[186:187], v[182:183]
    v_pk_add_f32 v[188:189], v[188:189], v[240:241]
    v_pk_add_f32 v[186:187], v[186:187], v[184:185]
    v_pk_add_f32 v[188:189], v[188:189], v[242:243]
    v_add_f32 v186, v186, v187
    v_add_f32 v188, v188, v189
    s_nop 1
    v_permlane32_swap_b32 v186, v188
    v_add_f32 v186, v186, v188
    v_rcp_f32 v186, v186
    s_nop 0
    v_mov_b32 v188, v186
    s_nop 1
    v_permlane32_swap_b32 v186, v188
    v_pk_mul_f32 v[176:177], v[176:177], v[186:187] op_sel_hi:[1,0]
    v_cvt_pk_bf16_f32 v244, v176, v177
    v_pk_mul_f32 v[178:179], v[178:179], v[186:187] op_sel_hi:[1,0]
    v_cvt_pk_bf16_f32 v245, v178, v179
    v_pk_mul_f32 v[180:181], v[180:181], v[186:187] op_sel_hi:[1,0]
    v_cvt_pk_bf16_f32 v246, v180, v181
    v_pk_mul_f32 v[182:183], v[182:183], v[186:187] op_sel_hi:[1,0]
    v_cvt_pk_bf16_f32 v247, v182, v183
    v_pk_mul_f32 v[184:185], v[184:185], v[186:187] op_sel_hi:[1,0]
    v_cvt_pk_bf16_f32 v248, v184, v185
    v_pk_mul_f32 v[234:235], v[234:235], v[188:189] op_sel_hi:[1,0]
    v_cvt_pk_bf16_f32 v249, v234, v235
    v_pk_mul_f32 v[236:237], v[236:237], v[188:189] op_sel_hi:[1,0]
    v_cvt_pk_bf16_f32 v250, v236, v237
    v_pk_mul_f32 v[238:239], v[238:239], v[188:189] op_sel_hi:[1,0]
    v_cvt_pk_bf16_f32 v251, v238, v239
    v_pk_mul_f32 v[240:241], v[240:241], v[188:189] op_sel_hi:[1,0]
    v_cvt_pk_bf16_f32 v252, v240, v241
    v_pk_mul_f32 v[242:243], v[242:243], v[188:189] op_sel_hi:[1,0]
    v_cvt_pk_bf16_f32 v253, v242, v243
    v_cndmask_b32 v122, v50, v15, s[60:61]
    v_cndmask_b32 v123, v51, v15, s[60:61]
    ds_write_b128 v3, v[68:71]
    ds_write_b64 v4, v[122:123]
    ds_read_b64_tr_b16 v[104:105], v5 offset:0
    ds_read_b64_tr_b16 v[106:107], v5 offset:384
    ds_read_b64_tr_b16 v[116:117], v5 offset:768
    ds_read_b64_tr_b16 v[118:119], v5 offset:1152
    ds_write_b64 v6, v[244:245] offset:0
    ds_write_b64 v6, v[246:247] offset:8
    ds_write_b64 v6, v[248:249] offset:16
    ds_write_b64 v6, v[250:251] offset:24
    ds_write_b64 v6, v[252:253] offset:32
    ds_read_b64_tr_b16 v[96:97], v7 offset:0
    ds_read_b64_tr_b16 v[100:101], v14 offset:32
    ds_read_b64_tr_b16 v[98:99], v7 offset:640
    ds_read_b64_tr_b16 v[102:103], v14 offset:672
    ds_read_b64_tr_b16 v[108:109], v7 offset:1280
    ds_read_b64_tr_b16 v[112:113], v14 offset:1312
    ds_read_b64_tr_b16 v[110:111], v7 offset:1920
    ds_read_b64_tr_b16 v[114:115], v14 offset:1952
    s_waitcnt lgkmcnt(5)
    v_mfma_f32_32x32x16_bf16 v[192:207], v[96:99], v[104:107], v[192:207]
    s_waitcnt lgkmcnt(4)
    v_mfma_f32_32x32x16_bf16 v[208:223], v[100:103], v[104:107], v[208:223]
    s_waitcnt lgkmcnt(1)
    v_mfma_f32_32x32x16_bf16 v[192:207], v[108:111], v[116:119], v[192:207]
    s_waitcnt lgkmcnt(0)
    v_mfma_f32_32x32x16_bf16 v[208:223], v[112:115], v[116:119], v[208:223]
    v_mfma_f32_32x32x16_bf16 v[160:175], v[16:19], v[40:43], 0
    v_mfma_f32_32x32x16_bf16 v[160:175], v[20:23], v[52:55], v[160:175]
    s_nop 11
    v_max3_f32 v170, v160, v161, v162
    v_max3_f32 v172, -v160, -v161, -v162
    v_max3_f32 v170, v170, v163, v164
    v_max3_f32 v172, v172, -v163, -v164
    v_max3_f32 v170, v170, v165, v166
    v_max3_f32 v172, v172, -v165, -v166
    v_max3_f32 v170, v170, v167, v168
    v_max3_f32 v172, v172, -v167, -v168
    v_max_f32 v170, v170, v169
    v_max_f32_e64 v172, v172, -v169
    s_nop 1
    v_permlane32_swap_b32 v170, v172
    v_max_f32 v170, v170, v172
    v_mov_b32 v172, v170
    s_nop 1
    v_permlane32_swap_b32 v170, v172
    v_add_f32 v224, v160, v172
    v_sub_f32 v160, v160, v170
    v_exp_f32_e64 v224, -v224
    v_exp_f32 v160, v160
    v_add_f32 v225, v161, v172
    v_sub_f32 v161, v161, v170
    v_exp_f32_e64 v225, -v225
    v_exp_f32 v161, v161
    v_add_f32 v226, v162, v172
    v_sub_f32 v162, v162, v170
    v_exp_f32_e64 v226, -v226
    v_exp_f32 v162, v162
    v_add_f32 v227, v163, v172
    v_sub_f32 v163, v163, v170
    v_exp_f32_e64 v227, -v227
    v_exp_f32 v163, v163
    v_add_f32 v228, v164, v172
    v_sub_f32 v164, v164, v170
    v_exp_f32_e64 v228, -v228
    v_exp_f32 v164, v164
    v_add_f32 v229, v165, v172
    v_sub_f32 v165, v165, v170
    v_exp_f32_e64 v229, -v229
    v_exp_f32 v165, v165
    v_add_f32 v230, v166, v172
    v_sub_f32 v166, v166, v170
    v_exp_f32_e64 v230, -v230
    v_exp_f32 v166, v166
    v_add_f32 v231, v167, v172
    v_sub_f32 v167, v167, v170
    v_exp_f32_e64 v231, -v231
    v_exp_f32 v167, v167
    v_add_f32 v232, v168, v172
    v_sub_f32 v168, v168, v170
    v_exp_f32_e64 v232, -v232
    v_exp_f32 v168, v168
    v_add_f32 v233, v169, v172
    v_sub_f32 v169, v169, v170
    v_exp_f32_e64 v233, -v233
    v_exp_f32 v169, v169
    v_pk_add_f32 v[170:171], v[160:161], v[162:163]
    v_pk_add_f32 v[172:173], v[224:225], v[226:227]
    v_pk_add_f32 v[170:171], v[170:171], v[164:165]
    v_pk_add_f32 v[172:173], v[172:173], v[228:229]
    v_pk_add_f32 v[170:171], v[170:171], v[166:167]
    v_pk_add_f32 v[172:173], v[172:173], v[230:231]
    v_pk_add_f32 v[170:171], v[170:171], v[168:169]
    v_pk_add_f32 v[172:173], v[172:173], v[232:233]
    v_add_f32 v170, v170, v171
    v_add_f32 v172, v172, v173
    s_nop 1
    v_permlane32_swap_b32 v170, v172
    v_add_f32 v170, v170, v172
    v_rcp_f32 v170, v170
    s_nop 0
    v_mov_b32 v172, v170
    s_nop 1
    v_permlane32_swap_b32 v170, v172
    v_pk_mul_f32 v[160:161], v[160:161], v[170:171] op_sel_hi:[1,0]
    v_cvt_pk_bf16_f32 v244, v160, v161
    v_pk_mul_f32 v[162:163], v[162:163], v[170:171] op_sel_hi:[1,0]
    v_cvt_pk_bf16_f32 v245, v162, v163
    v_pk_mul_f32 v[164:165], v[164:165], v[170:171] op_sel_hi:[1,0]
    v_cvt_pk_bf16_f32 v246, v164, v165
    v_pk_mul_f32 v[166:167], v[166:167], v[170:171] op_sel_hi:[1,0]
    v_cvt_pk_bf16_f32 v247, v166, v167
    v_pk_mul_f32 v[168:169], v[168:169], v[170:171] op_sel_hi:[1,0]
    v_cvt_pk_bf16_f32 v248, v168, v169
    v_pk_mul_f32 v[224:225], v[224:225], v[172:173] op_sel_hi:[1,0]
    v_cvt_pk_bf16_f32 v249, v224, v225
    v_pk_mul_f32 v[226:227], v[226:227], v[172:173] op_sel_hi:[1,0]
    v_cvt_pk_bf16_f32 v250, v226, v227
    v_pk_mul_f32 v[228:229], v[228:229], v[172:173] op_sel_hi:[1,0]
    v_cvt_pk_bf16_f32 v251, v228, v229
    v_pk_mul_f32 v[230:231], v[230:231], v[172:173] op_sel_hi:[1,0]
    v_cvt_pk_bf16_f32 v252, v230, v231
    v_pk_mul_f32 v[232:233], v[232:233], v[172:173] op_sel_hi:[1,0]
    v_cvt_pk_bf16_f32 v253, v232, v233
    v_cndmask_b32 v120, v52, v15, s[60:61]
    v_cndmask_b32 v121, v53, v15, s[60:61]
    ds_write_b128 v3, v[72:75]
    ds_write_b64 v4, v[120:121]
    ds_read_b64_tr_b16 v[104:105], v5 offset:0
    ds_read_b64_tr_b16 v[106:107], v5 offset:384
    ds_read_b64_tr_b16 v[116:117], v5 offset:768
    ds_read_b64_tr_b16 v[118:119], v5 offset:1152
    ds_write_b64 v6, v[244:245] offset:0
    ds_write_b64 v6, v[246:247] offset:8
    ds_write_b64 v6, v[248:249] offset:16
    ds_write_b64 v6, v[250:251] offset:24
    ds_write_b64 v6, v[252:253] offset:32
    ds_read_b64_tr_b16 v[96:97], v7 offset:0
    ds_read_b64_tr_b16 v[100:101], v14 offset:32
    ds_read_b64_tr_b16 v[98:99], v7 offset:640
    ds_read_b64_tr_b16 v[102:103], v14 offset:672
    ds_read_b64_tr_b16 v[108:109], v7 offset:1280
    ds_read_b64_tr_b16 v[112:113], v14 offset:1312
    ds_read_b64_tr_b16 v[110:111], v7 offset:1920
    ds_read_b64_tr_b16 v[114:115], v14 offset:1952
    s_waitcnt lgkmcnt(5)
    v_mfma_f32_32x32x16_bf16 v[192:207], v[96:99], v[104:107], v[192:207]
    s_waitcnt lgkmcnt(4)
    v_mfma_f32_32x32x16_bf16 v[208:223], v[100:103], v[104:107], v[208:223]
    s_waitcnt lgkmcnt(1)
    v_mfma_f32_32x32x16_bf16 v[192:207], v[108:111], v[116:119], v[192:207]
    s_waitcnt lgkmcnt(0)
    v_mfma_f32_32x32x16_bf16 v[208:223], v[112:115], v[116:119], v[208:223]
    v_mfma_f32_32x32x16_bf16 v[176:191], v[16:19], v[44:47], 0
    v_mfma_f32_32x32x16_bf16 v[176:191], v[20:23], v[54:57], v[176:191]
    s_nop 11
    v_max3_f32 v186, v176, v177, v178
    v_max3_f32 v188, -v176, -v177, -v178
    v_max3_f32 v186, v186, v179, v180
    v_max3_f32 v188, v188, -v179, -v180
    v_max3_f32 v186, v186, v181, v182
    v_max3_f32 v188, v188, -v181, -v182
    v_max3_f32 v186, v186, v183, v184
    v_max3_f32 v188, v188, -v183, -v184
    v_max_f32 v186, v186, v185
    v_max_f32_e64 v188, v188, -v185
    s_nop 1
    v_permlane32_swap_b32 v186, v188
    v_max_f32 v186, v186, v188
    v_mov_b32 v188, v186
    s_nop 1
    v_permlane32_swap_b32 v186, v188
    v_add_f32 v234, v176, v188
    v_sub_f32 v176, v176, v186
    v_exp_f32_e64 v234, -v234
    v_exp_f32 v176, v176
    v_add_f32 v235, v177, v188
    v_sub_f32 v177, v177, v186
    v_exp_f32_e64 v235, -v235
    v_exp_f32 v177, v177
    v_add_f32 v236, v178, v188
    v_sub_f32 v178, v178, v186
    v_exp_f32_e64 v236, -v236
    v_exp_f32 v178, v178
    v_add_f32 v237, v179, v188
    v_sub_f32 v179, v179, v186
    v_exp_f32_e64 v237, -v237
    v_exp_f32 v179, v179
    v_add_f32 v238, v180, v188
    v_sub_f32 v180, v180, v186
    v_exp_f32_e64 v238, -v238
    v_exp_f32 v180, v180
    v_add_f32 v239, v181, v188
    v_sub_f32 v181, v181, v186
    v_exp_f32_e64 v239, -v239
    v_exp_f32 v181, v181
    v_add_f32 v240, v182, v188
    v_sub_f32 v182, v182, v186
    v_exp_f32_e64 v240, -v240
    v_exp_f32 v182, v182
    v_add_f32 v241, v183, v188
    v_sub_f32 v183, v183, v186
    v_exp_f32_e64 v241, -v241
    v_exp_f32 v183, v183
    v_add_f32 v242, v184, v188
    v_sub_f32 v184, v184, v186
    v_exp_f32_e64 v242, -v242
    v_exp_f32 v184, v184
    v_add_f32 v243, v185, v188
    v_sub_f32 v185, v185, v186
    v_exp_f32_e64 v243, -v243
    v_exp_f32 v185, v185
    v_pk_add_f32 v[186:187], v[176:177], v[178:179]
    v_pk_add_f32 v[188:189], v[234:235], v[236:237]
    v_pk_add_f32 v[186:187], v[186:187], v[180:181]
    v_pk_add_f32 v[188:189], v[188:189], v[238:239]
    v_pk_add_f32 v[186:187], v[186:187], v[182:183]
    v_pk_add_f32 v[188:189], v[188:189], v[240:241]
    v_pk_add_f32 v[186:187], v[186:187], v[184:185]
    v_pk_add_f32 v[188:189], v[188:189], v[242:243]
    v_add_f32 v186, v186, v187
    v_add_f32 v188, v188, v189
    s_nop 1
    v_permlane32_swap_b32 v186, v188
    v_add_f32 v186, v186, v188
    v_rcp_f32 v186, v186
    s_nop 0
    v_mov_b32 v188, v186
    s_nop 1
    v_permlane32_swap_b32 v186, v188
    v_pk_mul_f32 v[176:177], v[176:177], v[186:187] op_sel_hi:[1,0]
    v_cvt_pk_bf16_f32 v244, v176, v177
    v_pk_mul_f32 v[178:179], v[178:179], v[186:187] op_sel_hi:[1,0]
    v_cvt_pk_bf16_f32 v245, v178, v179
    v_pk_mul_f32 v[180:181], v[180:181], v[186:187] op_sel_hi:[1,0]
    v_cvt_pk_bf16_f32 v246, v180, v181
    v_pk_mul_f32 v[182:183], v[182:183], v[186:187] op_sel_hi:[1,0]
    v_cvt_pk_bf16_f32 v247, v182, v183
    v_pk_mul_f32 v[184:185], v[184:185], v[186:187] op_sel_hi:[1,0]
    v_cvt_pk_bf16_f32 v248, v184, v185
    v_pk_mul_f32 v[234:235], v[234:235], v[188:189] op_sel_hi:[1,0]
    v_cvt_pk_bf16_f32 v249, v234, v235
    v_pk_mul_f32 v[236:237], v[236:237], v[188:189] op_sel_hi:[1,0]
    v_cvt_pk_bf16_f32 v250, v236, v237
    v_pk_mul_f32 v[238:239], v[238:239], v[188:189] op_sel_hi:[1,0]
    v_cvt_pk_bf16_f32 v251, v238, v239
    v_pk_mul_f32 v[240:241], v[240:241], v[188:189] op_sel_hi:[1,0]
    v_cvt_pk_bf16_f32 v252, v240, v241
    v_pk_mul_f32 v[242:243], v[242:243], v[188:189] op_sel_hi:[1,0]
    v_cvt_pk_bf16_f32 v253, v242, v243
    v_cndmask_b32 v122, v54, v15, s[60:61]
    v_cndmask_b32 v123, v55, v15, s[60:61]
    ds_write_b128 v3, v[76:79]
    ds_write_b64 v4, v[122:123]
    ds_read_b64_tr_b16 v[104:105], v5 offset:0
    ds_read_b64_tr_b16 v[106:107], v5 offset:384
    ds_read_b64_tr_b16 v[116:117], v5 offset:768
    ds_read_b64_tr_b16 v[118:119], v5 offset:1152
    ds_write_b64 v6, v[244:245] offset:0
    ds_write_b64 v6, v[246:247] offset:8
    ds_write_b64 v6, v[248:249] offset:16
    ds_write_b64 v6, v[250:251] offset:24
    ds_write_b64 v6, v[252:253] offset:32
    ds_read_b64_tr_b16 v[96:97], v7 offset:0
    ds_read_b64_tr_b16 v[100:101], v14 offset:32
    ds_read_b64_tr_b16 v[98:99], v7 offset:640
    ds_read_b64_tr_b16 v[102:103], v14 offset:672
    ds_read_b64_tr_b16 v[108:109], v7 offset:1280
    ds_read_b64_tr_b16 v[112:113], v14 offset:1312
    ds_read_b64_tr_b16 v[110:111], v7 offset:1920
    ds_read_b64_tr_b16 v[114:115], v14 offset:1952
    s_waitcnt lgkmcnt(5)
    v_mfma_f32_32x32x16_bf16 v[192:207], v[96:99], v[104:107], v[192:207]
    s_waitcnt lgkmcnt(4)
    v_mfma_f32_32x32x16_bf16 v[208:223], v[100:103], v[104:107], v[208:223]
    s_waitcnt lgkmcnt(1)
    v_mfma_f32_32x32x16_bf16 v[192:207], v[108:111], v[116:119], v[192:207]
    s_waitcnt lgkmcnt(0)
    v_mfma_f32_32x32x16_bf16 v[208:223], v[112:115], v[116:119], v[208:223]
    s_nop 9
    v_cvt_pk_bf16_f32 v244, v192, v193
    v_cvt_pk_bf16_f32 v245, v194, v195
    v_cvt_pk_bf16_f32 v246, v196, v197
    v_cvt_pk_bf16_f32 v247, v198, v199
    v_cvt_pk_bf16_f32 v248, v200, v201
    v_cvt_pk_bf16_f32 v249, v202, v203
    v_cvt_pk_bf16_f32 v250, v204, v205
    v_cvt_pk_bf16_f32 v251, v206, v207
    v_cvt_pk_bf16_f32 v252, v208, v209
    v_cvt_pk_bf16_f32 v253, v210, v211
    buffer_store_dwordx4 v[244:247], v28, s[12:15], s67 offen sc1
    buffer_store_dwordx4 v[248:251], v28, s[12:15], s67 offen offset:576 sc1
    buffer_store_dwordx2 v[252:253], v29, s[12:15], s67 offen offset:384 sc1
    v_mov_b32 v9, 163776
    s_mov_b64 exec, 1
    ds_add_u32 v9, v13 offset:0
    s_mov_b64 exec, -1
    s_waitcnt vmcnt(0)
    v_mov_b32 v8, 163776
    s_mov_b64 exec, 1
    ds_add_rtn_u32 v11, v8, v13 offset:44
    s_mov_b64 exec, -1
    s_waitcnt lgkmcnt(0)
    v_subrev_u32 v11, 3, v11
    v_and_b32 v11, 0x80000000, v11
    v_or_b32 v12, v12, v11
    buffer_store_dword v13, v12, s[12:15], 0 offen sc1
L_A_slowq:
    s_nop 15
    v_mfma_f32_32x32x16_bf16 v[160:175], v[16:19], v[80:83], 0
    v_mfma_f32_32x32x16_bf16 v[160:175], v[20:23], v[56:59], v[160:175]
    s_nop 11
    v_max3_f32 v170, v160, v161, v162
    v_max3_f32 v172, -v160, -v161, -v162
    v_max3_f32 v170, v170, v163, v164
    v_max3_f32 v172, v172, -v163, -v164
    v_max3_f32 v170, v170, v165, v166
    v_max3_f32 v172, v172, -v165, -v166
    v_max3_f32 v170, v170, v167, v168
    v_max3_f32 v172, v172, -v167, -v168
    v_max_f32 v170, v170, v169
    v_max_f32_e64 v172, v172, -v169
    s_nop 1
    v_permlane32_swap_b32 v170, v172
    v_max_f32 v170, v170, v172
    v_mov_b32 v172, v170
    s_nop 1
    v_permlane32_swap_b32 v170, v172
    v_add_f32 v224, v160, v172
    v_sub_f32 v160, v160, v170
    v_exp_f32_e64 v224, -v224
    v_exp_f32 v160, v160
    v_add_f32 v225, v161, v172
    v_sub_f32 v161, v161, v170
    v_exp_f32_e64 v225, -v225
    v_exp_f32 v161, v161
    v_add_f32 v226, v162, v172
    v_sub_f32 v162, v162, v170
    v_exp_f32_e64 v226, -v226
    v_exp_f32 v162, v162
    v_add_f32 v227, v163, v172
    v_sub_f32 v163, v163, v170
    v_exp_f32_e64 v227, -v227
    v_exp_f32 v163, v163
    v_add_f32 v228, v164, v172
    v_sub_f32 v164, v164, v170
    v_exp_f32_e64 v228, -v228
    v_exp_f32 v164, v164
    v_add_f32 v229, v165, v172
    v_sub_f32 v165, v165, v170
    v_exp_f32_e64 v229, -v229
    v_exp_f32 v165, v165
    v_add_f32 v230, v166, v172
    v_sub_f32 v166, v166, v170
    v_exp_f32_e64 v230, -v230
    v_exp_f32 v166, v166
    v_add_f32 v231, v167, v172
    v_sub_f32 v167, v167, v170
    v_exp_f32_e64 v231, -v231
    v_exp_f32 v167, v167
    v_add_f32 v232, v168, v172
    v_sub_f32 v168, v168, v170
    v_exp_f32_e64 v232, -v232
    v_exp_f32 v168, v168
    v_add_f32 v233, v169, v172
    v_sub_f32 v169, v169, v170
    v_exp_f32_e64 v233, -v233
    v_exp_f32 v169, v169
    v_pk_add_f32 v[170:171], v[160:161], v[162:163]
    v_pk_add_f32 v[172:173], v[224:225], v[226:227]
    v_pk_add_f32 v[170:171], v[170:171], v[164:165]
    v_pk_add_f32 v[172:173], v[172:173], v[228:229]
    v_pk_add_f32 v[170:171], v[170:171], v[166:167]
    v_pk_add_f32 v[172:173], v[172:173], v[230:231]
    v_pk_add_f32 v[170:171], v[170:171], v[168:169]
    v_pk_add_f32 v[172:173], v[172:173], v[232:233]
    v_add_f32 v170, v170, v171
    v_add_f32 v172, v172, v173
    s_nop 1
    v_permlane32_swap_b32 v170, v172
    v_add_f32 v170, v170, v172
    v_rcp_f32 v170, v170
    s_nop 0
    v_mov_b32 v172, v170
    s_nop 1
    v_permlane32_swap_b32 v170, v172
    v_pk_mul_f32 v[160:161], v[160:161], v[170:171] op_sel_hi:[1,0]
    v_cvt_pk_bf16_f32 v128, v160, v161
    v_pk_mul_f32 v[162:163], v[162:163], v[170:171] op_sel_hi:[1,0]
    v_cvt_pk_bf16_f32 v129, v162, v163
    v_pk_mul_f32 v[164:165], v[164:165], v[170:171] op_sel_hi:[1,0]
    v_cvt_pk_bf16_f32 v130, v164, v165
    v_pk_mul_f32 v[166:167], v[166:167], v[170:171] op_sel_hi:[1,0]
    v_cvt_pk_bf16_f32 v131, v166, v167
    v_pk_mul_f32 v[168:169], v[168:169], v[170:171] op_sel_hi:[1,0]
    v_cvt_pk_bf16_f32 v132, v168, v169
    v_pk_mul_f32 v[224:225], v[224:225], v[172:173] op_sel_hi:[1,0]
    v_cvt_pk_bf16_f32 v133, v224, v225
    v_pk_mul_f32 v[226:227], v[226:227], v[172:173] op_sel_hi:[1,0]
    v_cvt_pk_bf16_f32 v134, v226, v227
    v_pk_mul_f32 v[228:229], v[228:229], v[172:173] op_sel_hi:[1,0]
    v_cvt_pk_bf16_f32 v135, v228, v229
    v_pk_mul_f32 v[230:231], v[230:231], v[172:173] op_sel_hi:[1,0]
    v_cvt_pk_bf16_f32 v136, v230, v231
    v_pk_mul_f32 v[232:233], v[232:233], v[172:173] op_sel_hi:[1,0]
    v_cvt_pk_bf16_f32 v137, v232, v233
    v_mfma_f32_32x32x16_bf16 v[176:191], v[16:19], v[84:87], 0
    v_mfma_f32_32x32x16_bf16 v[176:191], v[20:23], v[58:61], v[176:191]
    s_nop 11
    v_max3_f32 v186, v176, v177, v178
    v_max3_f32 v188, -v176, -v177, -v178
    v_max3_f32 v186, v186, v179, v180
    v_max3_f32 v188, v188, -v179, -v180
    v_max3_f32 v186, v186, v181, v182
    v_max3_f32 v188, v188, -v181, -v182
    v_max3_f32 v186, v186, v183, v184
    v_max3_f32 v188, v188, -v183, -v184
    v_max_f32 v186, v186, v185
    v_max_f32_e64 v188, v188, -v185
    s_nop 1
    v_permlane32_swap_b32 v186, v188
    v_max_f32 v186, v186, v188
    v_mov_b32 v188, v186
    s_nop 1
    v_permlane32_swap_b32 v186, v188
    v_add_f32 v234, v176, v188
    v_sub_f32 v176, v176, v186
    v_exp_f32_e64 v234, -v234
    v_exp_f32 v176, v176
    v_add_f32 v235, v177, v188
    v_sub_f32 v177, v177, v186
    v_exp_f32_e64 v235, -v235
    v_exp_f32 v177, v177
    v_add_f32 v236, v178, v188
    v_sub_f32 v178, v178, v186
    v_exp_f32_e64 v236, -v236
    v_exp_f32 v178, v178
    v_add_f32 v237, v179, v188
    v_sub_f32 v179, v179, v186
    v_exp_f32_e64 v237, -v237
    v_exp_f32 v179, v179
    v_add_f32 v238, v180, v188
    v_sub_f32 v180, v180, v186
    v_exp_f32_e64 v238, -v238
    v_exp_f32 v180, v180
    v_add_f32 v239, v181, v188
    v_sub_f32 v181, v181, v186
    v_exp_f32_e64 v239, -v239
    v_exp_f32 v181, v181
    v_add_f32 v240, v182, v188
    v_sub_f32 v182, v182, v186
    v_exp_f32_e64 v240, -v240
    v_exp_f32 v182, v182
    v_add_f32 v241, v183, v188
    v_sub_f32 v183, v183, v186
    v_exp_f32_e64 v241, -v241
    v_exp_f32 v183, v183
    v_add_f32 v242, v184, v188
    v_sub_f32 v184, v184, v186
    v_exp_f32_e64 v242, -v242
    v_exp_f32 v184, v184
    v_add_f32 v243, v185, v188
    v_sub_f32 v185, v185, v186
    v_exp_f32_e64 v243, -v243
    v_exp_f32 v185, v185
    v_pk_add_f32 v[186:187], v[176:177], v[178:179]
    v_pk_add_f32 v[188:189], v[234:235], v[236:237]
    v_pk_add_f32 v[186:187], v[186:187], v[180:181]
    v_pk_add_f32 v[188:189], v[188:189], v[238:239]
    v_pk_add_f32 v[186:187], v[186:187], v[182:183]
    v_pk_add_f32 v[188:189], v[188:189], v[240:241]
    v_pk_add_f32 v[186:187], v[186:187], v[184:185]
    v_pk_add_f32 v[188:189], v[188:189], v[242:243]
    v_add_f32 v186, v186, v187
    v_add_f32 v188, v188, v189
    s_nop 1
    v_permlane32_swap_b32 v186, v188
    v_add_f32 v186, v186, v188
    v_rcp_f32 v186, v186
    s_nop 0
    v_mov_b32 v188, v186
    s_nop 1
    v_permlane32_swap_b32 v186, v188
    v_pk_mul_f32 v[176:177], v[176:177], v[186:187] op_sel_hi:[1,0]
    v_cvt_pk_bf16_f32 v138, v176, v177
    v_pk_mul_f32 v[178:179], v[178:179], v[186:187] op_sel_hi:[1,0]
    v_cvt_pk_bf16_f32 v139, v178, v179
    v_pk_mul_f32 v[180:181], v[180:181], v[186:187] op_sel_hi:[1,0]
    v_cvt_pk_bf16_f32 v140, v180, v181
    v_pk_mul_f32 v[182:183], v[182:183], v[186:187] op_sel_hi:[1,0]
    v_cvt_pk_bf16_f32 v141, v182, v183
    v_pk_mul_f32 v[184:185], v[184:185], v[186:187] op_sel_hi:[1,0]
    v_cvt_pk_bf16_f32 v142, v184, v185
    v_pk_mul_f32 v[234:235], v[234:235], v[188:189] op_sel_hi:[1,0]
    v_cvt_pk_bf16_f32 v143, v234, v235
    v_pk_mul_f32 v[236:237], v[236:237], v[188:189] op_sel_hi:[1,0]
    v_cvt_pk_bf16_f32 v144, v236, v237
    v_pk_mul_f32 v[238:239], v[238:239], v[188:189] op_sel_hi:[1,0]
    v_cvt_pk_bf16_f32 v145, v238, v239
    v_pk_mul_f32 v[240:241], v[240:241], v[188:189] op_sel_hi:[1,0]
    v_cvt_pk_bf16_f32 v146, v240, v241
    v_pk_mul_f32 v[242:243], v[242:243], v[188:189] op_sel_hi:[1,0]
    v_cvt_pk_bf16_f32 v147, v242, v243
    v_mfma_f32_32x32x16_bf16 v[160:175], v[16:19], v[88:91], 0
    v_mfma_f32_32x32x16_bf16 v[160:175], v[20:23], v[60:63], v[160:175]
    s_nop 11
    v_max3_f32 v170, v160, v161, v162
    v_max3_f32 v172, -v160, -v161, -v162
    v_max3_f32 v170, v170, v163, v164
    v_max3_f32 v172, v172, -v163, -v164
    v_max3_f32 v170, v170, v165, v166
    v_max3_f32 v172, v172, -v165, -v166
    v_max3_f32 v170, v170, v167, v168
    v_max3_f32 v172, v172, -v167, -v168
    v_max_f32 v170, v170, v169
    v_max_f32_e64 v172, v172, -v169
    s_nop 1
    v_permlane32_swap_b32 v170, v172
    v_max_f32 v170, v170, v172
    v_mov_b32 v172, v170
    s_nop 1
    v_permlane32_swap_b32 v170, v172
    v_add_f32 v224, v160, v172
    v_sub_f32 v160, v160, v170
    v_exp_f32_e64 v224, -v224
    v_exp_f32 v160, v160
    v_add_f32 v225, v161, v172
    v_sub_f32 v161, v161, v170
    v_exp_f32_e64 v225, -v225
    v_exp_f32 v161, v161
    v_add_f32 v226, v162, v172
    v_sub_f32 v162, v162, v170
    v_exp_f32_e64 v226, -v226
    v_exp_f32 v162, v162
    v_add_f32 v227, v163, v172
    v_sub_f32 v163, v163, v170
    v_exp_f32_e64 v227, -v227
    v_exp_f32 v163, v163
    v_add_f32 v228, v164, v172
    v_sub_f32 v164, v164, v170
    v_exp_f32_e64 v228, -v228
    v_exp_f32 v164, v164
    v_add_f32 v229, v165, v172
    v_sub_f32 v165, v165, v170
    v_exp_f32_e64 v229, -v229
    v_exp_f32 v165, v165
    v_add_f32 v230, v166, v172
    v_sub_f32 v166, v166, v170
    v_exp_f32_e64 v230, -v230
    v_exp_f32 v166, v166
    v_add_f32 v231, v167, v172
    v_sub_f32 v167, v167, v170
    v_exp_f32_e64 v231, -v231
    v_exp_f32 v167, v167
    v_add_f32 v232, v168, v172
    v_sub_f32 v168, v168, v170
    v_exp_f32_e64 v232, -v232
    v_exp_f32 v168, v168
    v_add_f32 v233, v169, v172
    v_sub_f32 v169, v169, v170
    v_exp_f32_e64 v233, -v233
    v_exp_f32 v169, v169
    v_pk_add_f32 v[170:171], v[160:161], v[162:163]
    v_pk_add_f32 v[172:173], v[224:225], v[226:227]
    v_pk_add_f32 v[170:171], v[170:171], v[164:165]
    v_pk_add_f32 v[172:173], v[172:173], v[228:229]
    v_pk_add_f32 v[170:171], v[170:171], v[166:167]
    v_pk_add_f32 v[172:173], v[172:173], v[230:231]
    v_pk_add_f32 v[170:171], v[170:171], v[168:169]
    v_pk_add_f32 v[172:173], v[172:173], v[232:233]
    v_add_f32 v170, v170, v171
    v_add_f32 v172, v172, v173
    s_nop 1
    v_permlane32_swap_b32 v170, v172
    v_add_f32 v170, v170, v172
    v_rcp_f32 v170, v170
    s_nop 0
    v_mov_b32 v172, v170
    s_nop 1
    v_permlane32_swap_b32 v170, v172
    v_pk_mul_f32 v[160:161], v[160:161], v[170:171] op_sel_hi:[1,0]
    v_cvt_pk_bf16_f32 v148, v160, v161
    v_pk_mul_f32 v[162:163], v[162:163], v[170:171] op_sel_hi:[1,0]
    v_cvt_pk_bf16_f32 v149, v162, v163
    v_pk_mul_f32 v[164:165], v[164:165], v[170:171] op_sel_hi:[1,0]
    v_cvt_pk_bf16_f32 v150, v164, v165
    v_pk_mul_f32 v[166:167], v[166:167], v[170:171] op_sel_hi:[1,0]
    v_cvt_pk_bf16_f32 v151, v166, v167
    v_pk_mul_f32 v[168:169], v[168:169], v[170:171] op_sel_hi:[1,0]
    v_cvt_pk_bf16_f32 v152, v168, v169
    v_pk_mul_f32 v[224:225], v[224:225], v[172:173] op_sel_hi:[1,0]
    v_cvt_pk_bf16_f32 v153, v224, v225
    v_pk_mul_f32 v[226:227], v[226:227], v[172:173] op_sel_hi:[1,0]
    v_cvt_pk_bf16_f32 v154, v226, v227
    v_pk_mul_f32 v[228:229], v[228:229], v[172:173] op_sel_hi:[1,0]
    v_cvt_pk_bf16_f32 v155, v228, v229
    v_pk_mul_f32 v[230:231], v[230:231], v[172:173] op_sel_hi:[1,0]
    v_cvt_pk_bf16_f32 v156, v230, v231
    v_pk_mul_f32 v[232:233], v[232:233], v[172:173] op_sel_hi:[1,0]
    v_cvt_pk_bf16_f32 v157, v232, v233
    v_mfma_f32_32x32x16_bf16 v[176:191], v[16:19], v[92:95], 0
    v_mfma_f32_32x32x16_bf16 v[176:191], v[20:23], v[62:65], v[176:191]
    s_nop 11
    v_max3_f32 v186, v176, v177, v178
    v_max3_f32 v188, -v176, -v177, -v178
    v_max3_f32 v186, v186, v179, v180
    v_max3_f32 v188, v188, -v179, -v180
    v_max3_f32 v186, v186, v181, v182
    v_max3_f32 v188, v188, -v181, -v182
    v_max3_f32 v186, v186, v183, v184
    v_max3_f32 v188, v188, -v183, -v184
    v_max_f32 v186, v186, v185
    v_max_f32_e64 v188, v188, -v185
    s_nop 1
    v_permlane32_swap_b32 v186, v188
    v_max_f32 v186, v186, v188
    v_mov_b32 v188, v186
    s_nop 1
    v_permlane32_swap_b32 v186, v188
    v_add_f32 v234, v176, v188
    v_sub_f32 v176, v176, v186
    v_exp_f32_e64 v234, -v234
    v_exp_f32 v176, v176
    v_add_f32 v235, v177, v188
    v_sub_f32 v177, v177, v186
    v_exp_f32_e64 v235, -v235
    v_exp_f32 v177, v177
    v_add_f32 v236, v178, v188
    v_sub_f32 v178, v178, v186
    v_exp_f32_e64 v236, -v236
    v_exp_f32 v178, v178
    v_add_f32 v237, v179, v188
    v_sub_f32 v179, v179, v186
    v_exp_f32_e64 v237, -v237
    v_exp_f32 v179, v179
    v_add_f32 v238, v180, v188
    v_sub_f32 v180, v180, v186
    v_exp_f32_e64 v238, -v238
    v_exp_f32 v180, v180
    v_add_f32 v239, v181, v188
    v_sub_f32 v181, v181, v186
    v_exp_f32_e64 v239, -v239
    v_exp_f32 v181, v181
    v_add_f32 v240, v182, v188
    v_sub_f32 v182, v182, v186
    v_exp_f32_e64 v240, -v240
    v_exp_f32 v182, v182
    v_add_f32 v241, v183, v188
    v_sub_f32 v183, v183, v186
    v_exp_f32_e64 v241, -v241
    v_exp_f32 v183, v183
    v_add_f32 v242, v184, v188
    v_sub_f32 v184, v184, v186
    v_exp_f32_e64 v242, -v242
    v_exp_f32 v184, v184
    v_add_f32 v243, v185, v188
    v_sub_f32 v185, v185, v186
    v_exp_f32_e64 v243, -v243
    v_exp_f32 v185, v185
    v_pk_add_f32 v[186:187], v[176:177], v[178:179]
    v_pk_add_f32 v[188:189], v[234:235], v[236:237]
    v_pk_add_f32 v[186:187], v[186:187], v[180:181]
    v_pk_add_f32 v[188:189], v[188:189], v[238:239]
    v_pk_add_f32 v[186:187], v[186:187], v[182:183]
    v_pk_add_f32 v[188:189], v[188:189], v[240:241]
    v_pk_add_f32 v[186:187], v[186:187], v[184:185]
    v_pk_add_f32 v[188:189], v[188:189], v[242:243]
    v_add_f32 v186, v186, v187
    v_add_f32 v188, v188, v189
    s_nop 1
    v_permlane32_swap_b32 v186, v188
    v_add_f32 v186, v186, v188
    v_rcp_f32 v186, v186
    s_nop 0
    v_mov_b32 v188, v186
    s_nop 1
    v_permlane32_swap_b32 v186, v188
    v_pk_mul_f32 v[176:177], v[176:177], v[186:187] op_sel_hi:[1,0]
    v_cvt_pk_bf16_f32 v244, v176, v177
    v_pk_mul_f32 v[178:179], v[178:179], v[186:187] op_sel_hi:[1,0]
    v_cvt_pk_bf16_f32 v245, v178, v179
    v_pk_mul_f32 v[180:181], v[180:181], v[186:187] op_sel_hi:[1,0]
    v_cvt_pk_bf16_f32 v246, v180, v181
    v_pk_mul_f32 v[182:183], v[182:183], v[186:187] op_sel_hi:[1,0]
    v_cvt_pk_bf16_f32 v247, v182, v183
    v_pk_mul_f32 v[184:185], v[184:185], v[186:187] op_sel_hi:[1,0]
    v_cvt_pk_bf16_f32 v248, v184, v185
    v_pk_mul_f32 v[234:235], v[234:235], v[188:189] op_sel_hi:[1,0]
    v_cvt_pk_bf16_f32 v249, v234, v235
    v_pk_mul_f32 v[236:237], v[236:237], v[188:189] op_sel_hi:[1,0]
    v_cvt_pk_bf16_f32 v250, v236, v237
    v_pk_mul_f32 v[238:239], v[238:239], v[188:189] op_sel_hi:[1,0]
    v_cvt_pk_bf16_f32 v251, v238, v239
    v_pk_mul_f32 v[240:241], v[240:241], v[188:189] op_sel_hi:[1,0]
    v_cvt_pk_bf16_f32 v252, v240, v241
    v_pk_mul_f32 v[242:243], v[242:243], v[188:189] op_sel_hi:[1,0]
    v_cvt_pk_bf16_f32 v253, v242, v243
    s_branch L_A_pre
L_B_slow:
    s_waitcnt vmcnt(0)
    s_mov_b32 s79, 9
    v_and_b32 v8, 31, v0
    v_lshrrev_b32 v9, 5, v0
    v_lshlrev_b32 v9, 2, v9
    v_sub_u32 v8, v8, v9
    v_mov_b32 v9, 0xff800000
    v_mov_b32 v36, 0
    v_mov_b32 v37, 0
    v_mov_b32 v40, 0
    v_mov_b32 v41, 0
    s_lshl_b32 s28, s58, 4
    s_mul_i32 s66, s28, 11264
    s_add_u32 s66, s66, 1343488
    v_cmp_gt_i32 vcc, 0, v8
    s_nop 1
    v_cndmask_b32 v16, 0, v9, vcc
    v_cmp_gt_i32 vcc, 1, v8
    s_nop 1
    v_cndmask_b32 v17, 0, v9, vcc
    v_cmp_gt_i32 vcc, 2, v8
    s_nop 1
    v_cndmask_b32 v18, 0, v9, vcc
    v_cmp_gt_i32 vcc, 3, v8
    s_nop 1
    v_cndmask_b32 v19, 0, v9, vcc
    v_cmp_gt_i32 vcc, 8, v8
    s_nop 1
    v_cndmask_b32 v20, 0, v9, vcc
    v_cmp_gt_i32 vcc, 9, v8
    s_nop 1
    v_cndmask_b32 v21, 0, v9, vcc
    v_cmp_gt_i32 vcc, 10, v8
    s_nop 1
    v_cndmask_b32 v22, 0, v9, vcc
    v_cmp_gt_i32 vcc, 11, v8
    s_nop 1
    v_cndmask_b32 v23, 0, v9, vcc
    v_cmp_gt_i32 vcc, 16, v8
    s_nop 1
    v_cndmask_b32 v24, 0, v9, vcc
    v_cmp_gt_i32 vcc, 17, v8
    s_nop 1
    v_cndmask_b32 v25, 0, v9, vcc
    v_cmp_gt_i32 vcc, 18, v8
    s_nop 1
    v_cndmask_b32 v26, 0, v9, vcc
    v_cmp_gt_i32 vcc, 19, v8
    s_nop 1
    v_cndmask_b32 v27, 0, v9, vcc
    v_cmp_gt_i32 vcc, 24, v8
    s_nop 1
    v_cndmask_b32 v28, 0, v9, vcc
    v_cmp_gt_i32 vcc, 25, v8
    s_nop 1
    v_cndmask_b32 v29, 0, v9, vcc
    v_cmp_gt_i32 vcc, 26, v8
    s_nop 1
    v_cndmask_b32 v30, 0, v9, vcc
    v_cmp_gt_i32 vcc, 27, v8
    s_nop 1
    v_cndmask_b32 v31, 0, v9, vcc
    s_lshl_b32 s67, s22, 2
    s_add_u32 s67, s67, 0
    s_sub_u32 s68, s67, 8
    s_mov_b32 s69, 0
    v_mov_b32 v8, 0xff800000
    v_mov_b32 v192, 0
    v_mov_b32 v193, 0
    v_mov_b32 v194, 0
    v_mov_b32 v195, 0
    v_mov_b32 v196, 0
    v_mov_b32 v197, 0
    v_mov_b32 v198, 0
    v_mov_b32 v199, 0
    v_mov_b32 v200, 0
    v_mov_b32 v201, 0
    v_mov_b32 v202, 0
    v_mov_b32 v203, 0
    v_mov_b32 v204, 0
    v_mov_b32 v205, 0
    v_mov_b32 v206, 0
    v_mov_b32 v207, 0
L_sp0:
    s_max_i32 s70, s68, 0
L_sk0:
    s_lshr_b32 s28, s70, 2
    s_mul_i32 s28, s28, 11264
    s_add_u32 s28, s28, s66
    s_and_b32 s29, s70, 3
    s_lshl_b32 s30, s29, 10
    s_add_u32 s30, s30, s28
    buffer_load_dwordx4 v[32:35], v1, s[12:15], s30 offen sc1
    s_lshr_b32 s30, s29, 1
    s_lshl_b32 s30, s30, 9
    s_and_b32 s31, s29, 1
    s_lshl_b32 s31, s31, 3
    s_add_u32 s30, s30, s31
    s_add_u32 s30, s30, s28
    s_add_u32 s30, s30, 4096
    buffer_load_dwordx2 v[38:39], v11, s[12:15], s30 offen sc1
    s_mul_i32 s30, s29, 1536
    s_add_u32 s30, s30, s28
    s_add_u32 s30, s30, 5120
    buffer_load_dwordx4 v[44:47], v6, s[12:15], s30 offen sc1
    buffer_load_dwordx4 v[48:51], v6, s[12:15], s30 offen offset:768 sc1
    s_cmp_eq_u32 s70, s68
    s_cselect_b32 s28, 0xff800000, 0
    s_cselect_b32 s29, -1, 0
    s_cmp_eq_u32 s70, s67
    s_cselect_b32 s29, -1, s29
    v_xor_b32 v136, s28, v16
    v_and_b32 v136, s29, v136
    v_xor_b32 v137, s28, v17
    v_and_b32 v137, s29, v137
    v_xor_b32 v138, s28, v18
    v_and_b32 v138, s29, v138
    v_xor_b32 v139, s28, v19
    v_and_b32 v139, s29, v139
    v_xor_b32 v140, s28, v20
    v_and_b32 v140, s29, v140
    v_xor_b32 v141, s28, v21
    v_and_b32 v141, s29, v141
    v_xor_b32 v142, s28, v22
    v_and_b32 v142, s29, v142
    v_xor_b32 v143, s28, v23
    v_and_b32 v143, s29, v143
    v_xor_b32 v144, s28, v24
    v_and_b32 v144, s29, v144
    v_xor_b32 v145, s28, v25
    v_and_b32 v145, s29, v145
    v_xor_b32 v146, s28, v26
    v_and_b32 v146, s29, v146
    v_xor_b32 v147, s28, v27
    v_and_b32 v147, s29, v147
    v_xor_b32 v148, s28, v28
    v_and_b32 v148, s29, v148
    v_xor_b32 v149, s28, v29
    v_and_b32 v149, s29, v149
    v_xor_b32 v150, s28, v30
    v_and_b32 v150, s29, v150
    v_xor_b32 v151, s28, v31
    v_and_b32 v151, s29, v151
    s_waitcnt vmcnt(0)
    s_nop 1
    v_mfma_f32_32x32x16_bf16 v[176:191], v[32:35], v[112:115], v[136:151]
    v_mfma_f32_32x32x16_bf16 v[176:191], v[38:41], v[56:59], v[176:191]
    s_nop 15
    s_cmp_lg_u32 s69, 0
    s_cbranch_scc1 L_s20
    v_max3_f32 v8, v8, v176, v177
    v_max3_f32 v8, v8, v178, v179
    v_max3_f32 v8, v8, v180, v181
    v_max3_f32 v8, v8, v182, v183
    v_max3_f32 v8, v8, v184, v185
    v_max3_f32 v8, v8, v186, v187
    v_max3_f32 v8, v8, v188, v189
    v_max3_f32 v8, v8, v190, v191
    s_branch L_sn0
L_s20:
    v_sub_f32 v176, v176, v8
    v_sub_f32 v177, v177, v8
    v_sub_f32 v178, v178, v8
    v_sub_f32 v179, v179, v8
    v_sub_f32 v180, v180, v8
    v_sub_f32 v181, v181, v8
    v_sub_f32 v182, v182, v8
    v_sub_f32 v183, v183, v8
    v_sub_f32 v184, v184, v8
    v_sub_f32 v185, v185, v8
    v_sub_f32 v186, v186, v8
    v_sub_f32 v187, v187, v8
    v_sub_f32 v188, v188, v8
    v_sub_f32 v189, v189, v8
    v_sub_f32 v190, v190, v8
    v_sub_f32 v191, v191, v8
    v_exp_f32 v176, v176
    v_exp_f32 v177, v177
    v_exp_f32 v178, v178
    v_exp_f32 v179, v179
    v_exp_f32 v180, v180
    v_exp_f32 v181, v181
    v_exp_f32 v182, v182
    v_exp_f32 v183, v183
    v_exp_f32 v184, v184
    v_exp_f32 v185, v185
    v_exp_f32 v186, v186
    v_exp_f32 v187, v187
    v_exp_f32 v188, v188
    v_exp_f32 v189, v189
    v_exp_f32 v190, v190
    v_exp_f32 v191, v191
    v_cvt_pk_bf16_f32 v128, v176, v177
    v_cvt_pk_bf16_f32 v129, v178, v179
    v_cvt_pk_bf16_f32 v130, v180, v181
    v_cvt_pk_bf16_f32 v131, v182, v183
    v_cvt_pk_bf16_f32 v132, v184, v185
    v_cvt_pk_bf16_f32 v133, v186, v187
    v_cvt_pk_bf16_f32 v134, v188, v189
    v_cvt_pk_bf16_f32 v135, v190, v191
    s_nop 1
    v_mfma_f32_32x32x16_bf16 v[192:207], v[44:47], v[128:131], v[192:207]
    v_mfma_f32_32x32x16_bf16 v[192:207], v[48:51], v[132:135], v[192:207]
    s_nop 15
L_sn0:
    s_add_u32 s70, s70, 1
    s_cmp_le_u32 s70, s67
    s_cbranch_scc1 L_sk0
    v_mov_b32 v9, v8
    s_nop 1
    v_permlane32_swap_b32 v8, v9
    v_max_f32 v8, v8, v9
    s_add_u32 s69, s69, 1
    s_cmp_lt_u32 s69, 2
    s_cbranch_scc1 L_sp0
    s_lshl_b32 s67, s22, 2
    s_add_u32 s67, s67, 1
    s_sub_u32 s68, s67, 8
    s_mov_b32 s69, 0
    v_mov_b32 v8, 0xff800000
    v_mov_b32 v208, 0
    v_mov_b32 v209, 0
    v_mov_b32 v210, 0
    v_mov_b32 v211, 0
    v_mov_b32 v212, 0
    v_mov_b32 v213, 0
    v_mov_b32 v214, 0
    v_mov_b32 v215, 0
    v_mov_b32 v216, 0
    v_mov_b32 v217, 0
    v_mov_b32 v218, 0
    v_mov_b32 v219, 0
    v_mov_b32 v220, 0
    v_mov_b32 v221, 0
    v_mov_b32 v222, 0
    v_mov_b32 v223, 0
L_sp1:
    s_max_i32 s70, s68, 0
L_sk1:
    s_lshr_b32 s28, s70, 2
    s_mul_i32 s28, s28, 11264
    s_add_u32 s28, s28, s66
    s_and_b32 s29, s70, 3
    s_lshl_b32 s30, s29, 10
    s_add_u32 s30, s30, s28
    buffer_load_dwordx4 v[32:35], v1, s[12:15], s30 offen sc1
    s_lshr_b32 s30, s29, 1
    s_lshl_b32 s30, s30, 9
    s_and_b32 s31, s29, 1
    s_lshl_b32 s31, s31, 3
    s_add_u32 s30, s30, s31
    s_add_u32 s30, s30, s28
    s_add_u32 s30, s30, 4096
    buffer_load_dwordx2 v[38:39], v11, s[12:15], s30 offen sc1
    s_mul_i32 s30, s29, 1536
    s_add_u32 s30, s30, s28
    s_add_u32 s30, s30, 5120
    buffer_load_dwordx4 v[44:47], v6, s[12:15], s30 offen sc1
    buffer_load_dwordx4 v[48:51], v6, s[12:15], s30 offen offset:768 sc1
    s_cmp_eq_u32 s70, s68
    s_cselect_b32 s28, 0xff800000, 0
    s_cselect_b32 s29, -1, 0
    s_cmp_eq_u32 s70, s67
    s_cselect_b32 s29, -1, s29
    v_xor_b32 v136, s28, v16
    v_and_b32 v136, s29, v136
    v_xor_b32 v137, s28, v17
    v_and_b32 v137, s29, v137
    v_xor_b32 v138, s28, v18
    v_and_b32 v138, s29, v138
    v_xor_b32 v139, s28, v19
    v_and_b32 v139, s29, v139
    v_xor_b32 v140, s28, v20
    v_and_b32 v140, s29, v140
    v_xor_b32 v141, s28, v21
    v_and_b32 v141, s29, v141
    v_xor_b32 v142, s28, v22
    v_and_b32 v142, s29, v142
    v_xor_b32 v143, s28, v23
    v_and_b32 v143, s29, v143
    v_xor_b32 v144, s28, v24
    v_and_b32 v144, s29, v144
    v_xor_b32 v145, s28, v25
    v_and_b32 v145, s29, v145
    v_xor_b32 v146, s28, v26
    v_and_b32 v146, s29, v146
    v_xor_b32 v147, s28, v27
    v_and_b32 v147, s29, v147
    v_xor_b32 v148, s28, v28
    v_and_b32 v148, s29, v148
    v_xor_b32 v149, s28, v29
    v_and_b32 v149, s29, v149
    v_xor_b32 v150, s28, v30
    v_and_b32 v150, s29, v150
    v_xor_b32 v151, s28, v31
    v_and_b32 v151, s29, v151
    s_waitcnt vmcnt(0)
    s_nop 1
    v_mfma_f32_32x32x16_bf16 v[176:191], v[32:35], v[116:119], v[136:151]
    v_mfma_f32_32x32x16_bf16 v[176:191], v[36:39], v[58:61], v[176:191]
    s_nop 15
    s_cmp_lg_u32 s69, 0
    s_cbranch_scc1 L_s21
    v_max3_f32 v8, v8, v176, v177
    v_max3_f32 v8, v8, v178, v179
    v_max3_f32 v8, v8, v180, v181
    v_max3_f32 v8, v8, v182, v183
    v_max3_f32 v8, v8, v184, v185
    v_max3_f32 v8, v8, v186, v187
    v_max3_f32 v8, v8, v188, v189
    v_max3_f32 v8, v8, v190, v191
    s_branch L_sn1
L_s21:
    v_sub_f32 v176, v176, v8
    v_sub_f32 v177, v177, v8
    v_sub_f32 v178, v178, v8
    v_sub_f32 v179, v179, v8
    v_sub_f32 v180, v180, v8
    v_sub_f32 v181, v181, v8
    v_sub_f32 v182, v182, v8
    v_sub_f32 v183, v183, v8
    v_sub_f32 v184, v184, v8
    v_sub_f32 v185, v185, v8
    v_sub_f32 v186, v186, v8
    v_sub_f32 v187, v187, v8
    v_sub_f32 v188, v188, v8
    v_sub_f32 v189, v189, v8
    v_sub_f32 v190, v190, v8
    v_sub_f32 v191, v191, v8
    v_exp_f32 v176, v176
    v_exp_f32 v177, v177
    v_exp_f32 v178, v178
    v_exp_f32 v179, v179
    v_exp_f32 v180, v180
    v_exp_f32 v181, v181
    v_exp_f32 v182, v182
    v_exp_f32 v183, v183
    v_exp_f32 v184, v184
    v_exp_f32 v185, v185
    v_exp_f32 v186, v186
    v_exp_f32 v187, v187
    v_exp_f32 v188, v188
    v_exp_f32 v189, v189
    v_exp_f32 v190, v190
    v_exp_f32 v191, v191
    v_cvt_pk_bf16_f32 v128, v176, v177
    v_cvt_pk_bf16_f32 v129, v178, v179
    v_cvt_pk_bf16_f32 v130, v180, v181
    v_cvt_pk_bf16_f32 v131, v182, v183
    v_cvt_pk_bf16_f32 v132, v184, v185
    v_cvt_pk_bf16_f32 v133, v186, v187
    v_cvt_pk_bf16_f32 v134, v188, v189
    v_cvt_pk_bf16_f32 v135, v190, v191
    s_nop 1
    v_mfma_f32_32x32x16_bf16 v[208:223], v[44:47], v[128:131], v[208:223]
    v_mfma_f32_32x32x16_bf16 v[208:223], v[48:51], v[132:135], v[208:223]
    s_nop 15
L_sn1:
    s_add_u32 s70, s70, 1
    s_cmp_le_u32 s70, s67
    s_cbranch_scc1 L_sk1
    v_mov_b32 v9, v8
    s_nop 1
    v_permlane32_swap_b32 v8, v9
    v_max_f32 v8, v8, v9
    s_add_u32 s69, s69, 1
    s_cmp_lt_u32 s69, 2
    s_cbranch_scc1 L_sp1
    s_lshl_b32 s67, s22, 2
    s_add_u32 s67, s67, 2
    s_sub_u32 s68, s67, 8
    s_mov_b32 s69, 0
    v_mov_b32 v8, 0xff800000
    v_mov_b32 v224, 0
    v_mov_b32 v225, 0
    v_mov_b32 v226, 0
    v_mov_b32 v227, 0
    v_mov_b32 v228, 0
    v_mov_b32 v229, 0
    v_mov_b32 v230, 0
    v_mov_b32 v231, 0
    v_mov_b32 v232, 0
    v_mov_b32 v233, 0
    v_mov_b32 v234, 0
    v_mov_b32 v235, 0
    v_mov_b32 v236, 0
    v_mov_b32 v237, 0
    v_mov_b32 v238, 0
    v_mov_b32 v239, 0
L_sp2:
    s_max_i32 s70, s68, 0
L_sk2:
    s_lshr_b32 s28, s70, 2
    s_mul_i32 s28, s28, 11264
    s_add_u32 s28, s28, s66
    s_and_b32 s29, s70, 3
    s_lshl_b32 s30, s29, 10
    s_add_u32 s30, s30, s28
    buffer_load_dwordx4 v[32:35], v1, s[12:15], s30 offen sc1
    s_lshr_b32 s30, s29, 1
    s_lshl_b32 s30, s30, 9
    s_and_b32 s31, s29, 1
    s_lshl_b32 s31, s31, 3
    s_add_u32 s30, s30, s31
    s_add_u32 s30, s30, s28
    s_add_u32 s30, s30, 4096
    buffer_load_dwordx2 v[38:39], v11, s[12:15], s30 offen sc1
    s_mul_i32 s30, s29, 1536
    s_add_u32 s30, s30, s28
    s_add_u32 s30, s30, 5120
    buffer_load_dwordx4 v[44:47], v6, s[12:15], s30 offen sc1
    buffer_load_dwordx4 v[48:51], v6, s[12:15], s30 offen offset:768 sc1
    s_cmp_eq_u32 s70, s68
    s_cselect_b32 s28, 0xff800000, 0
    s_cselect_b32 s29, -1, 0
    s_cmp_eq_u32 s70, s67
    s_cselect_b32 s29, -1, s29
    v_xor_b32 v136, s28, v16
    v_and_b32 v136, s29, v136
    v_xor_b32 v137, s28, v17
    v_and_b32 v137, s29, v137
    v_xor_b32 v138, s28, v18
    v_and_b32 v138, s29, v138
    v_xor_b32 v139, s28, v19
    v_and_b32 v139, s29, v139
    v_xor_b32 v140, s28, v20
    v_and_b32 v140, s29, v140
    v_xor_b32 v141, s28, v21
    v_and_b32 v141, s29, v141
    v_xor_b32 v142, s28, v22
    v_and_b32 v142, s29, v142
    v_xor_b32 v143, s28, v23
    v_and_b32 v143, s29, v143
    v_xor_b32 v144, s28, v24
    v_and_b32 v144, s29, v144
    v_xor_b32 v145, s28, v25
    v_and_b32 v145, s29, v145
    v_xor_b32 v146, s28, v26
    v_and_b32 v146, s29, v146
    v_xor_b32 v147, s28, v27
    v_and_b32 v147, s29, v147
    v_xor_b32 v148, s28, v28
    v_and_b32 v148, s29, v148
    v_xor_b32 v149, s28, v29
    v_and_b32 v149, s29, v149
    v_xor_b32 v150, s28, v30
    v_and_b32 v150, s29, v150
    v_xor_b32 v151, s28, v31
    v_and_b32 v151, s29, v151
    s_waitcnt vmcnt(0)
    s_nop 1
    v_mfma_f32_32x32x16_bf16 v[176:191], v[32:35], v[120:123], v[136:151]
    v_mfma_f32_32x32x16_bf16 v[176:191], v[38:41], v[62:65], v[176:191]
    s_nop 15
    s_cmp_lg_u32 s69, 0
    s_cbranch_scc1 L_s22
    v_max3_f32 v8, v8, v176, v177
    v_max3_f32 v8, v8, v178, v179
    v_max3_f32 v8, v8, v180, v181
    v_max3_f32 v8, v8, v182, v183
    v_max3_f32 v8, v8, v184, v185
    v_max3_f32 v8, v8, v186, v187
    v_max3_f32 v8, v8, v188, v189
    v_max3_f32 v8, v8, v190, v191
    s_branch L_sn2
L_s22:
    v_sub_f32 v176, v176, v8
    v_sub_f32 v177, v177, v8
    v_sub_f32 v178, v178, v8
    v_sub_f32 v179, v179, v8
    v_sub_f32 v180, v180, v8
    v_sub_f32 v181, v181, v8
    v_sub_f32 v182, v182, v8
    v_sub_f32 v183, v183, v8
    v_sub_f32 v184, v184, v8
    v_sub_f32 v185, v185, v8
    v_sub_f32 v186, v186, v8
    v_sub_f32 v187, v187, v8
    v_sub_f32 v188, v188, v8
    v_sub_f32 v189, v189, v8
    v_sub_f32 v190, v190, v8
    v_sub_f32 v191, v191, v8
    v_exp_f32 v176, v176
    v_exp_f32 v177, v177
    v_exp_f32 v178, v178
    v_exp_f32 v179, v179
    v_exp_f32 v180, v180
    v_exp_f32 v181, v181
    v_exp_f32 v182, v182
    v_exp_f32 v183, v183
    v_exp_f32 v184, v184
    v_exp_f32 v185, v185
    v_exp_f32 v186, v186
    v_exp_f32 v187, v187
    v_exp_f32 v188, v188
    v_exp_f32 v189, v189
    v_exp_f32 v190, v190
    v_exp_f32 v191, v191
    v_cvt_pk_bf16_f32 v128, v176, v177
    v_cvt_pk_bf16_f32 v129, v178, v179
    v_cvt_pk_bf16_f32 v130, v180, v181
    v_cvt_pk_bf16_f32 v131, v182, v183
    v_cvt_pk_bf16_f32 v132, v184, v185
    v_cvt_pk_bf16_f32 v133, v186, v187
    v_cvt_pk_bf16_f32 v134, v188, v189
    v_cvt_pk_bf16_f32 v135, v190, v191
    s_nop 1
    v_mfma_f32_32x32x16_bf16 v[224:239], v[44:47], v[128:131], v[224:239]
    v_mfma_f32_32x32x16_bf16 v[224:239], v[48:51], v[132:135], v[224:239]
    s_nop 15
L_sn2:
    s_add_u32 s70, s70, 1
    s_cmp_le_u32 s70, s67
    s_cbranch_scc1 L_sk2
    v_mov_b32 v9, v8
    s_nop 1
    v_permlane32_swap_b32 v8, v9
    v_max_f32 v8, v8, v9
    s_add_u32 s69, s69, 1
    s_cmp_lt_u32 s69, 2
    s_cbranch_scc1 L_sp2
    s_lshl_b32 s67, s22, 2
    s_add_u32 s67, s67, 3
    s_sub_u32 s68, s67, 8
    s_mov_b32 s69, 0
    v_mov_b32 v8, 0xff800000
    v_mov_b32 v240, 0
    v_mov_b32 v241, 0
    v_mov_b32 v242, 0
    v_mov_b32 v243, 0
    v_mov_b32 v244, 0
    v_mov_b32 v245, 0
    v_mov_b32 v246, 0
    v_mov_b32 v247, 0
    v_mov_b32 v248, 0
    v_mov_b32 v249, 0
    v_mov_b32 v250, 0
    v_mov_b32 v251, 0
    v_mov_b32 v252, 0
    v_mov_b32 v253, 0
    v_mov_b32 v254, 0
    v_mov_b32 v255, 0
L_sp3:
    s_max_i32 s70, s68, 0
L_sk3:
    s_lshr_b32 s28, s70, 2
    s_mul_i32 s28, s28, 11264
    s_add_u32 s28, s28, s66
    s_and_b32 s29, s70, 3
    s_lshl_b32 s30, s29, 10
    s_add_u32 s30, s30, s28
    buffer_load_dwordx4 v[32:35], v1, s[12:15], s30 offen sc1
    s_lshr_b32 s30, s29, 1
    s_lshl_b32 s30, s30, 9
    s_and_b32 s31, s29, 1
    s_lshl_b32 s31, s31, 3
    s_add_u32 s30, s30, s31
    s_add_u32 s30, s30, s28
    s_add_u32 s30, s30, 4096
    buffer_load_dwordx2 v[38:39], v11, s[12:15], s30 offen sc1
    s_mul_i32 s30, s29, 1536
    s_add_u32 s30, s30, s28
    s_add_u32 s30, s30, 5120
    buffer_load_dwordx4 v[44:47], v6, s[12:15], s30 offen sc1
    buffer_load_dwordx4 v[48:51], v6, s[12:15], s30 offen offset:768 sc1
    s_cmp_eq_u32 s70, s68
    s_cselect_b32 s28, 0xff800000, 0
    s_cselect_b32 s29, -1, 0
    s_cmp_eq_u32 s70, s67
    s_cselect_b32 s29, -1, s29
    v_xor_b32 v136, s28, v16
    v_and_b32 v136, s29, v136
    v_xor_b32 v137, s28, v17
    v_and_b32 v137, s29, v137
    v_xor_b32 v138, s28, v18
    v_and_b32 v138, s29, v138
    v_xor_b32 v139, s28, v19
    v_and_b32 v139, s29, v139
    v_xor_b32 v140, s28, v20
    v_and_b32 v140, s29, v140
    v_xor_b32 v141, s28, v21
    v_and_b32 v141, s29, v141
    v_xor_b32 v142, s28, v22
    v_and_b32 v142, s29, v142
    v_xor_b32 v143, s28, v23
    v_and_b32 v143, s29, v143
    v_xor_b32 v144, s28, v24
    v_and_b32 v144, s29, v144
    v_xor_b32 v145, s28, v25
    v_and_b32 v145, s29, v145
    v_xor_b32 v146, s28, v26
    v_and_b32 v146, s29, v146
    v_xor_b32 v147, s28, v27
    v_and_b32 v147, s29, v147
    v_xor_b32 v148, s28, v28
    v_and_b32 v148, s29, v148
    v_xor_b32 v149, s28, v29
    v_and_b32 v149, s29, v149
    v_xor_b32 v150, s28, v30
    v_and_b32 v150, s29, v150
    v_xor_b32 v151, s28, v31
    v_and_b32 v151, s29, v151
    s_waitcnt vmcnt(0)
    s_nop 1
    v_mfma_f32_32x32x16_bf16 v[176:191], v[32:35], v[124:127], v[136:151]
    v_mfma_f32_32x32x16_bf16 v[176:191], v[36:39], v[64:67], v[176:191]
    s_nop 15
    s_cmp_lg_u32 s69, 0
    s_cbranch_scc1 L_s23
    v_max3_f32 v8, v8, v176, v177
    v_max3_f32 v8, v8, v178, v179
    v_max3_f32 v8, v8, v180, v181
    v_max3_f32 v8, v8, v182, v183
    v_max3_f32 v8, v8, v184, v185
    v_max3_f32 v8, v8, v186, v187
    v_max3_f32 v8, v8, v188, v189
    v_max3_f32 v8, v8, v190, v191
    s_branch L_sn3
L_s23:
    v_sub_f32 v176, v176, v8
    v_sub_f32 v177, v177, v8
    v_sub_f32 v178, v178, v8
    v_sub_f32 v179, v179, v8
    v_sub_f32 v180, v180, v8
    v_sub_f32 v181, v181, v8
    v_sub_f32 v182, v182, v8
    v_sub_f32 v183, v183, v8
    v_sub_f32 v184, v184, v8
    v_sub_f32 v185, v185, v8
    v_sub_f32 v186, v186, v8
    v_sub_f32 v187, v187, v8
    v_sub_f32 v188, v188, v8
    v_sub_f32 v189, v189, v8
    v_sub_f32 v190, v190, v8
    v_sub_f32 v191, v191, v8
    v_exp_f32 v176, v176
    v_exp_f32 v177, v177
    v_exp_f32 v178, v178
    v_exp_f32 v179, v179
    v_exp_f32 v180, v180
    v_exp_f32 v181, v181
    v_exp_f32 v182, v182
    v_exp_f32 v183, v183
    v_exp_f32 v184, v184
    v_exp_f32 v185, v185
    v_exp_f32 v186, v186
    v_exp_f32 v187, v187
    v_exp_f32 v188, v188
    v_exp_f32 v189, v189
    v_exp_f32 v190, v190
    v_exp_f32 v191, v191
    v_cvt_pk_bf16_f32 v128, v176, v177
    v_cvt_pk_bf16_f32 v129, v178, v179
    v_cvt_pk_bf16_f32 v130, v180, v181
    v_cvt_pk_bf16_f32 v131, v182, v183
    v_cvt_pk_bf16_f32 v132, v184, v185
    v_cvt_pk_bf16_f32 v133, v186, v187
    v_cvt_pk_bf16_f32 v134, v188, v189
    v_cvt_pk_bf16_f32 v135, v190, v191
    s_nop 1
    v_mfma_f32_32x32x16_bf16 v[240:255], v[44:47], v[128:131], v[240:255]
    v_mfma_f32_32x32x16_bf16 v[240:255], v[48:51], v[132:135], v[240:255]
    s_nop 15
L_sn3:
    s_add_u32 s70, s70, 1
    s_cmp_le_u32 s70, s67
    s_cbranch_scc1 L_sk3
    v_mov_b32 v9, v8
    s_nop 1
    v_permlane32_swap_b32 v8, v9
    v_max_f32 v8, v8, v9
    s_add_u32 s69, s69, 1
    s_cmp_lt_u32 s69, 2
    s_cbranch_scc1 L_sp3
    s_branch L_B_fin4
L_end:
.if (L_end - L_t_code) < 38016 || (L_nocpf - gated_mix__linear_kernel_hedgehog__sliding_block__prompt_kernel) > 256
.error "code prefetch range / first fetch window"
.endif
    s_endpgm
.section .rodata,"a"
.p2align 6
.amdhsa_kernel gated_mix__linear_kernel_hedgehog__sliding_block__prompt_kernel
  .amdhsa_next_free_vgpr 256
  .amdhsa_next_free_sgpr 102
  .amdhsa_accum_offset 256
  .amdhsa_group_segment_fixed_size 0
  .amdhsa_kernarg_size 88
  .amdhsa_user_sgpr_count 2
  .amdhsa_user_sgpr_kernarg_segment_ptr 1
  .amdhsa_system_sgpr_workgroup_id_x 1
.end_amdhsa_kernel
```
